```python
import torch

def _softmax(x, axis=-1):
    return torch.softmax(x, dim=axis)

def _gelu(x):
    return torch.nn.functional.gelu(x, approximate='tanh')

def _silu(x):
    return torch.nn.functional.silu(x)

def _sigmoid(x):
    return torch.sigmoid(x)

def _layernorm(x, axis=-1, eps=1e-05):
    m = x.mean(dim=axis, keepdim=True)
    v = x.var(dim=axis, keepdim=True, unbiased=False)
    return (x - m) / torch.sqrt(v + eps)

def _scatter_add(tgt, idx, src, axis=0):
    return tgt.clone().index_add_(axis, idx, src)

def _segment_sum(src, seg, n):
    out = torch.zeros((n,) + src.shape[1:], dtype=src.dtype)
    return out.index_add_(0, seg, src)

def _pad(x, pw):
    flat = tuple((v for pair in reversed(pw) for v in pair))
    return torch.nn.functional.pad(x, flat)
kernel_name = 'adaLN_cond__ssm_conv_s4d__geglu_ffn__prompt'

def setup_inputs():

    _w = lambda a: (lambda t: t.to(torch.bfloat16) if t.is_floating_point() else t)(torch.as_tensor(a))

    def _A_setup():
        Bsz, L, D, N = (1, 2048, 512, 128)
        return {'u': _w((lambda *s: torch.randn(*s, dtype=torch.bfloat16) * 0.05)(Bsz, L, D)), 'log_A_real': _w((lambda *s: torch.randn(*s, dtype=torch.bfloat16) * 3.2)(D, N) * 0.5), 'A_imag': _w((lambda *s: torch.randn(*s, dtype=torch.bfloat16) * 0.05)(D, N) * 3.14), 'C_real': _w((lambda *s: torch.randn(*s, dtype=torch.bfloat16) * 0.4)(D, N) / N ** 0.5), 'C_imag': _w((lambda *s: torch.randn(*s, dtype=torch.bfloat16) * 0.4)(D, N) / N ** 0.5), 'log_dt': _w((lambda *s: torch.randn(*s, dtype=torch.bfloat16) * 0.05)(D) * 0.5 - 4.0), 'D_skip': _w((lambda *s: torch.randn(*s, dtype=torch.bfloat16) * 0.1)(D))}
    _A_in = _A_setup()

    def _B_setup():
        B, S, D, F = (1, 2048, 512, 1376)
        return {'x': _w((lambda *s: torch.randn(*s, dtype=torch.bfloat16) * 0.05)(B, S, D)), 'w_gate': _w((lambda *s: torch.randn(*s, dtype=torch.bfloat16) * 0.05)(D, F)), 'w_up': _w((lambda *s: torch.randn(*s, dtype=torch.bfloat16) * 0.05)(D, F)), 'w_down': _w((lambda *s: torch.randn(*s, dtype=torch.bfloat16) * 0.05)(F, D))}
    _B_in = _B_setup()
    return {'A_u': _A_in['u'], 'A_log_A_real': _A_in['log_A_real'], 'A_A_imag': _A_in['A_imag'], 'A_C_real': _A_in['C_real'], 'A_C_imag': _A_in['C_imag'], 'A_log_dt': _A_in['log_dt'], 'A_D_skip': _A_in['D_skip'], 'B_x': _B_in['x'], 'B_w_gate': _B_in['w_gate'], 'B_w_up': _B_in['w_up'], 'B_w_down': _B_in['w_down'], 'c': _w((lambda *s: torch.randn(*s, dtype=torch.bfloat16) * 0.2)(1, 512) * 8.0), 'w_mod': _w((lambda *s: torch.randn(*s, dtype=torch.bfloat16) * 0.2)(512, 6 * 512) * 512 ** (-0.5) * 8.0)}

def reference(A_u, A_log_A_real, A_A_imag, A_C_real, A_C_imag, A_log_dt, A_D_skip, B_x, B_w_gate, B_w_up, B_w_down, c, w_mod):

    def _A_ref(u, log_A_real, A_imag, C_real, C_imag, log_dt, D_skip):
        L = u.shape[1]
        dt = torch.exp(log_dt)
        A = -torch.exp(log_A_real) + 1j * A_imag
        C = (C_real + 1j * C_imag) * dt[:, None]
        pos = (lambda x, dt: x.to(dt))(torch.arange(L), log_dt.dtype)
        P = torch.exp((A * dt[:, None])[:, :, None] * pos[None, None, :])
        K = 2.0 * torch.einsum('dn,dnl->dl', C, P).real
        L2 = 2 * L
        u_t = (lambda x, *d: x.permute(*d))(u, 0, 2, 1)
        Kf = (lambda x, *a, **k: torch.fft.rfft(x.float(), *a, **k))(K, L2)
        Uf = (lambda x, *a, **k: torch.fft.rfft(x.float(), *a, **k))(u_t, L2)
        y = (lambda x, *a, **k: torch.fft.irfft(x, *a, **k).to(torch.bfloat16))(Uf * Kf[None, :, :], L2)[:, :, :L]
        y = (lambda x, *d: x.permute(*d))(y, 0, 2, 1)
        return y + u * D_skip[None, None, :]

    def _B_ref(x, w_gate, w_up, w_down):
        return _gelu(x @ w_gate) * (x @ w_up) @ w_down
    x = A_u
    mod = (_silu(c) @ w_mod).reshape(c.shape[0], 6, 1, -1)
    sa, ca, ga, sb, cb, gb = (mod[:, 0].clone(), mod[:, 1].clone(), mod[:, 2].clone(), mod[:, 3].clone(), mod[:, 4].clone(), mod[:, 5].clone())
    h = _layernorm(x, axis=-1) * (1 + ca) + sa
    x = x + ga * _A_ref(h, A_log_A_real, A_A_imag, A_C_real, A_C_imag, A_log_dt, A_D_skip)
    h = _layernorm(x, axis=-1) * (1 + cb) + sb
    x = x + gb * _B_ref(h, B_w_gate, B_w_up, B_w_down)
    return x
```

```asm
; @launch grid=(256,1,1) block=(768,1,1) lds=163840
.amdgcn_target "amdgcn-amd-amdhsa--gfx950"
.text
.globl adaLN_cond__ssm_conv_s4d__geglu_ffn__prompt_kernel
.p2align 8
.type adaLN_cond__ssm_conv_s4d__geglu_ffn__prompt_kernel,@function
adaLN_cond__ssm_conv_s4d__geglu_ffn__prompt_kernel:
    s_cmp_ge_u32 s2, 256
    s_cbranch_scc1 L_kf_exit
    s_load_dwordx16 s[4:19], s[0:1], 0
    s_load_dwordx16 s[20:35], s[0:1], 64
    v_lshrrev_b32 v1, 6, v0
    s_nop 0
    v_readfirstlane_b32 s40, v1
    s_and_b32 s41, s2, 7
    s_lshl_b32 s41, s41, 5
    s_lshr_b32 s42, s2, 3
    s_add_u32 s41, s41, s42
    s_lshl_b32 s41, s41, 1
    s_cmp_lt_u32 s40, 8
    s_cbranch_scc1 L_kgen
    v_subrev_u32 v0, 512, v0
    v_and_b32 v1, 63, v0
    s_sub_u32 s42, s40, 8
    s_cmp_eq_u32 s42, 0
    s_cbranch_scc1 L_help_n
    s_cmp_lt_u32 s42, 3
    s_cbranch_scc1 L_help_s
    s_cmp_lt_u32 s2, 192
    s_cbranch_scc0 L_help_n
    s_cmp_lt_u32 s2, 64
    s_cbranch_scc0 L_help_d
    v_lshrrev_b32 v6, 2, v1
    v_and_b32 v7, 3, v1
    v_lshlrev_b32 v3, 11, v7
    v_lshl_add_u32 v3, v6, 2, v3
    v_lshlrev_b32 v4, 4, v1
    s_lshl_b32 s52, s2, 13
    s_lshl_b32 s53, s42, 8
    s_add_u32 s53, s53, s52
    s_and_b32 s62, s2, 3
    s_lshr_b32 s63, s2, 2
    v_lshrrev_b32 v8, 3, v1
    v_and_b32 v9, 3, v8
    v_lshlrev_b32 v9, 1, v9
    v_and_b32 v10, 7, v1
    v_xor_b32 v9, v9, v10
    v_mul_u32_u24 v8, 6144, v8
    v_lshl_add_u32 v8, v9, 4, v8
    v_lshlrev_b32 v9, 2, v1
    s_lshl_b32 s64, s62, 8
    v_add_u32 v9, s64, v9
    s_waitcnt lgkmcnt(0)
    s_mov_b32 s44, s4
    s_and_b32 s45, s5, 0xffff
    s_mov_b32 s46, 0x200000
    s_mov_b32 s47, 0x00020000
    buffer_load_dword v16, v3, s[44:47], s53 offen offset:0
    buffer_load_dword v18, v3, s[44:47], s53 offen offset:1024
    buffer_load_dword v20, v3, s[44:47], s53 offen offset:64
    buffer_load_dword v22, v3, s[44:47], s53 offen offset:1088
    buffer_load_dword v24, v3, s[44:47], s53 offen offset:128
    buffer_load_dword v26, v3, s[44:47], s53 offen offset:1152
    buffer_load_dword v28, v3, s[44:47], s53 offen offset:192
    buffer_load_dword v30, v3, s[44:47], s53 offen offset:1216
    s_mov_b32 s58, 16777216
    s_load_dword s59, s[34:35], s58
    s_mov_b32 s68, s28
    s_and_b32 s69, s29, 0xffff
    s_mov_b32 s70, 0x300000
    s_mov_b32 s71, 0x00020000
    global_load_dword v64, v9, s[26:27]
    s_mul_i32 s64, s62, 786432
    s_lshl_b32 s65, s63, 7
    s_add_u32 s64, s64, s65
    s_mov_b32 s65, 117504
    s_mov_b32 m0, s65
    s_nop 0
    buffer_load_dwordx4 v8, s[68:71], s64 offen lds
    s_add_u32 s65, s65, 1024
    s_add_u32 s64, s64, 49152
    s_mov_b32 m0, s65
    s_nop 0
    buffer_load_dwordx4 v8, s[68:71], s64 offen lds
    s_add_u32 s65, s65, 1024
    s_add_u32 s64, s64, 49152
    s_mov_b32 m0, s65
    s_nop 0
    buffer_load_dwordx4 v8, s[68:71], s64 offen lds
    s_add_u32 s65, s65, 1024
    s_add_u32 s64, s64, 49152
    s_mov_b32 m0, s65
    s_nop 0
    buffer_load_dwordx4 v8, s[68:71], s64 offen lds
    s_add_u32 s65, s65, 1024
    s_add_u32 s64, s64, 49152
    s_mov_b32 m0, s65
    s_nop 0
    buffer_load_dwordx4 v8, s[68:71], s64 offen lds
    s_add_u32 s65, s65, 1024
    s_add_u32 s64, s64, 49152
    s_mov_b32 m0, s65
    s_nop 0
    buffer_load_dwordx4 v8, s[68:71], s64 offen lds
    s_add_u32 s65, s65, 1024
    s_add_u32 s64, s64, 49152
    s_mov_b32 m0, s65
    s_nop 0
    buffer_load_dwordx4 v8, s[68:71], s64 offen lds
    s_add_u32 s65, s65, 1024
    s_add_u32 s64, s64, 49152
    s_mov_b32 m0, s65
    s_nop 0
    buffer_load_dwordx4 v8, s[68:71], s64 offen lds
    s_add_u32 s65, s65, 1024
    s_add_u32 s64, s64, 49152
    s_mov_b32 m0, s65
    s_nop 0
    buffer_load_dwordx4 v8, s[68:71], s64 offen lds
    s_add_u32 s65, s65, 1024
    s_add_u32 s64, s64, 49152
    s_mov_b32 m0, s65
    s_nop 0
    buffer_load_dwordx4 v8, s[68:71], s64 offen lds
    s_add_u32 s65, s65, 1024
    s_add_u32 s64, s64, 49152
    s_mov_b32 m0, s65
    s_nop 0
    buffer_load_dwordx4 v8, s[68:71], s64 offen lds
    s_add_u32 s65, s65, 1024
    s_add_u32 s64, s64, 49152
    s_mov_b32 m0, s65
    s_nop 0
    buffer_load_dwordx4 v8, s[68:71], s64 offen lds
    s_add_u32 s65, s65, 1024
    s_add_u32 s64, s64, 49152
    s_mov_b32 m0, s65
    s_nop 0
    buffer_load_dwordx4 v8, s[68:71], s64 offen lds
    s_add_u32 s65, s65, 1024
    s_add_u32 s64, s64, 49152
    s_mov_b32 m0, s65
    s_nop 0
    buffer_load_dwordx4 v8, s[68:71], s64 offen lds
    s_add_u32 s65, s65, 1024
    s_add_u32 s64, s64, 49152
    s_mov_b32 m0, s65
    s_nop 0
    buffer_load_dwordx4 v8, s[68:71], s64 offen lds
    s_add_u32 s65, s65, 1024
    s_add_u32 s64, s64, 49152
    s_mov_b32 m0, s65
    s_nop 0
    buffer_load_dwordx4 v8, s[68:71], s64 offen lds
    s_barrier
    s_add_u32 s48, s34, 0x1000000
    s_addc_u32 s49, s35, 0
    s_and_b32 s49, s49, 0xffff
    s_mov_b32 s50, 0x500000
    s_mov_b32 s51, 0x00020000
    s_setprio 2
    v_lshlrev_b32 v5, 14, v6
    v_lshl_add_u32 v5, v7, 4, v5
    s_lshl_b32 s52, s42, 20
    s_lshl_b32 s53, s2, 6
    s_add_u32 s52, s52, s53
    s_add_u32 s52, s52, 1048576
    s_waitcnt lgkmcnt(0)
    s_add_u32 s59, s59, 1
    v_mov_b32 v17, s59
    v_mov_b32 v19, s59
    v_mov_b32 v21, s59
    v_mov_b32 v23, s59
    v_mov_b32 v25, s59
    v_mov_b32 v27, s59
    v_mov_b32 v29, s59
    v_mov_b32 v31, s59
    s_waitcnt vmcnt(17)
    buffer_store_dwordx4 v[16:19], v5, s[48:51], s52 offen sc1
    s_add_u32 s52, s52, 262144
    buffer_store_dwordx4 v[20:23], v5, s[48:51], s52 offen sc1
    s_add_u32 s52, s52, 262144
    buffer_store_dwordx4 v[24:27], v5, s[48:51], s52 offen sc1
    s_add_u32 s52, s52, 262144
    buffer_store_dwordx4 v[28:31], v5, s[48:51], s52 offen sc1
    v_lshrrev_b32 v10, 4, v1
    v_bfe_u32 v11, v1, 2, 2
    v_lshl_add_u32 v12, v10, 3, v11
    v_lshlrev_b32 v12, 7, v12
    v_and_b32 v13, 3, v1
    v_lshlrev_b32 v14, 3, v13
    v_lshlrev_b32 v156, 4, v10
    v_xor_b32 v15, 0, v11
    v_lshl_add_u32 v15, v15, 5, v14
    v_add_u32 v15, v12, v15
    v_add_u32 v152, 117504, v15
    v_xor_b32 v15, 1, v11
    v_lshl_add_u32 v15, v15, 5, v14
    v_add_u32 v15, v12, v15
    v_add_u32 v153, 117504, v15
    v_xor_b32 v15, 2, v11
    v_lshl_add_u32 v15, v15, 5, v14
    v_add_u32 v15, v12, v15
    v_add_u32 v154, 117504, v15
    v_xor_b32 v15, 3, v11
    v_lshl_add_u32 v15, v15, 5, v14
    v_add_u32 v15, v12, v15
    v_add_u32 v155, 117504, v15
    s_waitcnt vmcnt(20)
    v_lshlrev_b32 v148, 16, v64
    v_and_b32 v149, 0xffff0000, v64
    v_mul_f32 v150, 0xbfb8aa3b, v148
    v_mul_f32 v151, 0xbfb8aa3b, v149
    v_exp_f32 v150, v150
    v_exp_f32 v151, v151
    v_add_f32 v150, 1.0, v150
    v_add_f32 v151, 1.0, v151
    v_rcp_f32 v150, v150
    v_rcp_f32 v151, v151
    v_mul_f32 v150, v148, v150
    v_mul_f32 v151, v149, v151
    v_cvt_pk_bf16_f32 v148, v150, v151
    v_lshlrev_b32 v10, 2, v1
    ds_write_b32 v10, v148 offset:128
    s_waitcnt vmcnt(4) lgkmcnt(0)
    ds_read_b128 v[132:135], v156 offset:128
    ds_read_b128 v[136:139], v156 offset:192
    ds_read_b128 v[140:143], v156 offset:256
    ds_read_b128 v[144:147], v156 offset:320
    ds_read_b64_tr_b16 v[68:69], v152 offset:0
    ds_read_b64_tr_b16 v[70:71], v152 offset:512
    ds_read_b64_tr_b16 v[72:73], v153 offset:0
    ds_read_b64_tr_b16 v[74:75], v153 offset:512
    ds_read_b64_tr_b16 v[76:77], v154 offset:0
    ds_read_b64_tr_b16 v[78:79], v154 offset:512
    ds_read_b64_tr_b16 v[80:81], v155 offset:0
    ds_read_b64_tr_b16 v[82:83], v155 offset:512
    ds_read_b64_tr_b16 v[84:85], v152 offset:4096
    ds_read_b64_tr_b16 v[86:87], v152 offset:4608
    ds_read_b64_tr_b16 v[88:89], v153 offset:4096
    ds_read_b64_tr_b16 v[90:91], v153 offset:4608
    ds_read_b64_tr_b16 v[92:93], v154 offset:4096
    ds_read_b64_tr_b16 v[94:95], v154 offset:4608
    ds_read_b64_tr_b16 v[96:97], v155 offset:4096
    ds_read_b64_tr_b16 v[98:99], v155 offset:4608
    s_waitcnt lgkmcnt(8)
    v_mfma_f32_16x16x32_bf16 v[16:19], v[132:135], v[68:71], 0
    v_mfma_f32_16x16x32_bf16 v[20:23], v[132:135], v[72:75], 0
    v_mfma_f32_16x16x32_bf16 v[24:27], v[132:135], v[76:79], 0
    v_mfma_f32_16x16x32_bf16 v[28:31], v[132:135], v[80:83], 0
    ds_read_b64_tr_b16 v[100:101], v152 offset:8192
    ds_read_b64_tr_b16 v[102:103], v152 offset:8704
    ds_read_b64_tr_b16 v[104:105], v153 offset:8192
    ds_read_b64_tr_b16 v[106:107], v153 offset:8704
    ds_read_b64_tr_b16 v[108:109], v154 offset:8192
    ds_read_b64_tr_b16 v[110:111], v154 offset:8704
    ds_read_b64_tr_b16 v[112:113], v155 offset:8192
    ds_read_b64_tr_b16 v[114:115], v155 offset:8704
    s_waitcnt lgkmcnt(8)
    v_mfma_f32_16x16x32_bf16 v[16:19], v[136:139], v[84:87], v[16:19]
    v_mfma_f32_16x16x32_bf16 v[20:23], v[136:139], v[88:91], v[20:23]
    v_mfma_f32_16x16x32_bf16 v[24:27], v[136:139], v[92:95], v[24:27]
    v_mfma_f32_16x16x32_bf16 v[28:31], v[136:139], v[96:99], v[28:31]
    ds_read_b64_tr_b16 v[116:117], v152 offset:12288
    ds_read_b64_tr_b16 v[118:119], v152 offset:12800
    ds_read_b64_tr_b16 v[120:121], v153 offset:12288
    ds_read_b64_tr_b16 v[122:123], v153 offset:12800
    ds_read_b64_tr_b16 v[124:125], v154 offset:12288
    ds_read_b64_tr_b16 v[126:127], v154 offset:12800
    ds_read_b64_tr_b16 v[128:129], v155 offset:12288
    ds_read_b64_tr_b16 v[130:131], v155 offset:12800
    s_waitcnt lgkmcnt(8)
    v_mfma_f32_16x16x32_bf16 v[16:19], v[140:143], v[100:103], v[16:19]
    v_mfma_f32_16x16x32_bf16 v[20:23], v[140:143], v[104:107], v[20:23]
    v_mfma_f32_16x16x32_bf16 v[24:27], v[140:143], v[108:111], v[24:27]
    v_mfma_f32_16x16x32_bf16 v[28:31], v[140:143], v[112:115], v[28:31]
    s_waitcnt lgkmcnt(0)
    v_mfma_f32_16x16x32_bf16 v[16:19], v[144:147], v[116:119], v[16:19]
    v_mfma_f32_16x16x32_bf16 v[20:23], v[144:147], v[120:123], v[20:23]
    v_mfma_f32_16x16x32_bf16 v[24:27], v[144:147], v[124:127], v[24:27]
    v_mfma_f32_16x16x32_bf16 v[28:31], v[144:147], v[128:131], v[28:31]
    v_lshrrev_b32 v10, 4, v1
    v_lshlrev_b32 v11, 3, v1
    s_mul_i32 s64, s62, 24576
    s_lshl_b32 s65, s63, 9
    s_add_u32 s64, s64, s65
    s_add_u32 s64, s64, 32768
    v_mov_b32 v13, s59
    v_cmp_eq_u32 vcc, 1, v10
    s_nop 1
    v_cndmask_b32 v12, v16, v20, vcc
    v_cmp_eq_u32 vcc, 2, v10
    s_nop 1
    v_cndmask_b32 v12, v12, v24, vcc
    v_cmp_eq_u32 vcc, 3, v10
    s_nop 1
    v_cndmask_b32 v12, v12, v28, vcc
    buffer_store_dwordx2 v[12:13], v11, s[48:51], s64 offen sc1
    s_setprio 0
    s_lshl_b32 s52, s41, 13
    s_lshl_b32 s53, s42, 12
    s_add_u32 s52, s52, s53
    s_add_u32 s52, s52, 1048576
    s_add_u32 s53, s53, 4096
    v_min_u32 v6, 7, v1
    v_and_b32 v8, 3, v6
    v_mul_u32_u24 v8, 24576, v8
    v_lshrrev_b32 v6, 2, v6
    v_lshl_add_u32 v6, v6, 12, v8
    s_lshl_b32 s54, s41, 3
    s_add_u32 s54, s54, 32768
    v_lshlrev_b32 v7, 2, v1
    s_lshl_b32 s55, s42, 10
    v_add_u32 v7, s55, v7
    s_mov_b32 s36, 0x05040100
    s_mov_b32 s37, 0x07060302
    v_mov_b32 v10, 48
    s_mov_b32 s61, 0
L_lw_gc:
    ds_read_b32 v11, v10
    s_waitcnt lgkmcnt(0)
    v_readfirstlane_b32 s60, v11
    s_add_u32 s61, s61, 1
    s_cmp_ge_u32 s60, 4
    s_cbranch_scc1 L_lx_gc
    s_sleep 2
    s_cmp_lt_u32 s61, 64000
    s_cbranch_scc1 L_lw_gc
L_lx_gc:
    s_mov_b32 s57, 511
    s_mov_b32 s58, 0
L_pe_hc:
    s_bitcmp1_b32 s57, 0
    s_cbranch_scc0 L_pe_hc_0
    buffer_load_dwordx4 v[16:19], v4, s[48:51], s52 offen offset:0 sc1
L_pe_hc_0:
    s_bitcmp1_b32 s57, 1
    s_cbranch_scc0 L_pe_hc_1
    buffer_load_dwordx4 v[20:23], v4, s[48:51], s52 offen offset:1024 sc1
L_pe_hc_1:
    s_bitcmp1_b32 s57, 2
    s_cbranch_scc0 L_pe_hc_2
    buffer_load_dwordx4 v[24:27], v4, s[48:51], s52 offen offset:2048 sc1
L_pe_hc_2:
    s_bitcmp1_b32 s57, 3
    s_cbranch_scc0 L_pe_hc_3
    buffer_load_dwordx4 v[28:31], v4, s[48:51], s52 offen offset:3072 sc1
L_pe_hc_3:
    s_bitcmp1_b32 s57, 4
    s_cbranch_scc0 L_pe_hc_4
    buffer_load_dwordx4 v[32:35], v4, s[48:51], s53 offen offset:0 sc1
L_pe_hc_4:
    s_bitcmp1_b32 s57, 5
    s_cbranch_scc0 L_pe_hc_5
    buffer_load_dwordx4 v[36:39], v4, s[48:51], s53 offen offset:1024 sc1
L_pe_hc_5:
    s_bitcmp1_b32 s57, 6
    s_cbranch_scc0 L_pe_hc_6
    buffer_load_dwordx4 v[40:43], v4, s[48:51], s53 offen offset:2048 sc1
L_pe_hc_6:
    s_bitcmp1_b32 s57, 7
    s_cbranch_scc0 L_pe_hc_7
    buffer_load_dwordx4 v[44:47], v4, s[48:51], s53 offen offset:3072 sc1
L_pe_hc_7:
    s_bitcmp1_b32 s57, 8
    s_cbranch_scc0 L_pe_hc_8
    buffer_load_dwordx4 v[48:51], v6, s[48:51], s54 offen sc1
L_pe_hc_8:
    s_waitcnt vmcnt(0)
    s_mov_b32 s57, 0
    v_sad_u32 v52, v17, s59, 0
    v_sad_u32 v53, v19, s59, 0
    v_sad_u32 v52, v21, s59, v52
    v_sad_u32 v53, v23, s59, v53
    v_sad_u32 v52, v25, s59, v52
    v_sad_u32 v53, v27, s59, v53
    v_sad_u32 v52, v29, s59, v52
    v_sad_u32 v53, v31, s59, v53
    v_sad_u32 v52, v33, s59, v52
    v_sad_u32 v53, v35, s59, v53
    v_sad_u32 v52, v37, s59, v52
    v_sad_u32 v53, v39, s59, v53
    v_sad_u32 v52, v41, s59, v52
    v_sad_u32 v53, v43, s59, v53
    v_sad_u32 v52, v45, s59, v52
    v_sad_u32 v53, v47, s59, v53
    v_sad_u32 v52, v49, s59, v52
    v_sad_u32 v53, v51, s59, v53
    v_or_b32 v52, v52, v53
    v_cmp_ne_u32 vcc, 0, v52
    s_cmp_eq_u64 vcc, 0
    s_cbranch_scc1 L_ps_hc
    v_sad_u32 v52, v17, s59, 0
    v_sad_u32 v52, v19, s59, v52
    v_cmp_ne_u32 vcc, 0, v52
    s_cmp_lg_u64 vcc, 0
    s_cselect_b32 s56, 1, 0
    s_or_b32 s57, s57, s56
    v_sad_u32 v53, v21, s59, 0
    v_sad_u32 v53, v23, s59, v53
    v_cmp_ne_u32 vcc, 0, v53
    s_cmp_lg_u64 vcc, 0
    s_cselect_b32 s56, 2, 0
    s_or_b32 s57, s57, s56
    v_sad_u32 v52, v25, s59, 0
    v_sad_u32 v52, v27, s59, v52
    v_cmp_ne_u32 vcc, 0, v52
    s_cmp_lg_u64 vcc, 0
    s_cselect_b32 s56, 4, 0
    s_or_b32 s57, s57, s56
    v_sad_u32 v53, v29, s59, 0
    v_sad_u32 v53, v31, s59, v53
    v_cmp_ne_u32 vcc, 0, v53
    s_cmp_lg_u64 vcc, 0
    s_cselect_b32 s56, 8, 0
    s_or_b32 s57, s57, s56
    v_sad_u32 v52, v33, s59, 0
    v_sad_u32 v52, v35, s59, v52
    v_cmp_ne_u32 vcc, 0, v52
    s_cmp_lg_u64 vcc, 0
    s_cselect_b32 s56, 16, 0
    s_or_b32 s57, s57, s56
    v_sad_u32 v53, v37, s59, 0
    v_sad_u32 v53, v39, s59, v53
    v_cmp_ne_u32 vcc, 0, v53
    s_cmp_lg_u64 vcc, 0
    s_cselect_b32 s56, 32, 0
    s_or_b32 s57, s57, s56
    v_sad_u32 v52, v41, s59, 0
    v_sad_u32 v52, v43, s59, v52
    v_cmp_ne_u32 vcc, 0, v52
    s_cmp_lg_u64 vcc, 0
    s_cselect_b32 s56, 64, 0
    s_or_b32 s57, s57, s56
    v_sad_u32 v53, v45, s59, 0
    v_sad_u32 v53, v47, s59, v53
    v_cmp_ne_u32 vcc, 0, v53
    s_cmp_lg_u64 vcc, 0
    s_cselect_b32 s56, 128, 0
    s_or_b32 s57, s57, s56
    v_sad_u32 v52, v49, s59, 0
    v_sad_u32 v52, v51, s59, v52
    v_cmp_ne_u32 vcc, 0, v52
    s_cmp_lg_u64 vcc, 0
    s_cselect_b32 s56, 256, 0
    s_or_b32 s57, s57, s56
    s_cmp_eq_u32 s57, 0
    s_cbranch_scc1 L_ps_hc
    s_sleep 4
    s_add_u32 s58, s58, 1
    s_cmp_lt_u32 s58, 8000
    s_cbranch_scc1 L_pe_hc
L_ps_hc:
    v_mov_b32 v10, 72
    v_mov_b32 v11, 1
    s_mov_b64 exec, 1
    ds_add_u32 v10, v11
    s_mov_b64 exec, -1
    v_add_f32_dpp v48, v48, v48 quad_perm:[1,0,3,2] row_mask:0xf bank_mask:0xf
    v_add_f32_dpp v50, v50, v50 quad_perm:[1,0,3,2] row_mask:0xf bank_mask:0xf
    s_nop 0
    v_add_f32_dpp v48, v48, v48 quad_perm:[2,3,0,1] row_mask:0xf bank_mask:0xf
    v_add_f32_dpp v50, v50, v50 quad_perm:[2,3,0,1] row_mask:0xf bank_mask:0xf
    v_cvt_pk_bf16_f32 v49, v48, v50
    v_lshlrev_b32 v48, 16, v49
    v_and_b32 v50, 0xffff0000, v49
    v_mov_b32 v49, v50
    v_readlane_b32 s60, v48, 0
    v_readlane_b32 s61, v49, 0
    v_readlane_b32 s64, v48, 4
    v_readlane_b32 s65, v49, 4
    v_mov_b32 v72, s60
    v_mov_b32 v73, s61
    v_add_f32 v74, 1.0, s64
    v_add_f32 v75, 1.0, s65
    v_cvt_pk_bf16_f32 v76, v74, v75
    v_lshlrev_b32 v74, 16, v76
    v_and_b32 v75, 0xffff0000, v76
    v_and_b32 v57, 0xffff0000, v32
    v_lshlrev_b32 v56, 16, v32
    v_rcp_f32 v57, v57
    v_lshlrev_b32 v60, 16, v16
    v_and_b32 v61, 0xffff0000, v16
    v_and_b32 v59, 0xffff0000, v34
    v_lshlrev_b32 v58, 16, v34
    v_rcp_f32 v59, v59
    v_lshlrev_b32 v62, 16, v18
    v_and_b32 v63, 0xffff0000, v18
    v_pk_add_f32 v[60:61], v[60:61], v[56:57] op_sel_hi:[1,0]
    v_pk_add_f32 v[62:63], v[62:63], v[58:59] op_sel_hi:[1,0]
    v_pk_mul_f32 v[60:61], v[60:61], v[56:57] op_sel:[0,1] op_sel_hi:[1,1]
    v_pk_mul_f32 v[62:63], v[62:63], v[58:59] op_sel:[0,1] op_sel_hi:[1,1]
    v_pk_fma_f32 v[60:61], v[60:61], v[74:75], v[72:73]
    v_pk_fma_f32 v[62:63], v[62:63], v[74:75], v[72:73]
    v_cvt_pk_bf16_f32 v64, v60, v62
    v_cvt_pk_bf16_f32 v65, v61, v63
    v_perm_b32 v66, v18, v16, s36
    v_perm_b32 v67, v18, v16, s37
    ds_write2st64_b32 v7, v64, v65 offset0:134 offset1:152
    ds_write2st64_b32 v7, v66, v67 offset0:168 offset1:184
    v_and_b32 v57, 0xffff0000, v36
    v_lshlrev_b32 v56, 16, v36
    v_rcp_f32 v57, v57
    v_lshlrev_b32 v60, 16, v20
    v_and_b32 v61, 0xffff0000, v20
    v_and_b32 v59, 0xffff0000, v38
    v_lshlrev_b32 v58, 16, v38
    v_rcp_f32 v59, v59
    v_lshlrev_b32 v62, 16, v22
    v_and_b32 v63, 0xffff0000, v22
    v_pk_add_f32 v[60:61], v[60:61], v[56:57] op_sel_hi:[1,0]
    v_pk_add_f32 v[62:63], v[62:63], v[58:59] op_sel_hi:[1,0]
    v_pk_mul_f32 v[60:61], v[60:61], v[56:57] op_sel:[0,1] op_sel_hi:[1,1]
    v_pk_mul_f32 v[62:63], v[62:63], v[58:59] op_sel:[0,1] op_sel_hi:[1,1]
    v_pk_fma_f32 v[60:61], v[60:61], v[74:75], v[72:73]
    v_pk_fma_f32 v[62:63], v[62:63], v[74:75], v[72:73]
    v_cvt_pk_bf16_f32 v68, v60, v62
    v_cvt_pk_bf16_f32 v69, v61, v63
    v_perm_b32 v70, v22, v20, s36
    v_perm_b32 v71, v22, v20, s37
    ds_write2st64_b32 v7, v68, v69 offset0:135 offset1:153
    ds_write2st64_b32 v7, v70, v71 offset0:169 offset1:185
    v_and_b32 v57, 0xffff0000, v40
    v_lshlrev_b32 v56, 16, v40
    v_rcp_f32 v57, v57
    v_lshlrev_b32 v60, 16, v24
    v_and_b32 v61, 0xffff0000, v24
    v_and_b32 v59, 0xffff0000, v42
    v_lshlrev_b32 v58, 16, v42
    v_rcp_f32 v59, v59
    v_lshlrev_b32 v62, 16, v26
    v_and_b32 v63, 0xffff0000, v26
    v_pk_add_f32 v[60:61], v[60:61], v[56:57] op_sel_hi:[1,0]
    v_pk_add_f32 v[62:63], v[62:63], v[58:59] op_sel_hi:[1,0]
    v_pk_mul_f32 v[60:61], v[60:61], v[56:57] op_sel:[0,1] op_sel_hi:[1,1]
    v_pk_mul_f32 v[62:63], v[62:63], v[58:59] op_sel:[0,1] op_sel_hi:[1,1]
    v_pk_fma_f32 v[60:61], v[60:61], v[74:75], v[72:73]
    v_pk_fma_f32 v[62:63], v[62:63], v[74:75], v[72:73]
    v_cvt_pk_bf16_f32 v64, v60, v62
    v_cvt_pk_bf16_f32 v65, v61, v63
    v_perm_b32 v66, v26, v24, s36
    v_perm_b32 v67, v26, v24, s37
    ds_write2st64_b32 v7, v64, v65 offset0:136 offset1:154
    ds_write2st64_b32 v7, v66, v67 offset0:170 offset1:186
    v_and_b32 v57, 0xffff0000, v44
    v_lshlrev_b32 v56, 16, v44
    v_rcp_f32 v57, v57
    v_lshlrev_b32 v60, 16, v28
    v_and_b32 v61, 0xffff0000, v28
    v_and_b32 v59, 0xffff0000, v46
    v_lshlrev_b32 v58, 16, v46
    v_rcp_f32 v59, v59
    v_lshlrev_b32 v62, 16, v30
    v_and_b32 v63, 0xffff0000, v30
    v_pk_add_f32 v[60:61], v[60:61], v[56:57] op_sel_hi:[1,0]
    v_pk_add_f32 v[62:63], v[62:63], v[58:59] op_sel_hi:[1,0]
    v_pk_mul_f32 v[60:61], v[60:61], v[56:57] op_sel:[0,1] op_sel_hi:[1,1]
    v_pk_mul_f32 v[62:63], v[62:63], v[58:59] op_sel:[0,1] op_sel_hi:[1,1]
    v_pk_fma_f32 v[60:61], v[60:61], v[74:75], v[72:73]
    v_pk_fma_f32 v[62:63], v[62:63], v[74:75], v[72:73]
    v_cvt_pk_bf16_f32 v68, v60, v62
    v_cvt_pk_bf16_f32 v69, v61, v63
    v_perm_b32 v70, v30, v28, s36
    v_perm_b32 v71, v30, v28, s37
    ds_write2st64_b32 v7, v68, v69 offset0:137 offset1:155
    ds_write2st64_b32 v7, v70, v71 offset0:171 offset1:187
    s_waitcnt lgkmcnt(0)
    s_barrier
    s_branch L_k12_end
L_help_s:
    v_lshrrev_b32 v6, 2, v1
    v_and_b32 v7, 3, v1
    v_lshlrev_b32 v3, 11, v7
    v_lshl_add_u32 v3, v6, 2, v3
    v_lshlrev_b32 v4, 4, v1
    s_lshl_b32 s52, s2, 13
    s_lshl_b32 s53, s42, 8
    s_add_u32 s53, s53, s52
    s_sub_u32 s54, s42, 1
    s_lshl_b32 s54, s54, 12
    s_add_u32 s54, s54, s52
    s_waitcnt lgkmcnt(0)
    s_mov_b32 s44, s4
    s_and_b32 s45, s5, 0xffff
    s_mov_b32 s46, 0x200000
    s_mov_b32 s47, 0x00020000
    buffer_load_dword v16, v3, s[44:47], s53 offen offset:0
    buffer_load_dword v18, v3, s[44:47], s53 offen offset:1024
    buffer_load_dword v20, v3, s[44:47], s53 offen offset:64
    buffer_load_dword v22, v3, s[44:47], s53 offen offset:1088
    buffer_load_dword v24, v3, s[44:47], s53 offen offset:128
    buffer_load_dword v26, v3, s[44:47], s53 offen offset:1152
    buffer_load_dword v28, v3, s[44:47], s53 offen offset:192
    buffer_load_dword v30, v3, s[44:47], s53 offen offset:1216
    s_mov_b32 s58, 16777216
    s_load_dword s59, s[34:35], s58
    s_add_u32 s48, s34, 0x1000000
    s_addc_u32 s49, s35, 0
    s_and_b32 s49, s49, 0xffff
    s_mov_b32 s50, 0x500000
    s_mov_b32 s51, 0x00020000
    s_cmp_eq_u32 s42, 1
    s_cbranch_scc0 L_noclrs
    s_cmp_lt_u32 s2, 9
    s_cbranch_scc0 L_noclrs
    v_lshlrev_b32 v12, 7, v1
    v_mov_b32 v13, 0
    s_lshl_b32 s55, s2, 11
    s_add_u32 s55, s55, 393216
    s_mov_b64 exec, 0xffff
    buffer_store_dword v13, v12, s[48:51], s55 offen sc1
    buffer_store_dword v13, v12, s[48:51], s55 offen offset:64 sc1
    s_mov_b64 exec, -1
L_noclrs:
    buffer_load_dwordx4 v[80:83], v4, s[44:47], s54 offen offset:0
    buffer_load_dwordx4 v[84:87], v4, s[44:47], s54 offen offset:1024
    buffer_load_dwordx4 v[88:91], v4, s[44:47], s54 offen offset:2048
    buffer_load_dwordx4 v[92:95], v4, s[44:47], s54 offen offset:3072
    s_barrier
    s_setprio 2
    v_lshlrev_b32 v5, 14, v6
    v_lshl_add_u32 v5, v7, 4, v5
    s_lshl_b32 s52, s42, 20
    s_lshl_b32 s53, s2, 6
    s_add_u32 s52, s52, s53
    s_add_u32 s52, s52, 1048576
    s_waitcnt lgkmcnt(0)
    s_add_u32 s59, s59, 1
    v_mov_b32 v17, s59
    v_mov_b32 v19, s59
    v_mov_b32 v21, s59
    v_mov_b32 v23, s59
    v_mov_b32 v25, s59
    v_mov_b32 v27, s59
    v_mov_b32 v29, s59
    v_mov_b32 v31, s59
    s_waitcnt vmcnt(4)
    buffer_store_dwordx4 v[16:19], v5, s[48:51], s52 offen sc1
    s_add_u32 s52, s52, 262144
    buffer_store_dwordx4 v[20:23], v5, s[48:51], s52 offen sc1
    s_add_u32 s52, s52, 262144
    buffer_store_dwordx4 v[24:27], v5, s[48:51], s52 offen sc1
    s_add_u32 s52, s52, 262144
    buffer_store_dwordx4 v[28:31], v5, s[48:51], s52 offen sc1
    s_waitcnt vmcnt(4)
    s_mov_b32 s55, 0x3f803f80
    v_dot2_f32_bf16 v40, v80, s55, 0
    v_dot2_f32_bf16 v44, v80, v80, 0
    v_dot2_f32_bf16 v41, v84, s55, 0
    v_dot2_f32_bf16 v45, v84, v84, 0
    v_dot2_f32_bf16 v42, v88, s55, 0
    v_dot2_f32_bf16 v46, v88, v88, 0
    v_dot2_f32_bf16 v43, v92, s55, 0
    v_dot2_f32_bf16 v47, v92, v92, 0
    v_dot2_f32_bf16 v40, v81, s55, v40
    v_dot2_f32_bf16 v44, v81, v81, v44
    v_dot2_f32_bf16 v41, v85, s55, v41
    v_dot2_f32_bf16 v45, v85, v85, v45
    v_dot2_f32_bf16 v42, v89, s55, v42
    v_dot2_f32_bf16 v46, v89, v89, v46
    v_dot2_f32_bf16 v43, v93, s55, v43
    v_dot2_f32_bf16 v47, v93, v93, v47
    v_dot2_f32_bf16 v40, v82, s55, v40
    v_dot2_f32_bf16 v44, v82, v82, v44
    v_dot2_f32_bf16 v41, v86, s55, v41
    v_dot2_f32_bf16 v45, v86, v86, v45
    v_dot2_f32_bf16 v42, v90, s55, v42
    v_dot2_f32_bf16 v46, v90, v90, v46
    v_dot2_f32_bf16 v43, v94, s55, v43
    v_dot2_f32_bf16 v47, v94, v94, v47
    v_dot2_f32_bf16 v40, v83, s55, v40
    v_dot2_f32_bf16 v44, v83, v83, v44
    v_dot2_f32_bf16 v41, v87, s55, v41
    v_dot2_f32_bf16 v45, v87, v87, v45
    v_dot2_f32_bf16 v42, v91, s55, v42
    v_dot2_f32_bf16 v46, v91, v91, v46
    v_dot2_f32_bf16 v43, v95, s55, v43
    v_dot2_f32_bf16 v47, v95, v95, v47
    s_nop 2
    v_permlane32_swap_b32 v40, v41
    v_permlane32_swap_b32 v42, v43
    v_permlane32_swap_b32 v44, v45
    v_permlane32_swap_b32 v46, v47
    v_add_f32 v40, v40, v41
    v_add_f32 v42, v42, v43
    v_add_f32 v44, v44, v45
    v_add_f32 v46, v46, v47
    s_nop 0
    v_permlane16_swap_b32 v40, v44
    v_permlane16_swap_b32 v42, v46
    v_add_f32 v40, v40, v44
    v_add_f32 v42, v42, v46
    v_mov_b32 v56, 0
    s_nop 1
    v_add_f32_dpp v56, v40, v40 row_ror:8 row_mask:0xf bank_mask:0x3
    s_nop 1
    v_add_f32_dpp v56, v42, v42 row_ror:8 row_mask:0xf bank_mask:0xc
    s_nop 1
    v_add_f32_dpp v56, v56, v56 row_half_mirror row_mask:0xf bank_mask:0xf
    s_nop 1
    v_add_f32_dpp v56, v56, v56 quad_perm:[2,3,0,1] row_mask:0xf bank_mask:0xf
    s_nop 1
    v_add_f32_dpp v56, v56, v56 quad_perm:[1,0,3,2] row_mask:0xf bank_mask:0xf
    v_mov_b32 v57, v56
    s_nop 1
    v_permlane16_swap_b32 v56, v57
    v_mul_f32 v56, 0x3b000000, v56
    v_mul_f32 v57, 0x3b000000, v57
    v_fma_f32 v57, -v56, v56, v57
    v_max_f32 v57, 0, v57
    v_cvt_pk_bf16_f32 v57, v57, v57
    v_and_b32 v57, 0xffff0000, v57
    v_add_f32 v57, 0x3727c5ac, v57
    v_cvt_pk_bf16_f32 v57, v57, v57
    v_and_b32 v57, 0xffff0000, v57
    v_sqrt_f32 v57, v57
    s_nop 0
    v_cvt_pk_bf16_f32 v56, -v56, v57
    v_mov_b32 v57, s59
    v_lshrrev_b32 v10, 5, v1
    v_lshlrev_b32 v10, 3, v10
    v_bfe_u32 v11, v1, 3, 1
    v_lshl_add_u32 v10, v11, 4, v10
    s_lshl_b32 s52, s2, 6
    s_sub_u32 s53, s42, 1
    s_lshl_b32 s53, s53, 5
    s_add_u32 s52, s52, s53
    s_add_u32 s52, s52, 4096
    s_mov_b32 exec_lo, 0x101
    s_mov_b32 exec_hi, 0x101
    buffer_store_dwordx2 v[56:57], v10, s[48:51], s52 offen sc1
    s_mov_b64 exec, -1
    s_setprio 0
    s_lshl_b32 s52, s41, 13
    s_lshl_b32 s53, s42, 12
    s_add_u32 s52, s52, s53
    s_add_u32 s52, s52, 1048576
    s_add_u32 s53, s53, 4096
    v_min_u32 v6, 7, v1
    v_and_b32 v8, 3, v6
    v_mul_u32_u24 v8, 24576, v8
    v_lshrrev_b32 v6, 2, v6
    v_lshl_add_u32 v6, v6, 12, v8
    s_lshl_b32 s54, s41, 3
    s_add_u32 s54, s54, 32768
    v_lshlrev_b32 v7, 2, v1
    s_lshl_b32 s55, s42, 10
    v_add_u32 v7, s55, v7
    s_mov_b32 s36, 0x05040100
    s_mov_b32 s37, 0x07060302
    v_mov_b32 v10, 48
    s_mov_b32 s61, 0
L_lw_gs:
    ds_read_b32 v11, v10
    s_waitcnt lgkmcnt(0)
    v_readfirstlane_b32 s60, v11
    s_add_u32 s61, s61, 1
    s_cmp_ge_u32 s60, 4
    s_cbranch_scc1 L_lx_gs
    s_sleep 2
    s_cmp_lt_u32 s61, 64000
    s_cbranch_scc1 L_lw_gs
L_lx_gs:
    s_mov_b32 s57, 511
    s_mov_b32 s58, 0
L_pe_hs:
    s_bitcmp1_b32 s57, 0
    s_cbranch_scc0 L_pe_hs_0
    buffer_load_dwordx4 v[16:19], v4, s[48:51], s52 offen offset:0 sc1
L_pe_hs_0:
    s_bitcmp1_b32 s57, 1
    s_cbranch_scc0 L_pe_hs_1
    buffer_load_dwordx4 v[20:23], v4, s[48:51], s52 offen offset:1024 sc1
L_pe_hs_1:
    s_bitcmp1_b32 s57, 2
    s_cbranch_scc0 L_pe_hs_2
    buffer_load_dwordx4 v[24:27], v4, s[48:51], s52 offen offset:2048 sc1
L_pe_hs_2:
    s_bitcmp1_b32 s57, 3
    s_cbranch_scc0 L_pe_hs_3
    buffer_load_dwordx4 v[28:31], v4, s[48:51], s52 offen offset:3072 sc1
L_pe_hs_3:
    s_bitcmp1_b32 s57, 4
    s_cbranch_scc0 L_pe_hs_4
    buffer_load_dwordx4 v[32:35], v4, s[48:51], s53 offen offset:0 sc1
L_pe_hs_4:
    s_bitcmp1_b32 s57, 5
    s_cbranch_scc0 L_pe_hs_5
    buffer_load_dwordx4 v[36:39], v4, s[48:51], s53 offen offset:1024 sc1
L_pe_hs_5:
    s_bitcmp1_b32 s57, 6
    s_cbranch_scc0 L_pe_hs_6
    buffer_load_dwordx4 v[40:43], v4, s[48:51], s53 offen offset:2048 sc1
L_pe_hs_6:
    s_bitcmp1_b32 s57, 7
    s_cbranch_scc0 L_pe_hs_7
    buffer_load_dwordx4 v[44:47], v4, s[48:51], s53 offen offset:3072 sc1
L_pe_hs_7:
    s_bitcmp1_b32 s57, 8
    s_cbranch_scc0 L_pe_hs_8
    buffer_load_dwordx4 v[48:51], v6, s[48:51], s54 offen sc1
L_pe_hs_8:
    s_waitcnt vmcnt(0)
    s_mov_b32 s57, 0
    v_sad_u32 v52, v17, s59, 0
    v_sad_u32 v53, v19, s59, 0
    v_sad_u32 v52, v21, s59, v52
    v_sad_u32 v53, v23, s59, v53
    v_sad_u32 v52, v25, s59, v52
    v_sad_u32 v53, v27, s59, v53
    v_sad_u32 v52, v29, s59, v52
    v_sad_u32 v53, v31, s59, v53
    v_sad_u32 v52, v33, s59, v52
    v_sad_u32 v53, v35, s59, v53
    v_sad_u32 v52, v37, s59, v52
    v_sad_u32 v53, v39, s59, v53
    v_sad_u32 v52, v41, s59, v52
    v_sad_u32 v53, v43, s59, v53
    v_sad_u32 v52, v45, s59, v52
    v_sad_u32 v53, v47, s59, v53
    v_sad_u32 v52, v49, s59, v52
    v_sad_u32 v53, v51, s59, v53
    v_or_b32 v52, v52, v53
    v_cmp_ne_u32 vcc, 0, v52
    s_cmp_eq_u64 vcc, 0
    s_cbranch_scc1 L_ps_hs
    v_sad_u32 v52, v17, s59, 0
    v_sad_u32 v52, v19, s59, v52
    v_cmp_ne_u32 vcc, 0, v52
    s_cmp_lg_u64 vcc, 0
    s_cselect_b32 s56, 1, 0
    s_or_b32 s57, s57, s56
    v_sad_u32 v53, v21, s59, 0
    v_sad_u32 v53, v23, s59, v53
    v_cmp_ne_u32 vcc, 0, v53
    s_cmp_lg_u64 vcc, 0
    s_cselect_b32 s56, 2, 0
    s_or_b32 s57, s57, s56
    v_sad_u32 v52, v25, s59, 0
    v_sad_u32 v52, v27, s59, v52
    v_cmp_ne_u32 vcc, 0, v52
    s_cmp_lg_u64 vcc, 0
    s_cselect_b32 s56, 4, 0
    s_or_b32 s57, s57, s56
    v_sad_u32 v53, v29, s59, 0
    v_sad_u32 v53, v31, s59, v53
    v_cmp_ne_u32 vcc, 0, v53
    s_cmp_lg_u64 vcc, 0
    s_cselect_b32 s56, 8, 0
    s_or_b32 s57, s57, s56
    v_sad_u32 v52, v33, s59, 0
    v_sad_u32 v52, v35, s59, v52
    v_cmp_ne_u32 vcc, 0, v52
    s_cmp_lg_u64 vcc, 0
    s_cselect_b32 s56, 16, 0
    s_or_b32 s57, s57, s56
    v_sad_u32 v53, v37, s59, 0
    v_sad_u32 v53, v39, s59, v53
    v_cmp_ne_u32 vcc, 0, v53
    s_cmp_lg_u64 vcc, 0
    s_cselect_b32 s56, 32, 0
    s_or_b32 s57, s57, s56
    v_sad_u32 v52, v41, s59, 0
    v_sad_u32 v52, v43, s59, v52
    v_cmp_ne_u32 vcc, 0, v52
    s_cmp_lg_u64 vcc, 0
    s_cselect_b32 s56, 64, 0
    s_or_b32 s57, s57, s56
    v_sad_u32 v53, v45, s59, 0
    v_sad_u32 v53, v47, s59, v53
    v_cmp_ne_u32 vcc, 0, v53
    s_cmp_lg_u64 vcc, 0
    s_cselect_b32 s56, 128, 0
    s_or_b32 s57, s57, s56
    v_sad_u32 v52, v49, s59, 0
    v_sad_u32 v52, v51, s59, v52
    v_cmp_ne_u32 vcc, 0, v52
    s_cmp_lg_u64 vcc, 0
    s_cselect_b32 s56, 256, 0
    s_or_b32 s57, s57, s56
    s_cmp_eq_u32 s57, 0
    s_cbranch_scc1 L_ps_hs
    s_sleep 4
    s_add_u32 s58, s58, 1
    s_cmp_lt_u32 s58, 8000
    s_cbranch_scc1 L_pe_hs
L_ps_hs:
    v_mov_b32 v10, 72
    v_mov_b32 v11, 1
    s_mov_b64 exec, 1
    ds_add_u32 v10, v11
    s_mov_b64 exec, -1
    v_add_f32_dpp v48, v48, v48 quad_perm:[1,0,3,2] row_mask:0xf bank_mask:0xf
    v_add_f32_dpp v50, v50, v50 quad_perm:[1,0,3,2] row_mask:0xf bank_mask:0xf
    s_nop 0
    v_add_f32_dpp v48, v48, v48 quad_perm:[2,3,0,1] row_mask:0xf bank_mask:0xf
    v_add_f32_dpp v50, v50, v50 quad_perm:[2,3,0,1] row_mask:0xf bank_mask:0xf
    v_cvt_pk_bf16_f32 v49, v48, v50
    v_lshlrev_b32 v48, 16, v49
    v_and_b32 v50, 0xffff0000, v49
    v_mov_b32 v49, v50
    v_readlane_b32 s60, v48, 0
    v_readlane_b32 s61, v49, 0
    v_readlane_b32 s64, v48, 4
    v_readlane_b32 s65, v49, 4
    v_mov_b32 v72, s60
    v_mov_b32 v73, s61
    v_add_f32 v74, 1.0, s64
    v_add_f32 v75, 1.0, s65
    v_cvt_pk_bf16_f32 v76, v74, v75
    v_lshlrev_b32 v74, 16, v76
    v_and_b32 v75, 0xffff0000, v76
    v_and_b32 v57, 0xffff0000, v32
    v_lshlrev_b32 v56, 16, v32
    v_rcp_f32 v57, v57
    v_lshlrev_b32 v60, 16, v16
    v_and_b32 v61, 0xffff0000, v16
    v_and_b32 v59, 0xffff0000, v34
    v_lshlrev_b32 v58, 16, v34
    v_rcp_f32 v59, v59
    v_lshlrev_b32 v62, 16, v18
    v_and_b32 v63, 0xffff0000, v18
    v_pk_add_f32 v[60:61], v[60:61], v[56:57] op_sel_hi:[1,0]
    v_pk_add_f32 v[62:63], v[62:63], v[58:59] op_sel_hi:[1,0]
    v_pk_mul_f32 v[60:61], v[60:61], v[56:57] op_sel:[0,1] op_sel_hi:[1,1]
    v_pk_mul_f32 v[62:63], v[62:63], v[58:59] op_sel:[0,1] op_sel_hi:[1,1]
    v_pk_fma_f32 v[60:61], v[60:61], v[74:75], v[72:73]
    v_pk_fma_f32 v[62:63], v[62:63], v[74:75], v[72:73]
    v_cvt_pk_bf16_f32 v64, v60, v62
    v_cvt_pk_bf16_f32 v65, v61, v63
    v_perm_b32 v66, v18, v16, s36
    v_perm_b32 v67, v18, v16, s37
    ds_write2st64_b32 v7, v64, v65 offset0:134 offset1:152
    ds_write2st64_b32 v7, v66, v67 offset0:168 offset1:184
    v_and_b32 v57, 0xffff0000, v36
    v_lshlrev_b32 v56, 16, v36
    v_rcp_f32 v57, v57
    v_lshlrev_b32 v60, 16, v20
    v_and_b32 v61, 0xffff0000, v20
    v_and_b32 v59, 0xffff0000, v38
    v_lshlrev_b32 v58, 16, v38
    v_rcp_f32 v59, v59
    v_lshlrev_b32 v62, 16, v22
    v_and_b32 v63, 0xffff0000, v22
    v_pk_add_f32 v[60:61], v[60:61], v[56:57] op_sel_hi:[1,0]
    v_pk_add_f32 v[62:63], v[62:63], v[58:59] op_sel_hi:[1,0]
    v_pk_mul_f32 v[60:61], v[60:61], v[56:57] op_sel:[0,1] op_sel_hi:[1,1]
    v_pk_mul_f32 v[62:63], v[62:63], v[58:59] op_sel:[0,1] op_sel_hi:[1,1]
    v_pk_fma_f32 v[60:61], v[60:61], v[74:75], v[72:73]
    v_pk_fma_f32 v[62:63], v[62:63], v[74:75], v[72:73]
    v_cvt_pk_bf16_f32 v68, v60, v62
    v_cvt_pk_bf16_f32 v69, v61, v63
    v_perm_b32 v70, v22, v20, s36
    v_perm_b32 v71, v22, v20, s37
    ds_write2st64_b32 v7, v68, v69 offset0:135 offset1:153
    ds_write2st64_b32 v7, v70, v71 offset0:169 offset1:185
    v_and_b32 v57, 0xffff0000, v40
    v_lshlrev_b32 v56, 16, v40
    v_rcp_f32 v57, v57
    v_lshlrev_b32 v60, 16, v24
    v_and_b32 v61, 0xffff0000, v24
    v_and_b32 v59, 0xffff0000, v42
    v_lshlrev_b32 v58, 16, v42
    v_rcp_f32 v59, v59
    v_lshlrev_b32 v62, 16, v26
    v_and_b32 v63, 0xffff0000, v26
    v_pk_add_f32 v[60:61], v[60:61], v[56:57] op_sel_hi:[1,0]
    v_pk_add_f32 v[62:63], v[62:63], v[58:59] op_sel_hi:[1,0]
    v_pk_mul_f32 v[60:61], v[60:61], v[56:57] op_sel:[0,1] op_sel_hi:[1,1]
    v_pk_mul_f32 v[62:63], v[62:63], v[58:59] op_sel:[0,1] op_sel_hi:[1,1]
    v_pk_fma_f32 v[60:61], v[60:61], v[74:75], v[72:73]
    v_pk_fma_f32 v[62:63], v[62:63], v[74:75], v[72:73]
    v_cvt_pk_bf16_f32 v64, v60, v62
    v_cvt_pk_bf16_f32 v65, v61, v63
    v_perm_b32 v66, v26, v24, s36
    v_perm_b32 v67, v26, v24, s37
    ds_write2st64_b32 v7, v64, v65 offset0:136 offset1:154
    ds_write2st64_b32 v7, v66, v67 offset0:170 offset1:186
    v_and_b32 v57, 0xffff0000, v44
    v_lshlrev_b32 v56, 16, v44
    v_rcp_f32 v57, v57
    v_lshlrev_b32 v60, 16, v28
    v_and_b32 v61, 0xffff0000, v28
    v_and_b32 v59, 0xffff0000, v46
    v_lshlrev_b32 v58, 16, v46
    v_rcp_f32 v59, v59
    v_lshlrev_b32 v62, 16, v30
    v_and_b32 v63, 0xffff0000, v30
    v_pk_add_f32 v[60:61], v[60:61], v[56:57] op_sel_hi:[1,0]
    v_pk_add_f32 v[62:63], v[62:63], v[58:59] op_sel_hi:[1,0]
    v_pk_mul_f32 v[60:61], v[60:61], v[56:57] op_sel:[0,1] op_sel_hi:[1,1]
    v_pk_mul_f32 v[62:63], v[62:63], v[58:59] op_sel:[0,1] op_sel_hi:[1,1]
    v_pk_fma_f32 v[60:61], v[60:61], v[74:75], v[72:73]
    v_pk_fma_f32 v[62:63], v[62:63], v[74:75], v[72:73]
    v_cvt_pk_bf16_f32 v68, v60, v62
    v_cvt_pk_bf16_f32 v69, v61, v63
    v_perm_b32 v70, v30, v28, s36
    v_perm_b32 v71, v30, v28, s37
    ds_write2st64_b32 v7, v68, v69 offset0:137 offset1:155
    ds_write2st64_b32 v7, v70, v71 offset0:171 offset1:187
    s_waitcnt lgkmcnt(0)
    s_barrier
    s_cmp_eq_u32 s42, 2
    s_cbranch_scc0 L_nopa
    s_bfe_u32 s56, s2, 0x40003
    s_lshl_b32 s56, s56, 7
    s_add_u32 s56, s56, 393280
    v_lshlrev_b32 v10, 11, v1
    v_mov_b32 v11, 1
    s_mov_b64 exec, 0xff
    buffer_atomic_add v11, v10, s[48:51], s56 offen sc1
    s_mov_b64 exec, -1
L_nopa:
    s_cmp_eq_u32 s42, 1
    s_cbranch_scc0 L_notouch
    s_and_b32 s60, s2, 7
    s_mul_i32 s60, s60, 22
    s_lshr_b32 s61, s2, 3
    s_add_u32 s62, s60, s61
    s_cmp_lt_u32 s61, 22
    s_cselect_b32 s62, s62, 999
    s_lshr_b32 s60, s62, 2
    s_and_b32 s61, s62, 3
    s_cmp_lt_u32 s62, 172
    s_cbranch_scc0 L_touch
    v_mov_b32 v10, 163380
    s_mov_b32 s61, 0
L_lw_tw:
    ds_read_b32 v11, v10
    s_waitcnt lgkmcnt(0)
    v_readfirstlane_b32 s60, v11
    s_add_u32 s61, s61, 1
    s_cmp_ge_u32 s60, 4
    s_cbranch_scc1 L_lx_tw
    s_sleep 4
    s_cmp_lt_u32 s61, 64000
    s_cbranch_scc1 L_lw_tw
L_lx_tw:
L_touch:
    s_mov_b32 s68, s24
    s_and_b32 s69, s25, 0xffff
    s_mov_b32 s70, 0x158000
    s_mov_b32 s71, 0x00020000
    s_mul_i32 s52, s2, 6144
    v_lshlrev_b32 v10, 4, v1
    buffer_load_dwordx4 v[104:107], v10, s[68:71], s52 offen offset:0
    buffer_load_dwordx4 v[108:111], v10, s[68:71], s52 offen offset:1024
    buffer_load_dwordx4 v[112:115], v10, s[68:71], s52 offen offset:2048
    buffer_load_dwordx4 v[116:119], v10, s[68:71], s52 offen offset:3072
    s_add_u32 s52, s52, 4096
    buffer_load_dwordx4 v[120:123], v10, s[68:71], s52 offen offset:0
    buffer_load_dwordx4 v[124:127], v10, s[68:71], s52 offen offset:1024
L_notouch:
    s_branch L_k12_end
L_help_d:
    v_lshrrev_b32 v6, 2, v1
    v_and_b32 v7, 3, v1
    v_lshlrev_b32 v3, 11, v7
    v_lshl_add_u32 v3, v6, 2, v3
    v_lshlrev_b32 v4, 4, v1
    s_lshl_b32 s52, s2, 13
    s_lshl_b32 s53, s42, 8
    s_add_u32 s53, s53, s52
    s_and_b32 s62, s2, 3
    s_lshr_b32 s63, s2, 2
    v_lshrrev_b32 v8, 3, v1
    v_and_b32 v9, 3, v8
    v_lshlrev_b32 v9, 1, v9
    v_and_b32 v10, 7, v1
    v_xor_b32 v9, v9, v10
    v_mul_u32_u24 v8, 6144, v8
    v_lshl_add_u32 v8, v9, 4, v8
    v_lshlrev_b32 v9, 2, v1
    s_lshl_b32 s64, s62, 8
    v_add_u32 v9, s64, v9
    s_waitcnt lgkmcnt(0)
    s_mov_b32 s44, s4
    s_and_b32 s45, s5, 0xffff
    s_mov_b32 s46, 0x200000
    s_mov_b32 s47, 0x00020000
    buffer_load_dword v16, v3, s[44:47], s53 offen offset:0
    buffer_load_dword v18, v3, s[44:47], s53 offen offset:1024
    buffer_load_dword v20, v3, s[44:47], s53 offen offset:64
    buffer_load_dword v22, v3, s[44:47], s53 offen offset:1088
    buffer_load_dword v24, v3, s[44:47], s53 offen offset:128
    buffer_load_dword v26, v3, s[44:47], s53 offen offset:1152
    buffer_load_dword v28, v3, s[44:47], s53 offen offset:192
    buffer_load_dword v30, v3, s[44:47], s53 offen offset:1216
    s_mov_b32 s58, 16777216
    s_load_dword s59, s[34:35], s58
    s_barrier
    s_add_u32 s48, s34, 0x1000000
    s_addc_u32 s49, s35, 0
    s_and_b32 s49, s49, 0xffff
    s_mov_b32 s50, 0x500000
    s_mov_b32 s51, 0x00020000
    s_setprio 2
    v_lshlrev_b32 v5, 14, v6
    v_lshl_add_u32 v5, v7, 4, v5
    s_lshl_b32 s52, s42, 20
    s_lshl_b32 s53, s2, 6
    s_add_u32 s52, s52, s53
    s_add_u32 s52, s52, 1048576
    s_waitcnt lgkmcnt(0)
    s_add_u32 s59, s59, 1
    v_mov_b32 v17, s59
    v_mov_b32 v19, s59
    v_mov_b32 v21, s59
    v_mov_b32 v23, s59
    v_mov_b32 v25, s59
    v_mov_b32 v27, s59
    v_mov_b32 v29, s59
    v_mov_b32 v31, s59
    s_waitcnt vmcnt(0)
    buffer_store_dwordx4 v[16:19], v5, s[48:51], s52 offen sc1
    s_add_u32 s52, s52, 262144
    buffer_store_dwordx4 v[20:23], v5, s[48:51], s52 offen sc1
    s_add_u32 s52, s52, 262144
    buffer_store_dwordx4 v[24:27], v5, s[48:51], s52 offen sc1
    s_add_u32 s52, s52, 262144
    buffer_store_dwordx4 v[28:31], v5, s[48:51], s52 offen sc1
    s_mov_b32 s68, s28
    s_and_b32 s69, s29, 0xffff
    s_mov_b32 s70, 0x300000
    s_mov_b32 s71, 0x00020000
    global_load_dword v64, v9, s[26:27]
    s_mul_i32 s64, s62, 786432
    s_lshl_b32 s65, s63, 7
    s_add_u32 s64, s64, s65
    s_mov_b32 s65, 117504
    s_mov_b32 m0, s65
    s_nop 0
    buffer_load_dwordx4 v8, s[68:71], s64 offen lds
    s_add_u32 s65, s65, 1024
    s_add_u32 s64, s64, 49152
    s_mov_b32 m0, s65
    s_nop 0
    buffer_load_dwordx4 v8, s[68:71], s64 offen lds
    s_add_u32 s65, s65, 1024
    s_add_u32 s64, s64, 49152
    s_mov_b32 m0, s65
    s_nop 0
    buffer_load_dwordx4 v8, s[68:71], s64 offen lds
    s_add_u32 s65, s65, 1024
    s_add_u32 s64, s64, 49152
    s_mov_b32 m0, s65
    s_nop 0
    buffer_load_dwordx4 v8, s[68:71], s64 offen lds
    s_add_u32 s65, s65, 1024
    s_add_u32 s64, s64, 49152
    s_mov_b32 m0, s65
    s_nop 0
    buffer_load_dwordx4 v8, s[68:71], s64 offen lds
    s_add_u32 s65, s65, 1024
    s_add_u32 s64, s64, 49152
    s_mov_b32 m0, s65
    s_nop 0
    buffer_load_dwordx4 v8, s[68:71], s64 offen lds
    s_add_u32 s65, s65, 1024
    s_add_u32 s64, s64, 49152
    s_mov_b32 m0, s65
    s_nop 0
    buffer_load_dwordx4 v8, s[68:71], s64 offen lds
    s_add_u32 s65, s65, 1024
    s_add_u32 s64, s64, 49152
    s_mov_b32 m0, s65
    s_nop 0
    buffer_load_dwordx4 v8, s[68:71], s64 offen lds
    s_add_u32 s65, s65, 1024
    s_add_u32 s64, s64, 49152
    s_mov_b32 m0, s65
    s_nop 0
    buffer_load_dwordx4 v8, s[68:71], s64 offen lds
    s_add_u32 s65, s65, 1024
    s_add_u32 s64, s64, 49152
    s_mov_b32 m0, s65
    s_nop 0
    buffer_load_dwordx4 v8, s[68:71], s64 offen lds
    s_add_u32 s65, s65, 1024
    s_add_u32 s64, s64, 49152
    s_mov_b32 m0, s65
    s_nop 0
    buffer_load_dwordx4 v8, s[68:71], s64 offen lds
    s_add_u32 s65, s65, 1024
    s_add_u32 s64, s64, 49152
    s_mov_b32 m0, s65
    s_nop 0
    buffer_load_dwordx4 v8, s[68:71], s64 offen lds
    s_add_u32 s65, s65, 1024
    s_add_u32 s64, s64, 49152
    s_mov_b32 m0, s65
    s_nop 0
    buffer_load_dwordx4 v8, s[68:71], s64 offen lds
    s_add_u32 s65, s65, 1024
    s_add_u32 s64, s64, 49152
    s_mov_b32 m0, s65
    s_nop 0
    buffer_load_dwordx4 v8, s[68:71], s64 offen lds
    s_add_u32 s65, s65, 1024
    s_add_u32 s64, s64, 49152
    s_mov_b32 m0, s65
    s_nop 0
    buffer_load_dwordx4 v8, s[68:71], s64 offen lds
    s_add_u32 s65, s65, 1024
    s_add_u32 s64, s64, 49152
    s_mov_b32 m0, s65
    s_nop 0
    buffer_load_dwordx4 v8, s[68:71], s64 offen lds
    v_lshrrev_b32 v10, 4, v1
    v_bfe_u32 v11, v1, 2, 2
    v_lshl_add_u32 v12, v10, 3, v11
    v_lshlrev_b32 v12, 7, v12
    v_and_b32 v13, 3, v1
    v_lshlrev_b32 v14, 3, v13
    v_lshlrev_b32 v156, 4, v10
    v_xor_b32 v15, 0, v11
    v_lshl_add_u32 v15, v15, 5, v14
    v_add_u32 v15, v12, v15
    v_add_u32 v152, 117504, v15
    v_xor_b32 v15, 1, v11
    v_lshl_add_u32 v15, v15, 5, v14
    v_add_u32 v15, v12, v15
    v_add_u32 v153, 117504, v15
    v_xor_b32 v15, 2, v11
    v_lshl_add_u32 v15, v15, 5, v14
    v_add_u32 v15, v12, v15
    v_add_u32 v154, 117504, v15
    v_xor_b32 v15, 3, v11
    v_lshl_add_u32 v15, v15, 5, v14
    v_add_u32 v15, v12, v15
    v_add_u32 v155, 117504, v15
    s_waitcnt vmcnt(16)
    v_lshlrev_b32 v148, 16, v64
    v_and_b32 v149, 0xffff0000, v64
    v_mul_f32 v150, 0xbfb8aa3b, v148
    v_mul_f32 v151, 0xbfb8aa3b, v149
    v_exp_f32 v150, v150
    v_exp_f32 v151, v151
    v_add_f32 v150, 1.0, v150
    v_add_f32 v151, 1.0, v151
    v_rcp_f32 v150, v150
    v_rcp_f32 v151, v151
    v_mul_f32 v150, v148, v150
    v_mul_f32 v151, v149, v151
    v_cvt_pk_bf16_f32 v148, v150, v151
    v_lshlrev_b32 v10, 2, v1
    ds_write_b32 v10, v148 offset:128
    s_waitcnt vmcnt(0) lgkmcnt(0)
    ds_read_b128 v[132:135], v156 offset:128
    ds_read_b128 v[136:139], v156 offset:192
    ds_read_b128 v[140:143], v156 offset:256
    ds_read_b128 v[144:147], v156 offset:320
    ds_read_b64_tr_b16 v[68:69], v152 offset:0
    ds_read_b64_tr_b16 v[70:71], v152 offset:512
    ds_read_b64_tr_b16 v[72:73], v153 offset:0
    ds_read_b64_tr_b16 v[74:75], v153 offset:512
    ds_read_b64_tr_b16 v[76:77], v154 offset:0
    ds_read_b64_tr_b16 v[78:79], v154 offset:512
    ds_read_b64_tr_b16 v[80:81], v155 offset:0
    ds_read_b64_tr_b16 v[82:83], v155 offset:512
    ds_read_b64_tr_b16 v[84:85], v152 offset:4096
    ds_read_b64_tr_b16 v[86:87], v152 offset:4608
    ds_read_b64_tr_b16 v[88:89], v153 offset:4096
    ds_read_b64_tr_b16 v[90:91], v153 offset:4608
    ds_read_b64_tr_b16 v[92:93], v154 offset:4096
    ds_read_b64_tr_b16 v[94:95], v154 offset:4608
    ds_read_b64_tr_b16 v[96:97], v155 offset:4096
    ds_read_b64_tr_b16 v[98:99], v155 offset:4608
    s_waitcnt lgkmcnt(8)
    v_mfma_f32_16x16x32_bf16 v[16:19], v[132:135], v[68:71], 0
    v_mfma_f32_16x16x32_bf16 v[20:23], v[132:135], v[72:75], 0
    v_mfma_f32_16x16x32_bf16 v[24:27], v[132:135], v[76:79], 0
    v_mfma_f32_16x16x32_bf16 v[28:31], v[132:135], v[80:83], 0
    ds_read_b64_tr_b16 v[100:101], v152 offset:8192
    ds_read_b64_tr_b16 v[102:103], v152 offset:8704
    ds_read_b64_tr_b16 v[104:105], v153 offset:8192
    ds_read_b64_tr_b16 v[106:107], v153 offset:8704
    ds_read_b64_tr_b16 v[108:109], v154 offset:8192
    ds_read_b64_tr_b16 v[110:111], v154 offset:8704
    ds_read_b64_tr_b16 v[112:113], v155 offset:8192
    ds_read_b64_tr_b16 v[114:115], v155 offset:8704
    s_waitcnt lgkmcnt(8)
    v_mfma_f32_16x16x32_bf16 v[16:19], v[136:139], v[84:87], v[16:19]
    v_mfma_f32_16x16x32_bf16 v[20:23], v[136:139], v[88:91], v[20:23]
    v_mfma_f32_16x16x32_bf16 v[24:27], v[136:139], v[92:95], v[24:27]
    v_mfma_f32_16x16x32_bf16 v[28:31], v[136:139], v[96:99], v[28:31]
    ds_read_b64_tr_b16 v[116:117], v152 offset:12288
    ds_read_b64_tr_b16 v[118:119], v152 offset:12800
    ds_read_b64_tr_b16 v[120:121], v153 offset:12288
    ds_read_b64_tr_b16 v[122:123], v153 offset:12800
    ds_read_b64_tr_b16 v[124:125], v154 offset:12288
    ds_read_b64_tr_b16 v[126:127], v154 offset:12800
    ds_read_b64_tr_b16 v[128:129], v155 offset:12288
    ds_read_b64_tr_b16 v[130:131], v155 offset:12800
    s_waitcnt lgkmcnt(8)
    v_mfma_f32_16x16x32_bf16 v[16:19], v[140:143], v[100:103], v[16:19]
    v_mfma_f32_16x16x32_bf16 v[20:23], v[140:143], v[104:107], v[20:23]
    v_mfma_f32_16x16x32_bf16 v[24:27], v[140:143], v[108:111], v[24:27]
    v_mfma_f32_16x16x32_bf16 v[28:31], v[140:143], v[112:115], v[28:31]
    s_waitcnt lgkmcnt(0)
    v_mfma_f32_16x16x32_bf16 v[16:19], v[144:147], v[116:119], v[16:19]
    v_mfma_f32_16x16x32_bf16 v[20:23], v[144:147], v[120:123], v[20:23]
    v_mfma_f32_16x16x32_bf16 v[24:27], v[144:147], v[124:127], v[24:27]
    v_mfma_f32_16x16x32_bf16 v[28:31], v[144:147], v[128:131], v[28:31]
    v_lshrrev_b32 v10, 4, v1
    v_lshlrev_b32 v11, 3, v1
    s_mul_i32 s64, s62, 24576
    s_lshl_b32 s65, s63, 9
    s_add_u32 s64, s64, s65
    s_add_u32 s64, s64, 32768
    v_mov_b32 v13, s59
    v_cmp_eq_u32 vcc, 1, v10
    s_nop 1
    v_cndmask_b32 v12, v16, v20, vcc
    v_cmp_eq_u32 vcc, 2, v10
    s_nop 1
    v_cndmask_b32 v12, v12, v24, vcc
    v_cmp_eq_u32 vcc, 3, v10
    s_nop 1
    v_cndmask_b32 v12, v12, v28, vcc
    buffer_store_dwordx2 v[12:13], v11, s[48:51], s64 offen sc1
    s_setprio 0
    s_lshl_b32 s52, s41, 13
    s_lshl_b32 s53, s42, 12
    s_add_u32 s52, s52, s53
    s_add_u32 s52, s52, 1048576
    s_add_u32 s53, s53, 4096
    v_min_u32 v6, 7, v1
    v_and_b32 v8, 3, v6
    v_mul_u32_u24 v8, 24576, v8
    v_lshrrev_b32 v6, 2, v6
    v_lshl_add_u32 v6, v6, 12, v8
    s_lshl_b32 s54, s41, 3
    s_add_u32 s54, s54, 32768
    v_lshlrev_b32 v7, 2, v1
    s_lshl_b32 s55, s42, 10
    v_add_u32 v7, s55, v7
    s_mov_b32 s36, 0x05040100
    s_mov_b32 s37, 0x07060302
    v_mov_b32 v10, 48
    s_mov_b32 s61, 0
L_lw_gd:
    ds_read_b32 v11, v10
    s_waitcnt lgkmcnt(0)
    v_readfirstlane_b32 s60, v11
    s_add_u32 s61, s61, 1
    s_cmp_ge_u32 s60, 4
    s_cbranch_scc1 L_lx_gd
    s_sleep 2
    s_cmp_lt_u32 s61, 64000
    s_cbranch_scc1 L_lw_gd
L_lx_gd:
    s_mov_b32 s57, 511
    s_mov_b32 s58, 0
L_pe_hd:
    s_bitcmp1_b32 s57, 0
    s_cbranch_scc0 L_pe_hd_0
    buffer_load_dwordx4 v[16:19], v4, s[48:51], s52 offen offset:0 sc1
L_pe_hd_0:
    s_bitcmp1_b32 s57, 1
    s_cbranch_scc0 L_pe_hd_1
    buffer_load_dwordx4 v[20:23], v4, s[48:51], s52 offen offset:1024 sc1
L_pe_hd_1:
    s_bitcmp1_b32 s57, 2
    s_cbranch_scc0 L_pe_hd_2
    buffer_load_dwordx4 v[24:27], v4, s[48:51], s52 offen offset:2048 sc1
L_pe_hd_2:
    s_bitcmp1_b32 s57, 3
    s_cbranch_scc0 L_pe_hd_3
    buffer_load_dwordx4 v[28:31], v4, s[48:51], s52 offen offset:3072 sc1
L_pe_hd_3:
    s_bitcmp1_b32 s57, 4
    s_cbranch_scc0 L_pe_hd_4
    buffer_load_dwordx4 v[32:35], v4, s[48:51], s53 offen offset:0 sc1
L_pe_hd_4:
    s_bitcmp1_b32 s57, 5
    s_cbranch_scc0 L_pe_hd_5
    buffer_load_dwordx4 v[36:39], v4, s[48:51], s53 offen offset:1024 sc1
L_pe_hd_5:
    s_bitcmp1_b32 s57, 6
    s_cbranch_scc0 L_pe_hd_6
    buffer_load_dwordx4 v[40:43], v4, s[48:51], s53 offen offset:2048 sc1
L_pe_hd_6:
    s_bitcmp1_b32 s57, 7
    s_cbranch_scc0 L_pe_hd_7
    buffer_load_dwordx4 v[44:47], v4, s[48:51], s53 offen offset:3072 sc1
L_pe_hd_7:
    s_bitcmp1_b32 s57, 8
    s_cbranch_scc0 L_pe_hd_8
    buffer_load_dwordx4 v[48:51], v6, s[48:51], s54 offen sc1
L_pe_hd_8:
    s_waitcnt vmcnt(0)
    s_mov_b32 s57, 0
    v_sad_u32 v52, v17, s59, 0
    v_sad_u32 v53, v19, s59, 0
    v_sad_u32 v52, v21, s59, v52
    v_sad_u32 v53, v23, s59, v53
    v_sad_u32 v52, v25, s59, v52
    v_sad_u32 v53, v27, s59, v53
    v_sad_u32 v52, v29, s59, v52
    v_sad_u32 v53, v31, s59, v53
    v_sad_u32 v52, v33, s59, v52
    v_sad_u32 v53, v35, s59, v53
    v_sad_u32 v52, v37, s59, v52
    v_sad_u32 v53, v39, s59, v53
    v_sad_u32 v52, v41, s59, v52
    v_sad_u32 v53, v43, s59, v53
    v_sad_u32 v52, v45, s59, v52
    v_sad_u32 v53, v47, s59, v53
    v_sad_u32 v52, v49, s59, v52
    v_sad_u32 v53, v51, s59, v53
    v_or_b32 v52, v52, v53
    v_cmp_ne_u32 vcc, 0, v52
    s_cmp_eq_u64 vcc, 0
    s_cbranch_scc1 L_ps_hd
    v_sad_u32 v52, v17, s59, 0
    v_sad_u32 v52, v19, s59, v52
    v_cmp_ne_u32 vcc, 0, v52
    s_cmp_lg_u64 vcc, 0
    s_cselect_b32 s56, 1, 0
    s_or_b32 s57, s57, s56
    v_sad_u32 v53, v21, s59, 0
    v_sad_u32 v53, v23, s59, v53
    v_cmp_ne_u32 vcc, 0, v53
    s_cmp_lg_u64 vcc, 0
    s_cselect_b32 s56, 2, 0
    s_or_b32 s57, s57, s56
    v_sad_u32 v52, v25, s59, 0
    v_sad_u32 v52, v27, s59, v52
    v_cmp_ne_u32 vcc, 0, v52
    s_cmp_lg_u64 vcc, 0
    s_cselect_b32 s56, 4, 0
    s_or_b32 s57, s57, s56
    v_sad_u32 v53, v29, s59, 0
    v_sad_u32 v53, v31, s59, v53
    v_cmp_ne_u32 vcc, 0, v53
    s_cmp_lg_u64 vcc, 0
    s_cselect_b32 s56, 8, 0
    s_or_b32 s57, s57, s56
    v_sad_u32 v52, v33, s59, 0
    v_sad_u32 v52, v35, s59, v52
    v_cmp_ne_u32 vcc, 0, v52
    s_cmp_lg_u64 vcc, 0
    s_cselect_b32 s56, 16, 0
    s_or_b32 s57, s57, s56
    v_sad_u32 v53, v37, s59, 0
    v_sad_u32 v53, v39, s59, v53
    v_cmp_ne_u32 vcc, 0, v53
    s_cmp_lg_u64 vcc, 0
    s_cselect_b32 s56, 32, 0
    s_or_b32 s57, s57, s56
    v_sad_u32 v52, v41, s59, 0
    v_sad_u32 v52, v43, s59, v52
    v_cmp_ne_u32 vcc, 0, v52
    s_cmp_lg_u64 vcc, 0
    s_cselect_b32 s56, 64, 0
    s_or_b32 s57, s57, s56
    v_sad_u32 v53, v45, s59, 0
    v_sad_u32 v53, v47, s59, v53
    v_cmp_ne_u32 vcc, 0, v53
    s_cmp_lg_u64 vcc, 0
    s_cselect_b32 s56, 128, 0
    s_or_b32 s57, s57, s56
    v_sad_u32 v52, v49, s59, 0
    v_sad_u32 v52, v51, s59, v52
    v_cmp_ne_u32 vcc, 0, v52
    s_cmp_lg_u64 vcc, 0
    s_cselect_b32 s56, 256, 0
    s_or_b32 s57, s57, s56
    s_cmp_eq_u32 s57, 0
    s_cbranch_scc1 L_ps_hd
    s_sleep 4
    s_add_u32 s58, s58, 1
    s_cmp_lt_u32 s58, 8000
    s_cbranch_scc1 L_pe_hd
L_ps_hd:
    v_mov_b32 v10, 72
    v_mov_b32 v11, 1
    s_mov_b64 exec, 1
    ds_add_u32 v10, v11
    s_mov_b64 exec, -1
    v_add_f32_dpp v48, v48, v48 quad_perm:[1,0,3,2] row_mask:0xf bank_mask:0xf
    v_add_f32_dpp v50, v50, v50 quad_perm:[1,0,3,2] row_mask:0xf bank_mask:0xf
    s_nop 0
    v_add_f32_dpp v48, v48, v48 quad_perm:[2,3,0,1] row_mask:0xf bank_mask:0xf
    v_add_f32_dpp v50, v50, v50 quad_perm:[2,3,0,1] row_mask:0xf bank_mask:0xf
    v_cvt_pk_bf16_f32 v49, v48, v50
    v_lshlrev_b32 v48, 16, v49
    v_and_b32 v50, 0xffff0000, v49
    v_mov_b32 v49, v50
    v_readlane_b32 s60, v48, 0
    v_readlane_b32 s61, v49, 0
    v_readlane_b32 s64, v48, 4
    v_readlane_b32 s65, v49, 4
    v_mov_b32 v72, s60
    v_mov_b32 v73, s61
    v_add_f32 v74, 1.0, s64
    v_add_f32 v75, 1.0, s65
    v_cvt_pk_bf16_f32 v76, v74, v75
    v_lshlrev_b32 v74, 16, v76
    v_and_b32 v75, 0xffff0000, v76
    v_and_b32 v57, 0xffff0000, v32
    v_lshlrev_b32 v56, 16, v32
    v_rcp_f32 v57, v57
    v_lshlrev_b32 v60, 16, v16
    v_and_b32 v61, 0xffff0000, v16
    v_and_b32 v59, 0xffff0000, v34
    v_lshlrev_b32 v58, 16, v34
    v_rcp_f32 v59, v59
    v_lshlrev_b32 v62, 16, v18
    v_and_b32 v63, 0xffff0000, v18
    v_pk_add_f32 v[60:61], v[60:61], v[56:57] op_sel_hi:[1,0]
    v_pk_add_f32 v[62:63], v[62:63], v[58:59] op_sel_hi:[1,0]
    v_pk_mul_f32 v[60:61], v[60:61], v[56:57] op_sel:[0,1] op_sel_hi:[1,1]
    v_pk_mul_f32 v[62:63], v[62:63], v[58:59] op_sel:[0,1] op_sel_hi:[1,1]
    v_pk_fma_f32 v[60:61], v[60:61], v[74:75], v[72:73]
    v_pk_fma_f32 v[62:63], v[62:63], v[74:75], v[72:73]
    v_cvt_pk_bf16_f32 v64, v60, v62
    v_cvt_pk_bf16_f32 v65, v61, v63
    v_perm_b32 v66, v18, v16, s36
    v_perm_b32 v67, v18, v16, s37
    ds_write2st64_b32 v7, v64, v65 offset0:134 offset1:152
    ds_write2st64_b32 v7, v66, v67 offset0:168 offset1:184
    v_and_b32 v57, 0xffff0000, v36
    v_lshlrev_b32 v56, 16, v36
    v_rcp_f32 v57, v57
    v_lshlrev_b32 v60, 16, v20
    v_and_b32 v61, 0xffff0000, v20
    v_and_b32 v59, 0xffff0000, v38
    v_lshlrev_b32 v58, 16, v38
    v_rcp_f32 v59, v59
    v_lshlrev_b32 v62, 16, v22
    v_and_b32 v63, 0xffff0000, v22
    v_pk_add_f32 v[60:61], v[60:61], v[56:57] op_sel_hi:[1,0]
    v_pk_add_f32 v[62:63], v[62:63], v[58:59] op_sel_hi:[1,0]
    v_pk_mul_f32 v[60:61], v[60:61], v[56:57] op_sel:[0,1] op_sel_hi:[1,1]
    v_pk_mul_f32 v[62:63], v[62:63], v[58:59] op_sel:[0,1] op_sel_hi:[1,1]
    v_pk_fma_f32 v[60:61], v[60:61], v[74:75], v[72:73]
    v_pk_fma_f32 v[62:63], v[62:63], v[74:75], v[72:73]
    v_cvt_pk_bf16_f32 v68, v60, v62
    v_cvt_pk_bf16_f32 v69, v61, v63
    v_perm_b32 v70, v22, v20, s36
    v_perm_b32 v71, v22, v20, s37
    ds_write2st64_b32 v7, v68, v69 offset0:135 offset1:153
    ds_write2st64_b32 v7, v70, v71 offset0:169 offset1:185
    v_and_b32 v57, 0xffff0000, v40
    v_lshlrev_b32 v56, 16, v40
    v_rcp_f32 v57, v57
    v_lshlrev_b32 v60, 16, v24
    v_and_b32 v61, 0xffff0000, v24
    v_and_b32 v59, 0xffff0000, v42
    v_lshlrev_b32 v58, 16, v42
    v_rcp_f32 v59, v59
    v_lshlrev_b32 v62, 16, v26
    v_and_b32 v63, 0xffff0000, v26
    v_pk_add_f32 v[60:61], v[60:61], v[56:57] op_sel_hi:[1,0]
    v_pk_add_f32 v[62:63], v[62:63], v[58:59] op_sel_hi:[1,0]
    v_pk_mul_f32 v[60:61], v[60:61], v[56:57] op_sel:[0,1] op_sel_hi:[1,1]
    v_pk_mul_f32 v[62:63], v[62:63], v[58:59] op_sel:[0,1] op_sel_hi:[1,1]
    v_pk_fma_f32 v[60:61], v[60:61], v[74:75], v[72:73]
    v_pk_fma_f32 v[62:63], v[62:63], v[74:75], v[72:73]
    v_cvt_pk_bf16_f32 v64, v60, v62
    v_cvt_pk_bf16_f32 v65, v61, v63
    v_perm_b32 v66, v26, v24, s36
    v_perm_b32 v67, v26, v24, s37
    ds_write2st64_b32 v7, v64, v65 offset0:136 offset1:154
    ds_write2st64_b32 v7, v66, v67 offset0:170 offset1:186
    v_and_b32 v57, 0xffff0000, v44
    v_lshlrev_b32 v56, 16, v44
    v_rcp_f32 v57, v57
    v_lshlrev_b32 v60, 16, v28
    v_and_b32 v61, 0xffff0000, v28
    v_and_b32 v59, 0xffff0000, v46
    v_lshlrev_b32 v58, 16, v46
    v_rcp_f32 v59, v59
    v_lshlrev_b32 v62, 16, v30
    v_and_b32 v63, 0xffff0000, v30
    v_pk_add_f32 v[60:61], v[60:61], v[56:57] op_sel_hi:[1,0]
    v_pk_add_f32 v[62:63], v[62:63], v[58:59] op_sel_hi:[1,0]
    v_pk_mul_f32 v[60:61], v[60:61], v[56:57] op_sel:[0,1] op_sel_hi:[1,1]
    v_pk_mul_f32 v[62:63], v[62:63], v[58:59] op_sel:[0,1] op_sel_hi:[1,1]
    v_pk_fma_f32 v[60:61], v[60:61], v[74:75], v[72:73]
    v_pk_fma_f32 v[62:63], v[62:63], v[74:75], v[72:73]
    v_cvt_pk_bf16_f32 v68, v60, v62
    v_cvt_pk_bf16_f32 v69, v61, v63
    v_perm_b32 v70, v30, v28, s36
    v_perm_b32 v71, v30, v28, s37
    ds_write2st64_b32 v7, v68, v69 offset0:137 offset1:155
    ds_write2st64_b32 v7, v70, v71 offset0:171 offset1:187
    s_waitcnt lgkmcnt(0)
    s_barrier
    s_branch L_k12_end
L_help_n:
    v_lshrrev_b32 v6, 2, v1
    v_and_b32 v7, 3, v1
    v_lshlrev_b32 v3, 11, v7
    v_lshl_add_u32 v3, v6, 2, v3
    v_lshlrev_b32 v4, 4, v1
    s_lshl_b32 s52, s2, 13
    s_lshl_b32 s53, s42, 8
    s_add_u32 s53, s53, s52
    s_waitcnt lgkmcnt(0)
    s_mov_b32 s44, s4
    s_and_b32 s45, s5, 0xffff
    s_mov_b32 s46, 0x200000
    s_mov_b32 s47, 0x00020000
    buffer_load_dword v16, v3, s[44:47], s53 offen offset:0
    buffer_load_dword v18, v3, s[44:47], s53 offen offset:1024
    buffer_load_dword v20, v3, s[44:47], s53 offen offset:64
    buffer_load_dword v22, v3, s[44:47], s53 offen offset:1088
    buffer_load_dword v24, v3, s[44:47], s53 offen offset:128
    buffer_load_dword v26, v3, s[44:47], s53 offen offset:1152
    buffer_load_dword v28, v3, s[44:47], s53 offen offset:192
    buffer_load_dword v30, v3, s[44:47], s53 offen offset:1216
    s_mov_b32 s58, 16777216
    s_load_dword s59, s[34:35], s58
    s_barrier
    s_add_u32 s48, s34, 0x1000000
    s_addc_u32 s49, s35, 0
    s_and_b32 s49, s49, 0xffff
    s_mov_b32 s50, 0x500000
    s_mov_b32 s51, 0x00020000
    s_setprio 2
    v_lshlrev_b32 v5, 14, v6
    v_lshl_add_u32 v5, v7, 4, v5
    s_lshl_b32 s52, s42, 20
    s_lshl_b32 s53, s2, 6
    s_add_u32 s52, s52, s53
    s_add_u32 s52, s52, 1048576
    v_mov_b32 v60, 0
    v_mov_b32 v61, 0
    v_mov_b32 v62, 0
    v_mov_b32 v63, 0
    v_lshrrev_b32 v10, 4, v1
    v_mul_u32_u24 v10, 16640, v10
    v_bfe_u32 v11, v1, 2, 2
    v_mul_u32_u24 v11, 4160, v11
    v_add_u32 v10, v10, v11
    v_and_b32 v11, 3, v1
    v_lshl_add_u32 v10, v11, 4, v10
    s_mov_b32 exec_hi, 0
    ds_write_b128 v10, v[60:63] offset:4608
    s_mov_b64 exec, -1
    v_lshrrev_b32 v10, 5, v1
    v_mul_u32_u24 v10, 4608, v10
    v_and_b32 v11, 31, v1
    v_lshl_add_u32 v10, v11, 4, v10
    ds_write_b128 v10, v[60:63] offset:33792
    s_waitcnt lgkmcnt(0)
    s_add_u32 s59, s59, 1
    v_mov_b32 v17, s59
    v_mov_b32 v19, s59
    v_mov_b32 v21, s59
    v_mov_b32 v23, s59
    v_mov_b32 v25, s59
    v_mov_b32 v27, s59
    v_mov_b32 v29, s59
    v_mov_b32 v31, s59
    v_mov_b32 v10, 0
    v_mov_b32 v11, s59
    ds_write_b32 v10, v11
    v_mov_b32 v10, 163328
    ds_write_b32 v10, v11
    s_waitcnt vmcnt(0)
    buffer_store_dwordx4 v[16:19], v5, s[48:51], s52 offen sc1
    s_add_u32 s52, s52, 262144
    buffer_store_dwordx4 v[20:23], v5, s[48:51], s52 offen sc1
    s_add_u32 s52, s52, 262144
    buffer_store_dwordx4 v[24:27], v5, s[48:51], s52 offen sc1
    s_add_u32 s52, s52, 262144
    buffer_store_dwordx4 v[28:31], v5, s[48:51], s52 offen sc1
    s_setprio 0
    s_lshl_b32 s52, s41, 13
    s_lshl_b32 s53, s42, 12
    s_add_u32 s52, s52, s53
    s_add_u32 s52, s52, 1048576
    s_add_u32 s53, s53, 4096
    v_min_u32 v6, 7, v1
    v_and_b32 v8, 3, v6
    v_mul_u32_u24 v8, 24576, v8
    v_lshrrev_b32 v6, 2, v6
    v_lshl_add_u32 v6, v6, 12, v8
    s_lshl_b32 s54, s41, 3
    s_add_u32 s54, s54, 32768
    v_lshlrev_b32 v7, 2, v1
    s_lshl_b32 s55, s42, 10
    v_add_u32 v7, s55, v7
    s_mov_b32 s36, 0x05040100
    s_mov_b32 s37, 0x07060302
    v_mov_b32 v10, 48
    s_mov_b32 s61, 0
L_lw_gn:
    ds_read_b32 v11, v10
    s_waitcnt lgkmcnt(0)
    v_readfirstlane_b32 s60, v11
    s_add_u32 s61, s61, 1
    s_cmp_ge_u32 s60, 4
    s_cbranch_scc1 L_lx_gn
    s_sleep 2
    s_cmp_lt_u32 s61, 64000
    s_cbranch_scc1 L_lw_gn
L_lx_gn:
    s_mov_b32 s57, 511
    s_mov_b32 s58, 0
L_pe_hn:
    s_bitcmp1_b32 s57, 0
    s_cbranch_scc0 L_pe_hn_0
    buffer_load_dwordx4 v[16:19], v4, s[48:51], s52 offen offset:0 sc1
L_pe_hn_0:
    s_bitcmp1_b32 s57, 1
    s_cbranch_scc0 L_pe_hn_1
    buffer_load_dwordx4 v[20:23], v4, s[48:51], s52 offen offset:1024 sc1
L_pe_hn_1:
    s_bitcmp1_b32 s57, 2
    s_cbranch_scc0 L_pe_hn_2
    buffer_load_dwordx4 v[24:27], v4, s[48:51], s52 offen offset:2048 sc1
L_pe_hn_2:
    s_bitcmp1_b32 s57, 3
    s_cbranch_scc0 L_pe_hn_3
    buffer_load_dwordx4 v[28:31], v4, s[48:51], s52 offen offset:3072 sc1
L_pe_hn_3:
    s_bitcmp1_b32 s57, 4
    s_cbranch_scc0 L_pe_hn_4
    buffer_load_dwordx4 v[32:35], v4, s[48:51], s53 offen offset:0 sc1
L_pe_hn_4:
    s_bitcmp1_b32 s57, 5
    s_cbranch_scc0 L_pe_hn_5
    buffer_load_dwordx4 v[36:39], v4, s[48:51], s53 offen offset:1024 sc1
L_pe_hn_5:
    s_bitcmp1_b32 s57, 6
    s_cbranch_scc0 L_pe_hn_6
    buffer_load_dwordx4 v[40:43], v4, s[48:51], s53 offen offset:2048 sc1
L_pe_hn_6:
    s_bitcmp1_b32 s57, 7
    s_cbranch_scc0 L_pe_hn_7
    buffer_load_dwordx4 v[44:47], v4, s[48:51], s53 offen offset:3072 sc1
L_pe_hn_7:
    s_bitcmp1_b32 s57, 8
    s_cbranch_scc0 L_pe_hn_8
    buffer_load_dwordx4 v[48:51], v6, s[48:51], s54 offen sc1
L_pe_hn_8:
    s_waitcnt vmcnt(0)
    s_mov_b32 s57, 0
    v_sad_u32 v52, v17, s59, 0
    v_sad_u32 v53, v19, s59, 0
    v_sad_u32 v52, v21, s59, v52
    v_sad_u32 v53, v23, s59, v53
    v_sad_u32 v52, v25, s59, v52
    v_sad_u32 v53, v27, s59, v53
    v_sad_u32 v52, v29, s59, v52
    v_sad_u32 v53, v31, s59, v53
    v_sad_u32 v52, v33, s59, v52
    v_sad_u32 v53, v35, s59, v53
    v_sad_u32 v52, v37, s59, v52
    v_sad_u32 v53, v39, s59, v53
    v_sad_u32 v52, v41, s59, v52
    v_sad_u32 v53, v43, s59, v53
    v_sad_u32 v52, v45, s59, v52
    v_sad_u32 v53, v47, s59, v53
    v_sad_u32 v52, v49, s59, v52
    v_sad_u32 v53, v51, s59, v53
    v_or_b32 v52, v52, v53
    v_cmp_ne_u32 vcc, 0, v52
    s_cmp_eq_u64 vcc, 0
    s_cbranch_scc1 L_ps_hn
    v_sad_u32 v52, v17, s59, 0
    v_sad_u32 v52, v19, s59, v52
    v_cmp_ne_u32 vcc, 0, v52
    s_cmp_lg_u64 vcc, 0
    s_cselect_b32 s56, 1, 0
    s_or_b32 s57, s57, s56
    v_sad_u32 v53, v21, s59, 0
    v_sad_u32 v53, v23, s59, v53
    v_cmp_ne_u32 vcc, 0, v53
    s_cmp_lg_u64 vcc, 0
    s_cselect_b32 s56, 2, 0
    s_or_b32 s57, s57, s56
    v_sad_u32 v52, v25, s59, 0
    v_sad_u32 v52, v27, s59, v52
    v_cmp_ne_u32 vcc, 0, v52
    s_cmp_lg_u64 vcc, 0
    s_cselect_b32 s56, 4, 0
    s_or_b32 s57, s57, s56
    v_sad_u32 v53, v29, s59, 0
    v_sad_u32 v53, v31, s59, v53
    v_cmp_ne_u32 vcc, 0, v53
    s_cmp_lg_u64 vcc, 0
    s_cselect_b32 s56, 8, 0
    s_or_b32 s57, s57, s56
    v_sad_u32 v52, v33, s59, 0
    v_sad_u32 v52, v35, s59, v52
    v_cmp_ne_u32 vcc, 0, v52
    s_cmp_lg_u64 vcc, 0
    s_cselect_b32 s56, 16, 0
    s_or_b32 s57, s57, s56
    v_sad_u32 v53, v37, s59, 0
    v_sad_u32 v53, v39, s59, v53
    v_cmp_ne_u32 vcc, 0, v53
    s_cmp_lg_u64 vcc, 0
    s_cselect_b32 s56, 32, 0
    s_or_b32 s57, s57, s56
    v_sad_u32 v52, v41, s59, 0
    v_sad_u32 v52, v43, s59, v52
    v_cmp_ne_u32 vcc, 0, v52
    s_cmp_lg_u64 vcc, 0
    s_cselect_b32 s56, 64, 0
    s_or_b32 s57, s57, s56
    v_sad_u32 v53, v45, s59, 0
    v_sad_u32 v53, v47, s59, v53
    v_cmp_ne_u32 vcc, 0, v53
    s_cmp_lg_u64 vcc, 0
    s_cselect_b32 s56, 128, 0
    s_or_b32 s57, s57, s56
    v_sad_u32 v52, v49, s59, 0
    v_sad_u32 v52, v51, s59, v52
    v_cmp_ne_u32 vcc, 0, v52
    s_cmp_lg_u64 vcc, 0
    s_cselect_b32 s56, 256, 0
    s_or_b32 s57, s57, s56
    s_cmp_eq_u32 s57, 0
    s_cbranch_scc1 L_ps_hn
    s_sleep 4
    s_add_u32 s58, s58, 1
    s_cmp_lt_u32 s58, 8000
    s_cbranch_scc1 L_pe_hn
L_ps_hn:
    v_mov_b32 v10, 72
    v_mov_b32 v11, 1
    s_mov_b64 exec, 1
    ds_add_u32 v10, v11
    s_mov_b64 exec, -1
    v_add_f32_dpp v48, v48, v48 quad_perm:[1,0,3,2] row_mask:0xf bank_mask:0xf
    v_add_f32_dpp v50, v50, v50 quad_perm:[1,0,3,2] row_mask:0xf bank_mask:0xf
    s_nop 0
    v_add_f32_dpp v48, v48, v48 quad_perm:[2,3,0,1] row_mask:0xf bank_mask:0xf
    v_add_f32_dpp v50, v50, v50 quad_perm:[2,3,0,1] row_mask:0xf bank_mask:0xf
    v_cvt_pk_bf16_f32 v49, v48, v50
    v_lshlrev_b32 v48, 16, v49
    v_and_b32 v50, 0xffff0000, v49
    v_mov_b32 v49, v50
    v_readlane_b32 s60, v48, 0
    v_readlane_b32 s61, v49, 0
    v_readlane_b32 s64, v48, 4
    v_readlane_b32 s65, v49, 4
    v_mov_b32 v72, s60
    v_mov_b32 v73, s61
    v_add_f32 v74, 1.0, s64
    v_add_f32 v75, 1.0, s65
    v_cvt_pk_bf16_f32 v76, v74, v75
    v_lshlrev_b32 v74, 16, v76
    v_and_b32 v75, 0xffff0000, v76
    v_and_b32 v57, 0xffff0000, v32
    v_lshlrev_b32 v56, 16, v32
    v_rcp_f32 v57, v57
    v_lshlrev_b32 v60, 16, v16
    v_and_b32 v61, 0xffff0000, v16
    v_and_b32 v59, 0xffff0000, v34
    v_lshlrev_b32 v58, 16, v34
    v_rcp_f32 v59, v59
    v_lshlrev_b32 v62, 16, v18
    v_and_b32 v63, 0xffff0000, v18
    v_pk_add_f32 v[60:61], v[60:61], v[56:57] op_sel_hi:[1,0]
    v_pk_add_f32 v[62:63], v[62:63], v[58:59] op_sel_hi:[1,0]
    v_pk_mul_f32 v[60:61], v[60:61], v[56:57] op_sel:[0,1] op_sel_hi:[1,1]
    v_pk_mul_f32 v[62:63], v[62:63], v[58:59] op_sel:[0,1] op_sel_hi:[1,1]
    v_pk_fma_f32 v[60:61], v[60:61], v[74:75], v[72:73]
    v_pk_fma_f32 v[62:63], v[62:63], v[74:75], v[72:73]
    v_cvt_pk_bf16_f32 v64, v60, v62
    v_cvt_pk_bf16_f32 v65, v61, v63
    v_perm_b32 v66, v18, v16, s36
    v_perm_b32 v67, v18, v16, s37
    ds_write2st64_b32 v7, v64, v65 offset0:134 offset1:152
    ds_write2st64_b32 v7, v66, v67 offset0:168 offset1:184
    v_and_b32 v57, 0xffff0000, v36
    v_lshlrev_b32 v56, 16, v36
    v_rcp_f32 v57, v57
    v_lshlrev_b32 v60, 16, v20
    v_and_b32 v61, 0xffff0000, v20
    v_and_b32 v59, 0xffff0000, v38
    v_lshlrev_b32 v58, 16, v38
    v_rcp_f32 v59, v59
    v_lshlrev_b32 v62, 16, v22
    v_and_b32 v63, 0xffff0000, v22
    v_pk_add_f32 v[60:61], v[60:61], v[56:57] op_sel_hi:[1,0]
    v_pk_add_f32 v[62:63], v[62:63], v[58:59] op_sel_hi:[1,0]
    v_pk_mul_f32 v[60:61], v[60:61], v[56:57] op_sel:[0,1] op_sel_hi:[1,1]
    v_pk_mul_f32 v[62:63], v[62:63], v[58:59] op_sel:[0,1] op_sel_hi:[1,1]
    v_pk_fma_f32 v[60:61], v[60:61], v[74:75], v[72:73]
    v_pk_fma_f32 v[62:63], v[62:63], v[74:75], v[72:73]
    v_cvt_pk_bf16_f32 v68, v60, v62
    v_cvt_pk_bf16_f32 v69, v61, v63
    v_perm_b32 v70, v22, v20, s36
    v_perm_b32 v71, v22, v20, s37
    ds_write2st64_b32 v7, v68, v69 offset0:135 offset1:153
    ds_write2st64_b32 v7, v70, v71 offset0:169 offset1:185
    v_and_b32 v57, 0xffff0000, v40
    v_lshlrev_b32 v56, 16, v40
    v_rcp_f32 v57, v57
    v_lshlrev_b32 v60, 16, v24
    v_and_b32 v61, 0xffff0000, v24
    v_and_b32 v59, 0xffff0000, v42
    v_lshlrev_b32 v58, 16, v42
    v_rcp_f32 v59, v59
    v_lshlrev_b32 v62, 16, v26
    v_and_b32 v63, 0xffff0000, v26
    v_pk_add_f32 v[60:61], v[60:61], v[56:57] op_sel_hi:[1,0]
    v_pk_add_f32 v[62:63], v[62:63], v[58:59] op_sel_hi:[1,0]
    v_pk_mul_f32 v[60:61], v[60:61], v[56:57] op_sel:[0,1] op_sel_hi:[1,1]
    v_pk_mul_f32 v[62:63], v[62:63], v[58:59] op_sel:[0,1] op_sel_hi:[1,1]
    v_pk_fma_f32 v[60:61], v[60:61], v[74:75], v[72:73]
    v_pk_fma_f32 v[62:63], v[62:63], v[74:75], v[72:73]
    v_cvt_pk_bf16_f32 v64, v60, v62
    v_cvt_pk_bf16_f32 v65, v61, v63
    v_perm_b32 v66, v26, v24, s36
    v_perm_b32 v67, v26, v24, s37
    ds_write2st64_b32 v7, v64, v65 offset0:136 offset1:154
    ds_write2st64_b32 v7, v66, v67 offset0:170 offset1:186
    v_and_b32 v57, 0xffff0000, v44
    v_lshlrev_b32 v56, 16, v44
    v_rcp_f32 v57, v57
    v_lshlrev_b32 v60, 16, v28
    v_and_b32 v61, 0xffff0000, v28
    v_and_b32 v59, 0xffff0000, v46
    v_lshlrev_b32 v58, 16, v46
    v_rcp_f32 v59, v59
    v_lshlrev_b32 v62, 16, v30
    v_and_b32 v63, 0xffff0000, v30
    v_pk_add_f32 v[60:61], v[60:61], v[56:57] op_sel_hi:[1,0]
    v_pk_add_f32 v[62:63], v[62:63], v[58:59] op_sel_hi:[1,0]
    v_pk_mul_f32 v[60:61], v[60:61], v[56:57] op_sel:[0,1] op_sel_hi:[1,1]
    v_pk_mul_f32 v[62:63], v[62:63], v[58:59] op_sel:[0,1] op_sel_hi:[1,1]
    v_pk_fma_f32 v[60:61], v[60:61], v[74:75], v[72:73]
    v_pk_fma_f32 v[62:63], v[62:63], v[74:75], v[72:73]
    v_cvt_pk_bf16_f32 v68, v60, v62
    v_cvt_pk_bf16_f32 v69, v61, v63
    v_perm_b32 v70, v30, v28, s36
    v_perm_b32 v71, v30, v28, s37
    ds_write2st64_b32 v7, v68, v69 offset0:137 offset1:155
    ds_write2st64_b32 v7, v70, v71 offset0:171 offset1:187
    s_waitcnt lgkmcnt(0)
    s_barrier
    s_cmp_eq_u32 s42, 0
    s_cbranch_scc0 L_hendn
    s_cmp_eq_u32 s2, 0
    s_cbranch_scc0 L_noepn
    v_mov_b32 v10, s59
    s_mov_b64 exec, 1
    buffer_store_dword v10, off, s[48:51], 0 sc1
    s_mov_b64 exec, -1
L_noepn:
    v_min_u32 v6, 15, v1
    v_and_b32 v8, 3, v6
    v_mul_u32_u24 v8, 24576, v8
    v_lshrrev_b32 v6, 2, v6
    v_lshl_add_u32 v6, v6, 12, v8
    s_add_u32 s54, s54, 8192
    s_mov_b32 s57, 1
    s_mov_b32 s58, 0
L_pe_m:
    s_bitcmp1_b32 s57, 0
    s_cbranch_scc0 L_pe_m_0
    buffer_load_dwordx4 v[48:51], v6, s[48:51], s54 offen sc1
L_pe_m_0:
    s_waitcnt vmcnt(0)
    s_mov_b32 s57, 0
    v_sad_u32 v52, v49, s59, 0
    v_sad_u32 v52, v51, s59, v52
    v_cmp_ne_u32 vcc, 0, v52
    s_cmp_lg_u64 vcc, 0
    s_cselect_b32 s56, 1, 0
    s_or_b32 s57, s57, s56
    s_cmp_eq_u32 s57, 0
    s_cbranch_scc1 L_ps_m
    s_sleep 8
    s_add_u32 s58, s58, 1
    s_cmp_lt_u32 s58, 8000
    s_cbranch_scc1 L_pe_m
L_ps_m:
    v_add_f32_dpp v48, v48, v48 quad_perm:[1,0,3,2] row_mask:0xf bank_mask:0xf
    v_add_f32_dpp v50, v50, v50 quad_perm:[1,0,3,2] row_mask:0xf bank_mask:0xf
    s_nop 0
    v_add_f32_dpp v48, v48, v48 quad_perm:[2,3,0,1] row_mask:0xf bank_mask:0xf
    v_add_f32_dpp v50, v50, v50 quad_perm:[2,3,0,1] row_mask:0xf bank_mask:0xf
    v_cvt_pk_bf16_f32 v49, v48, v50
    v_lshlrev_b32 v48, 16, v49
    v_and_b32 v50, 0xffff0000, v49
    v_mov_b32 v49, v50
    v_add_f32 v54, 1.0, v48
    v_add_f32 v55, 1.0, v49
    v_cvt_pk_bf16_f32 v56, v54, v55
    v_lshlrev_b32 v54, 16, v56
    v_and_b32 v55, 0xffff0000, v56
    v_cmp_eq_u32 vcc, 8, v1
    s_nop 1
    v_cndmask_b32 v54, v48, v54, vcc
    v_cndmask_b32 v55, v49, v55, vcc
    v_lshl_add_u32 v10, v1, 1, 8
    v_mov_b32 v11, 1
    s_mov_b64 exec, 0x101
    ds_write_b64 v10, v[54:55]
    s_mov_b64 exec, 1
    ds_write_b32 v10, v11 offset:8
    v_mov_b32 v10, 163384
    ds_write_b32 v10, v11
    s_mov_b64 exec, -1
    v_and_b32 v8, 3, v1
    v_lshlrev_b32 v8, 4, v8
    s_lshl_b32 s56, s41, 5
    s_add_u32 s56, s56, 65536
    v_add_u32 v8, s56, v8
    s_mov_b64 exec, 0xf000
    global_store_dwordx4 v8, v[48:51], s[34:35] sc1
    s_mov_b64 exec, -1
L_hendn:
    s_branch L_k12_end
L_kgen:
    s_cmp_eq_u32 s40, 0
    s_cbranch_scc0 L_nozero
    v_mov_b32 v4, 0
    v_mov_b32 v5, 0
    v_mov_b32 v6, 0
    v_mov_b32 v7, 0
    v_lshlrev_b32 v2, 4, v0
    s_mov_b64 exec, 0xff
    ds_write_b128 v2, v[4:7] offset:0
    v_add_u32 v3, 163328, v2
    s_mov_b64 exec, 0xf
    ds_write_b128 v3, v[4:7]
    s_mov_b64 exec, -1
L_nozero:
    v_and_b32 v0, 255, v0
    s_lshr_b32 s42, s40, 2
    s_add_u32 s43, s41, s42
    s_mul_i32 s44, s42, 24960
    s_add_u32 s44, s44, 67584
    v_and_b32 v1, 63, v0
    v_lshrrev_b32 v2, 6, v0
    v_and_b32 v3, 31, v0
    v_lshl_add_u32 v3, v2, 5, v3
    s_lshl_b32 s45, s43, 8
    v_lshlrev_b32 v4, 1, v3
    v_add_u32 v4, s45, v4
    v_mov_b32 v8, 0
    v_mov_b32 v9, 0
    v_mov_b32 v10, 0
    v_mov_b32 v11, 0
    s_lshr_b32 s46, s43, 1
    s_lshl_b32 s46, s46, 2
    s_waitcnt lgkmcnt(0)
    s_load_dword s47, s[14:15], s46
    s_load_dword s48, s[16:17], s46
    global_load_short_d16_hi v8, v4, s[6:7]
    global_load_short_d16_hi v9, v4, s[8:9]
    global_load_short_d16_hi v10, v4, s[10:11]
    global_load_short_d16_hi v11, v4, s[12:13]
    s_barrier
    v_and_b32 v5, 15, v1
    v_subrev_u32 v6, 8, v5
    v_lshlrev_b32 v6, 1, v6
    v_add_u32 v6, 256, v6
    v_cmp_gt_u32 vcc, 8, v5
    s_nop 1
    v_cndmask_b32 v6, v6, v5, vcc
    v_subrev_u32 v7, 12, v5
    v_and_b32 v12, 1, v7
    v_lshlrev_b32 v12, 2, v12
    v_lshrrev_b32 v7, 1, v7
    v_lshl_add_u32 v7, v7, 8, v12
    v_add_u32 v7, 512, v7
    v_cmp_gt_u32 vcc, 12, v5
    s_nop 1
    v_cndmask_b32 v6, v7, v6, vcc
    v_cvt_f32_u32 v12, v6
    v_lshlrev_b32 v14, 3, v5
    v_cvt_f32_u32 v14, v14
    v_mov_b32 v16, 0x43000000
    v_mov_b32 v17, 0x44800000
    v_cmp_gt_u32 vcc, 32, v1
    s_nop 1
    v_cndmask_b32 v16, v17, v16, vcc
    v_lshlrev_b32 v7, 3, v0
    v_sub_u32 v7, 2047, v7
    v_subrev_u32 v44, 0, v7
    v_subrev_u32 v45, 1, v7
    v_subrev_u32 v46, 2, v7
    v_subrev_u32 v47, 3, v7
    v_subrev_u32 v48, 4, v7
    v_subrev_u32 v49, 5, v7
    v_subrev_u32 v50, 6, v7
    v_subrev_u32 v51, 7, v7
    v_subrev_u32 v52, 8, v7
    v_subrev_u32 v53, 9, v7
    v_subrev_u32 v54, 10, v7
    v_max_i32 v52, 0, v52
    v_max_i32 v53, 0, v53
    v_max_i32 v54, 0, v54
    v_cvt_f32_u32 v44, v44
    v_cvt_f32_u32 v45, v45
    v_cvt_f32_u32 v46, v46
    v_cvt_f32_u32 v47, v47
    v_cvt_f32_u32 v48, v48
    v_cvt_f32_u32 v49, v49
    v_cvt_f32_u32 v50, v50
    v_cvt_f32_u32 v51, v51
    v_cvt_f32_u32 v52, v52
    v_cvt_f32_u32 v53, v53
    v_cvt_f32_u32 v54, v54
    v_cvt_pk_bf16_f32 v18, v44, v45
    v_lshlrev_b32 v44, 16, v18
    v_and_b32 v45, 0xffff0000, v18
    v_cvt_pk_bf16_f32 v18, v46, v47
    v_lshlrev_b32 v46, 16, v18
    v_and_b32 v47, 0xffff0000, v18
    v_cvt_pk_bf16_f32 v18, v48, v49
    v_lshlrev_b32 v48, 16, v18
    v_and_b32 v49, 0xffff0000, v18
    v_cvt_pk_bf16_f32 v18, v50, v51
    v_lshlrev_b32 v50, 16, v18
    v_and_b32 v51, 0xffff0000, v18
    v_cvt_pk_bf16_f32 v18, v52, v53
    v_lshlrev_b32 v52, 16, v18
    v_and_b32 v53, 0xffff0000, v18
    v_cvt_pk_bf16_f32 v18, v54, v54
    v_lshlrev_b32 v54, 16, v18
    v_cvt_u32_f32 v44, v44
    v_cvt_u32_f32 v45, v45
    v_cvt_u32_f32 v46, v46
    v_cvt_u32_f32 v47, v47
    v_cvt_u32_f32 v48, v48
    v_cvt_u32_f32 v49, v49
    v_cvt_u32_f32 v50, v50
    v_cvt_u32_f32 v51, v51
    v_cvt_u32_f32 v52, v52
    v_cvt_u32_f32 v53, v53
    v_cvt_u32_f32 v54, v54
    v_mov_b32 v18, 2050
    v_cmp_eq_u32 vcc, 255, v0
    s_nop 1
    v_cndmask_b32 v52, v52, v18, vcc
    v_cndmask_b32 v53, v53, v18, vcc
    v_cndmask_b32 v54, v54, v18, vcc
    v_lshl_add_u32 v44, v44, 1, s44
    v_lshl_add_u32 v45, v45, 1, s44
    v_lshl_add_u32 v46, v46, 1, s44
    v_lshl_add_u32 v47, v47, 1, s44
    v_lshl_add_u32 v48, v48, 1, s44
    v_lshl_add_u32 v49, v49, 1, s44
    v_lshl_add_u32 v50, v50, 1, s44
    v_lshl_add_u32 v51, v51, 1, s44
    v_lshl_add_u32 v52, v52, 1, s44
    v_lshl_add_u32 v53, v53, 1, s44
    v_lshl_add_u32 v54, v54, 1, s44
    v_lshrrev_b32 v7, 4, v1
    v_and_b32 v18, 1, v2
    v_lshl_add_u32 v18, v18, 4, v5
    v_lshlrev_b32 v18, 3, v18
    v_lshrrev_b32 v19, 1, v2
    v_lshl_add_u32 v18, v19, 10, v18
    v_lshl_add_u32 v56, v7, 2, 0
    v_mov_b32 v19, 256
    v_cmp_eq_u32 vcc, 2, v7
    s_nop 1
    v_cndmask_b32 v56, v56, v19, vcc
    v_mov_b32 v19, 512
    v_cmp_eq_u32 vcc, 3, v7
    s_nop 1
    v_cndmask_b32 v56, v56, v19, vcc
    v_add_lshl_u32 v56, v56, v18, 1
    v_add_u32 v56, s44, v56
    v_lshl_add_u32 v57, v7, 2, 1
    v_mov_b32 v19, 258
    v_cmp_eq_u32 vcc, 2, v7
    s_nop 1
    v_cndmask_b32 v57, v57, v19, vcc
    v_mov_b32 v19, 516
    v_cmp_eq_u32 vcc, 3, v7
    s_nop 1
    v_cndmask_b32 v57, v57, v19, vcc
    v_add_lshl_u32 v57, v57, v18, 1
    v_add_u32 v57, s44, v57
    v_lshl_add_u32 v58, v7, 2, 2
    v_mov_b32 v19, 260
    v_cmp_eq_u32 vcc, 2, v7
    s_nop 1
    v_cndmask_b32 v58, v58, v19, vcc
    v_mov_b32 v19, 768
    v_cmp_eq_u32 vcc, 3, v7
    s_nop 1
    v_cndmask_b32 v58, v58, v19, vcc
    v_add_lshl_u32 v58, v58, v18, 1
    v_add_u32 v58, s44, v58
    v_lshl_add_u32 v59, v7, 2, 3
    v_mov_b32 v19, 262
    v_cmp_eq_u32 vcc, 2, v7
    s_nop 1
    v_cndmask_b32 v59, v59, v19, vcc
    v_mov_b32 v19, 772
    v_cmp_eq_u32 vcc, 3, v7
    s_nop 1
    v_cndmask_b32 v59, v59, v19, vcc
    v_add_lshl_u32 v59, v59, v18, 1
    v_add_u32 v59, s44, v59
    v_mov_b32 v19, 0
    v_mov_b32 v18, s44
    ds_write_b32 v18, v19 offset:24580
    s_waitcnt lgkmcnt(0)
    s_cmp_eq_u32 s42, 0
    s_cbranch_scc0 L_kg_odd
    s_lshl_b32 s47, s47, 16
L_kg_odd:
    s_and_b32 s47, s47, 0xffff0000
    v_mov_b32 v18, 0x3fb8aa3b
    v_mul_f32 v18, s47, v18
    v_exp_f32 v18, v18
    s_nop 0
    v_cvt_pk_bf16_f32 v18, v18, v18
    v_and_b32 v18, 0xffff0000, v18
    s_waitcnt vmcnt(0)
    v_mul_f32 v8, 0x3fb8aa3b, v8
    v_exp_f32 v8, v8
    s_nop 0
    v_cvt_pk_bf16_f32 v8, v8, v8
    v_and_b32 v8, 0xffff0000, v8
    v_mul_f32 v8, v8, v18
    v_mul_f32 v8, 0xbfb8aa3b, v8
    v_mul_f32 v9, v9, v18
    v_mul_f32 v9, 0x3e22f983, v9
    v_pk_mul_f32 v[22:23], v[8:9], v[16:17] op_sel_hi:[1,0]
    v_exp_f32 v22, v22
    v_fract_f32 v23, v23
    v_cos_f32 v20, v23
    v_sin_f32 v21, v23
    s_nop 0
    v_pk_mul_f32 v[20:21], v[20:21], v[22:23] op_sel_hi:[1,0]
    v_lshl_add_u32 v19, v3, 5, s44
    ds_write_b128 v19, v[8:11] offset:0
    v_lshrrev_b32 v24, 5, v1
    v_lshl_add_u32 v19, v24, 3, v19
    ds_write_b64 v19, v[20:21] offset:16
    v_mul_f32 v22, v20, v20
    v_fma_f32 v22, -v21, v21, v22
    v_mul_f32 v23, v20, v21
    v_add_f32 v23, v23, v23
    v_mul_f32 v22, v10, v22
    v_fma_f32 v22, -v11, v23, v22
    s_nop 1
    v_add_f32_dpp v22, v22, v22 row_ror:8 row_mask:0xf bank_mask:0xf
    s_nop 1
    v_add_f32_dpp v22, v22, v22 row_ror:4 row_mask:0xf bank_mask:0xf
    s_nop 1
    v_add_f32_dpp v22, v22, v22 row_ror:2 row_mask:0xf bank_mask:0xf
    s_nop 1
    v_add_f32_dpp v22, v22, v22 row_ror:1 row_mask:0xf bank_mask:0xf
    v_lshrrev_b32 v23, 4, v0
    v_lshl_add_u32 v23, v23, 2, s44
    ds_write_b32 v23, v22 offset:24832
    v_mov_b32 v64, 0
    v_mov_b32 v65, 0
    v_mov_b32 v66, 0
    v_mov_b32 v67, 0
    v_mov_b32 v68, 0
    v_mov_b32 v69, 0
    v_mov_b32 v70, 0
    v_mov_b32 v71, 0
    v_mov_b32 v72, 0
    v_mov_b32 v73, 0
    v_mov_b32 v74, 0
    v_mov_b32 v75, 0
    v_mov_b32 v76, 0
    v_mov_b32 v77, 0
    v_mov_b32 v78, 0
    v_mov_b32 v79, 0
    v_lshrrev_b32 v7, 4, v1
    v_lshl_add_u32 v7, v2, 3, v7
    v_lshl_add_u32 v7, v7, 7, s44
    s_waitcnt lgkmcnt(0)
    ds_read_b128 v[80:83], v7 offset:0
    ds_read_b128 v[84:87], v7 offset:16
    ds_read_b128 v[88:91], v7 offset:32
    ds_read_b128 v[92:95], v7 offset:48
    ds_read_b128 v[96:99], v7 offset:64
    ds_read_b128 v[100:103], v7 offset:80
    ds_read_b128 v[104:107], v7 offset:96
    ds_read_b128 v[108:111], v7 offset:112
    s_waitcnt lgkmcnt(6)
    v_pk_mul_f32 v[22:23], v[80:81], v[14:15] op_sel_hi:[1,0]
    v_exp_f32 v22, v22
    v_fract_f32 v23, v23
    v_cos_f32 v20, v23
    v_sin_f32 v21, v23
    s_nop 0
    v_pk_mul_f32 v[20:21], v[20:21], v[22:23] op_sel_hi:[1,0]
    v_cvt_pk_bf16_f32 v120, v20, v21
    v_pk_mul_f32 v[22:23], v[20:21], v[84:85] op_sel_hi:[1,0]
    v_pk_fma_f32 v[22:23], v[20:21], v[84:85], v[22:23] op_sel:[1,1,0] op_sel_hi:[0,1,1] neg_lo:[1,0,0]
    v_cvt_pk_bf16_f32 v124, v22, v23
    v_pk_mul_f32 v[26:27], v[80:81], v[12:13] op_sel_hi:[1,0]
    v_exp_f32 v26, v26
    v_fract_f32 v27, v27
    v_cos_f32 v24, v27
    v_sin_f32 v25, v27
    s_nop 0
    v_pk_mul_f32 v[24:25], v[24:25], v[26:27] op_sel_hi:[1,0]
    v_pk_mul_f32 v[26:27], v[24:25], v[82:83] op_sel_hi:[1,0] neg_hi:[1,0]
    v_pk_fma_f32 v[26:27], v[24:25], v[82:83], v[26:27] op_sel:[1,1,0] op_sel_hi:[0,1,1] neg_lo:[1,0,0] neg_hi:[1,0,0]
    v_cvt_pk_bf16_f32 v112, v26, v27
    v_pk_mul_f32 v[24:25], v[26:27], v[86:87] op_sel_hi:[1,0]
    v_pk_fma_f32 v[24:25], v[26:27], v[86:87], v[24:25] op_sel:[1,1,0] op_sel_hi:[0,1,1] neg_hi:[1,0,0]
    v_cvt_pk_bf16_f32 v116, v24, v25
    s_waitcnt lgkmcnt(4)
    v_pk_mul_f32 v[22:23], v[88:89], v[14:15] op_sel_hi:[1,0]
    v_exp_f32 v22, v22
    v_fract_f32 v23, v23
    v_cos_f32 v20, v23
    v_sin_f32 v21, v23
    s_nop 0
    v_pk_mul_f32 v[20:21], v[20:21], v[22:23] op_sel_hi:[1,0]
    v_cvt_pk_bf16_f32 v121, v20, v21
    v_pk_mul_f32 v[22:23], v[20:21], v[92:93] op_sel_hi:[1,0]
    v_pk_fma_f32 v[22:23], v[20:21], v[92:93], v[22:23] op_sel:[1,1,0] op_sel_hi:[0,1,1] neg_lo:[1,0,0]
    v_cvt_pk_bf16_f32 v125, v22, v23
    v_pk_mul_f32 v[26:27], v[88:89], v[12:13] op_sel_hi:[1,0]
    v_exp_f32 v26, v26
    v_fract_f32 v27, v27
    v_cos_f32 v24, v27
    v_sin_f32 v25, v27
    s_nop 0
    v_pk_mul_f32 v[24:25], v[24:25], v[26:27] op_sel_hi:[1,0]
    v_pk_mul_f32 v[26:27], v[24:25], v[90:91] op_sel_hi:[1,0] neg_hi:[1,0]
    v_pk_fma_f32 v[26:27], v[24:25], v[90:91], v[26:27] op_sel:[1,1,0] op_sel_hi:[0,1,1] neg_lo:[1,0,0] neg_hi:[1,0,0]
    v_cvt_pk_bf16_f32 v113, v26, v27
    v_pk_mul_f32 v[24:25], v[26:27], v[94:95] op_sel_hi:[1,0]
    v_pk_fma_f32 v[24:25], v[26:27], v[94:95], v[24:25] op_sel:[1,1,0] op_sel_hi:[0,1,1] neg_hi:[1,0,0]
    v_cvt_pk_bf16_f32 v117, v24, v25
    s_waitcnt lgkmcnt(2)
    v_pk_mul_f32 v[22:23], v[96:97], v[14:15] op_sel_hi:[1,0]
    v_exp_f32 v22, v22
    v_fract_f32 v23, v23
    v_cos_f32 v20, v23
    v_sin_f32 v21, v23
    s_nop 0
    v_pk_mul_f32 v[20:21], v[20:21], v[22:23] op_sel_hi:[1,0]
    v_cvt_pk_bf16_f32 v122, v20, v21
    v_pk_mul_f32 v[22:23], v[20:21], v[100:101] op_sel_hi:[1,0]
    v_pk_fma_f32 v[22:23], v[20:21], v[100:101], v[22:23] op_sel:[1,1,0] op_sel_hi:[0,1,1] neg_lo:[1,0,0]
    v_cvt_pk_bf16_f32 v126, v22, v23
    v_pk_mul_f32 v[26:27], v[96:97], v[12:13] op_sel_hi:[1,0]
    v_exp_f32 v26, v26
    v_fract_f32 v27, v27
    v_cos_f32 v24, v27
    v_sin_f32 v25, v27
    s_nop 0
    v_pk_mul_f32 v[24:25], v[24:25], v[26:27] op_sel_hi:[1,0]
    v_pk_mul_f32 v[26:27], v[24:25], v[98:99] op_sel_hi:[1,0] neg_hi:[1,0]
    v_pk_fma_f32 v[26:27], v[24:25], v[98:99], v[26:27] op_sel:[1,1,0] op_sel_hi:[0,1,1] neg_lo:[1,0,0] neg_hi:[1,0,0]
    v_cvt_pk_bf16_f32 v114, v26, v27
    v_pk_mul_f32 v[24:25], v[26:27], v[102:103] op_sel_hi:[1,0]
    v_pk_fma_f32 v[24:25], v[26:27], v[102:103], v[24:25] op_sel:[1,1,0] op_sel_hi:[0,1,1] neg_hi:[1,0,0]
    v_cvt_pk_bf16_f32 v118, v24, v25
    s_waitcnt lgkmcnt(0)
    v_pk_mul_f32 v[22:23], v[104:105], v[14:15] op_sel_hi:[1,0]
    v_exp_f32 v22, v22
    v_fract_f32 v23, v23
    v_cos_f32 v20, v23
    v_sin_f32 v21, v23
    s_nop 0
    v_pk_mul_f32 v[20:21], v[20:21], v[22:23] op_sel_hi:[1,0]
    v_cvt_pk_bf16_f32 v123, v20, v21
    v_pk_mul_f32 v[22:23], v[20:21], v[108:109] op_sel_hi:[1,0]
    v_pk_fma_f32 v[22:23], v[20:21], v[108:109], v[22:23] op_sel:[1,1,0] op_sel_hi:[0,1,1] neg_lo:[1,0,0]
    v_cvt_pk_bf16_f32 v127, v22, v23
    v_pk_mul_f32 v[26:27], v[104:105], v[12:13] op_sel_hi:[1,0]
    v_exp_f32 v26, v26
    v_fract_f32 v27, v27
    v_cos_f32 v24, v27
    v_sin_f32 v25, v27
    s_nop 0
    v_pk_mul_f32 v[24:25], v[24:25], v[26:27] op_sel_hi:[1,0]
    v_pk_mul_f32 v[26:27], v[24:25], v[106:107] op_sel_hi:[1,0] neg_hi:[1,0]
    v_pk_fma_f32 v[26:27], v[24:25], v[106:107], v[26:27] op_sel:[1,1,0] op_sel_hi:[0,1,1] neg_lo:[1,0,0] neg_hi:[1,0,0]
    v_cvt_pk_bf16_f32 v115, v26, v27
    v_pk_mul_f32 v[24:25], v[26:27], v[110:111] op_sel_hi:[1,0]
    v_pk_fma_f32 v[24:25], v[26:27], v[110:111], v[24:25] op_sel:[1,1,0] op_sel_hi:[0,1,1] neg_hi:[1,0,0]
    v_cvt_pk_bf16_f32 v119, v24, v25
    v_mfma_f32_16x16x32_bf16 v[64:67], v[112:115], v[120:123], v[64:67]
    v_mfma_f32_16x16x32_bf16 v[68:71], v[112:115], v[124:127], v[68:71]
    v_mfma_f32_16x16x32_bf16 v[72:75], v[116:119], v[120:123], v[72:75]
    v_mfma_f32_16x16x32_bf16 v[76:79], v[116:119], v[124:127], v[76:79]
    ds_read_b128 v[80:83], v7 offset:512
    ds_read_b128 v[84:87], v7 offset:528
    ds_read_b128 v[88:91], v7 offset:544
    ds_read_b128 v[92:95], v7 offset:560
    ds_read_b128 v[96:99], v7 offset:576
    ds_read_b128 v[100:103], v7 offset:592
    ds_read_b128 v[104:107], v7 offset:608
    ds_read_b128 v[108:111], v7 offset:624
    s_waitcnt lgkmcnt(6)
    v_pk_mul_f32 v[22:23], v[80:81], v[14:15] op_sel_hi:[1,0]
    v_exp_f32 v22, v22
    v_fract_f32 v23, v23
    v_cos_f32 v20, v23
    v_sin_f32 v21, v23
    s_nop 0
    v_pk_mul_f32 v[20:21], v[20:21], v[22:23] op_sel_hi:[1,0]
    v_cvt_pk_bf16_f32 v120, v20, v21
    v_pk_mul_f32 v[22:23], v[20:21], v[84:85] op_sel_hi:[1,0]
    v_pk_fma_f32 v[22:23], v[20:21], v[84:85], v[22:23] op_sel:[1,1,0] op_sel_hi:[0,1,1] neg_lo:[1,0,0]
    v_cvt_pk_bf16_f32 v124, v22, v23
    v_pk_mul_f32 v[26:27], v[80:81], v[12:13] op_sel_hi:[1,0]
    v_exp_f32 v26, v26
    v_fract_f32 v27, v27
    v_cos_f32 v24, v27
    v_sin_f32 v25, v27
    s_nop 0
    v_pk_mul_f32 v[24:25], v[24:25], v[26:27] op_sel_hi:[1,0]
    v_pk_mul_f32 v[26:27], v[24:25], v[82:83] op_sel_hi:[1,0] neg_hi:[1,0]
    v_pk_fma_f32 v[26:27], v[24:25], v[82:83], v[26:27] op_sel:[1,1,0] op_sel_hi:[0,1,1] neg_lo:[1,0,0] neg_hi:[1,0,0]
    v_cvt_pk_bf16_f32 v112, v26, v27
    v_pk_mul_f32 v[24:25], v[26:27], v[86:87] op_sel_hi:[1,0]
    v_pk_fma_f32 v[24:25], v[26:27], v[86:87], v[24:25] op_sel:[1,1,0] op_sel_hi:[0,1,1] neg_hi:[1,0,0]
    v_cvt_pk_bf16_f32 v116, v24, v25
    s_waitcnt lgkmcnt(4)
    v_pk_mul_f32 v[22:23], v[88:89], v[14:15] op_sel_hi:[1,0]
    v_exp_f32 v22, v22
    v_fract_f32 v23, v23
    v_cos_f32 v20, v23
    v_sin_f32 v21, v23
    s_nop 0
    v_pk_mul_f32 v[20:21], v[20:21], v[22:23] op_sel_hi:[1,0]
    v_cvt_pk_bf16_f32 v121, v20, v21
    v_pk_mul_f32 v[22:23], v[20:21], v[92:93] op_sel_hi:[1,0]
    v_pk_fma_f32 v[22:23], v[20:21], v[92:93], v[22:23] op_sel:[1,1,0] op_sel_hi:[0,1,1] neg_lo:[1,0,0]
    v_cvt_pk_bf16_f32 v125, v22, v23
    v_pk_mul_f32 v[26:27], v[88:89], v[12:13] op_sel_hi:[1,0]
    v_exp_f32 v26, v26
    v_fract_f32 v27, v27
    v_cos_f32 v24, v27
    v_sin_f32 v25, v27
    s_nop 0
    v_pk_mul_f32 v[24:25], v[24:25], v[26:27] op_sel_hi:[1,0]
    v_pk_mul_f32 v[26:27], v[24:25], v[90:91] op_sel_hi:[1,0] neg_hi:[1,0]
    v_pk_fma_f32 v[26:27], v[24:25], v[90:91], v[26:27] op_sel:[1,1,0] op_sel_hi:[0,1,1] neg_lo:[1,0,0] neg_hi:[1,0,0]
    v_cvt_pk_bf16_f32 v113, v26, v27
    v_pk_mul_f32 v[24:25], v[26:27], v[94:95] op_sel_hi:[1,0]
    v_pk_fma_f32 v[24:25], v[26:27], v[94:95], v[24:25] op_sel:[1,1,0] op_sel_hi:[0,1,1] neg_hi:[1,0,0]
    v_cvt_pk_bf16_f32 v117, v24, v25
    s_waitcnt lgkmcnt(2)
    v_pk_mul_f32 v[22:23], v[96:97], v[14:15] op_sel_hi:[1,0]
    v_exp_f32 v22, v22
    v_fract_f32 v23, v23
    v_cos_f32 v20, v23
    v_sin_f32 v21, v23
    s_nop 0
    v_pk_mul_f32 v[20:21], v[20:21], v[22:23] op_sel_hi:[1,0]
    v_cvt_pk_bf16_f32 v122, v20, v21
    v_pk_mul_f32 v[22:23], v[20:21], v[100:101] op_sel_hi:[1,0]
    v_pk_fma_f32 v[22:23], v[20:21], v[100:101], v[22:23] op_sel:[1,1,0] op_sel_hi:[0,1,1] neg_lo:[1,0,0]
    v_cvt_pk_bf16_f32 v126, v22, v23
    v_pk_mul_f32 v[26:27], v[96:97], v[12:13] op_sel_hi:[1,0]
    v_exp_f32 v26, v26
    v_fract_f32 v27, v27
    v_cos_f32 v24, v27
    v_sin_f32 v25, v27
    s_nop 0
    v_pk_mul_f32 v[24:25], v[24:25], v[26:27] op_sel_hi:[1,0]
    v_pk_mul_f32 v[26:27], v[24:25], v[98:99] op_sel_hi:[1,0] neg_hi:[1,0]
    v_pk_fma_f32 v[26:27], v[24:25], v[98:99], v[26:27] op_sel:[1,1,0] op_sel_hi:[0,1,1] neg_lo:[1,0,0] neg_hi:[1,0,0]
    v_cvt_pk_bf16_f32 v114, v26, v27
    v_pk_mul_f32 v[24:25], v[26:27], v[102:103] op_sel_hi:[1,0]
    v_pk_fma_f32 v[24:25], v[26:27], v[102:103], v[24:25] op_sel:[1,1,0] op_sel_hi:[0,1,1] neg_hi:[1,0,0]
    v_cvt_pk_bf16_f32 v118, v24, v25
    s_waitcnt lgkmcnt(0)
    v_pk_mul_f32 v[22:23], v[104:105], v[14:15] op_sel_hi:[1,0]
    v_exp_f32 v22, v22
    v_fract_f32 v23, v23
    v_cos_f32 v20, v23
    v_sin_f32 v21, v23
    s_nop 0
    v_pk_mul_f32 v[20:21], v[20:21], v[22:23] op_sel_hi:[1,0]
    v_cvt_pk_bf16_f32 v123, v20, v21
    v_pk_mul_f32 v[22:23], v[20:21], v[108:109] op_sel_hi:[1,0]
    v_pk_fma_f32 v[22:23], v[20:21], v[108:109], v[22:23] op_sel:[1,1,0] op_sel_hi:[0,1,1] neg_lo:[1,0,0]
    v_cvt_pk_bf16_f32 v127, v22, v23
    v_pk_mul_f32 v[26:27], v[104:105], v[12:13] op_sel_hi:[1,0]
    v_exp_f32 v26, v26
    v_fract_f32 v27, v27
    v_cos_f32 v24, v27
    v_sin_f32 v25, v27
    s_nop 0
    v_pk_mul_f32 v[24:25], v[24:25], v[26:27] op_sel_hi:[1,0]
    v_pk_mul_f32 v[26:27], v[24:25], v[106:107] op_sel_hi:[1,0] neg_hi:[1,0]
    v_pk_fma_f32 v[26:27], v[24:25], v[106:107], v[26:27] op_sel:[1,1,0] op_sel_hi:[0,1,1] neg_lo:[1,0,0] neg_hi:[1,0,0]
    v_cvt_pk_bf16_f32 v115, v26, v27
    v_pk_mul_f32 v[24:25], v[26:27], v[110:111] op_sel_hi:[1,0]
    v_pk_fma_f32 v[24:25], v[26:27], v[110:111], v[24:25] op_sel:[1,1,0] op_sel_hi:[0,1,1] neg_hi:[1,0,0]
    v_cvt_pk_bf16_f32 v119, v24, v25
    v_mfma_f32_16x16x32_bf16 v[64:67], v[112:115], v[120:123], v[64:67]
    v_mfma_f32_16x16x32_bf16 v[68:71], v[112:115], v[124:127], v[68:71]
    v_mfma_f32_16x16x32_bf16 v[72:75], v[116:119], v[120:123], v[72:75]
    v_mfma_f32_16x16x32_bf16 v[76:79], v[116:119], v[124:127], v[76:79]
    v_lshl_add_u32 v7, v1, 4, s44
    v_lshl_add_u32 v19, v2, 12, v7
    s_nop 2
    ds_write_b128 v19, v[64:67] offset:4096
    ds_write_b128 v19, v[68:71] offset:5120
    ds_write_b128 v19, v[72:75] offset:6144
    ds_write_b128 v19, v[76:79] offset:7168
    s_lshl_b32 s45, s42, 3
    s_add_u32 s45, s45, 48
    v_mov_b32 v29, s45
    v_mov_b32 v28, 1
    s_mov_b64 exec, 1
    ds_add_u32 v29, v28
    s_mov_b64 exec, -1
    s_mov_b32 s51, 0
L_ls_ka:
    ds_read_b32 v28, v29
    s_waitcnt lgkmcnt(0)
    v_readfirstlane_b32 s50, v28
    s_add_u32 s51, s51, 1
    s_cmp_ge_u32 s50, 4
    s_cbranch_scc1 L_lg_ka
    s_cmp_lt_u32 s51, 128000
    s_cbranch_scc1 L_ls_ka
L_lg_ka:
    v_lshl_add_u32 v19, v2, 10, v7
    ds_read_b128 v[80:83], v19 offset:4096
    ds_read_b128 v[84:87], v19 offset:8192
    ds_read_b128 v[88:91], v19 offset:12288
    ds_read_b128 v[92:95], v19 offset:16384
    v_add_f32 v18, v18, v18
    v_mov_b32 v28, s44
    ds_read_b64 v[96:97], v28 offset:24840
    ds_read_b64 v[98:99], v28 offset:24856
    ds_read_b64 v[100:101], v28 offset:24872
    ds_read_b64 v[102:103], v28 offset:24888
    s_waitcnt lgkmcnt(4)
    v_add_f32 v80, v80, v84
    v_add_f32 v88, v88, v92
    v_add_f32 v81, v81, v85
    v_add_f32 v89, v89, v93
    v_add_f32 v82, v82, v86
    v_add_f32 v90, v90, v94
    v_add_f32 v83, v83, v87
    v_add_f32 v91, v91, v95
    v_add_f32 v80, v80, v88
    v_add_f32 v81, v81, v89
    v_add_f32 v82, v82, v90
    v_add_f32 v83, v83, v91
    v_mul_f32 v80, v80, v18
    v_mul_f32 v81, v81, v18
    v_mul_f32 v82, v82, v18
    v_mul_f32 v83, v83, v18
    v_cvt_pk_bf16_f32 v80, v80, v81
    v_cvt_pk_bf16_f32 v82, v82, v83
    ds_write_b16 v56, v80 offset:20480
    ds_write_b16_d16_hi v57, v80 offset:20480
    ds_write_b16 v58, v82 offset:20480
    ds_write_b16_d16_hi v59, v82 offset:20480
    s_waitcnt lgkmcnt(4)
    v_pk_add_f32 v[96:97], v[96:97], v[98:99]
    v_pk_add_f32 v[100:101], v[100:101], v[102:103]
    v_pk_add_f32 v[96:97], v[96:97], v[100:101]
    v_add_f32 v96, v96, v97
    v_mul_f32 v96, v96, v18
    v_cvt_pk_bf16_f32 v96, v96, v96
    ds_write_b16 v28, v96 offset:24576
    v_add_u32 v29, 4, v29
    v_mov_b32 v28, 1
    s_mov_b64 exec, 1
    ds_add_u32 v29, v28
    s_mov_b64 exec, -1
    s_mov_b32 s51, 0
L_ls_kb:
    ds_read_b32 v28, v29
    s_waitcnt lgkmcnt(0)
    v_readfirstlane_b32 s50, v28
    s_add_u32 s51, s51, 1
    s_cmp_ge_u32 s50, 4
    s_cbranch_scc1 L_lg_kb
    s_cmp_lt_u32 s51, 128000
    s_cbranch_scc1 L_ls_kb
L_lg_kb:
    ds_read_u16 v80, v44 offset:20480
    ds_read_u16 v81, v45 offset:20480
    ds_read_u16 v82, v46 offset:20480
    ds_read_u16 v83, v47 offset:20480
    ds_read_u16 v84, v48 offset:20480
    ds_read_u16 v85, v49 offset:20480
    ds_read_u16 v86, v50 offset:20480
    ds_read_u16 v87, v51 offset:20480
    ds_read_u16 v88, v52 offset:20480
    ds_read_u16 v89, v53 offset:20480
    ds_read_u16 v90, v54 offset:20480
    s_mul_i32 s45, s42, 16640
    v_lshl_add_u32 v7, v0, 4, s45
    s_waitcnt lgkmcnt(3)
    v_lshl_or_b32 v92, v81, 16, v80
    v_lshl_or_b32 v93, v83, 16, v82
    v_lshl_or_b32 v94, v85, 16, v84
    v_lshl_or_b32 v95, v87, 16, v86
    s_waitcnt lgkmcnt(2)
    v_lshl_or_b32 v96, v82, 16, v81
    v_lshl_or_b32 v97, v84, 16, v83
    v_lshl_or_b32 v98, v86, 16, v85
    v_lshl_or_b32 v99, v88, 16, v87
    s_waitcnt lgkmcnt(1)
    v_lshl_or_b32 v100, v83, 16, v82
    v_lshl_or_b32 v101, v85, 16, v84
    v_lshl_or_b32 v102, v87, 16, v86
    v_lshl_or_b32 v103, v89, 16, v88
    s_waitcnt lgkmcnt(0)
    v_lshl_or_b32 v104, v84, 16, v83
    v_lshl_or_b32 v105, v86, 16, v85
    v_lshl_or_b32 v106, v88, 16, v87
    v_lshl_or_b32 v107, v90, 16, v89
    ds_write_b128 v7, v[92:95] offset:512
    ds_write_b128 v7, v[96:99] offset:4672
    ds_write_b128 v7, v[100:103] offset:8832
    ds_write_b128 v7, v[104:107] offset:12992
    s_cmp_lt_u32 s40, 4
    s_cbranch_scc0 L_side
    v_mov_b32 v6, v1
    v_and_b32 v8, 15, v6
    v_lshrrev_b32 v9, 4, v6
    s_lshr_b32 s42, s40, 1
    s_and_b32 s43, s40, 1
    s_lshl_b32 s44, s43, 8
    v_sub_u32 v10, 3, v8
    v_and_b32 v10, 3, v10
    v_mul_u32_u24 v10, 4160, v10
    v_lshrrev_b32 v11, 2, v8
    v_lshlrev_b32 v12, 1, v9
    v_sub_u32 v11, v12, v11
    v_add_u32 v11, 507, v11
    v_lshl_add_u32 v10, v11, 3, v10
    s_mul_i32 s45, s42, 16640
    s_sub_u32 s45, s45, s44
    s_add_u32 s45, s45, -3520
    v_add_u32 v2, s45, v10
    v_lshl_add_u32 v11, v8, 1, v9
    v_lshlrev_b32 v11, 4, v11
    s_mul_i32 s45, s42, 4608
    s_sub_u32 s45, s45, s44
    s_add_u32 s45, s45, 34080
    v_add_u32 v3, s45, v11
    v_lshlrev_b32 v4, 5, v8
    v_lshl_add_u32 v4, v9, 3, v4
    s_lshl_b32 s46, s43, 11
    s_mul_i32 s50, s42, 4608
    s_add_u32 s50, s50, s46
    s_mul_i32 s51, s42, 4096
    s_add_u32 s51, s51, s46
    s_lshl_b32 s52, s40, 12
    s_lshl_b32 s53, s40, 2
    s_add_u32 s53, s53, 32
    s_xor_b32 s54, s53, 4
    s_lshl_b32 s55, s42, 2
    s_add_u32 s55, s55, 8
    s_lshl_b32 s45, s41, 13
    s_lshl_b32 s44, s42, 12
    s_add_u32 s45, s45, s44
    s_add_u32 s44, s45, s46
    s_add_u32 s45, s44, 8192
    s_lshl_b32 s46, s48, 16
    s_and_b32 s47, s48, 0xffff0000
    s_cmp_eq_u32 s42, 0
    s_cselect_b32 s46, s46, s47
    v_and_b32 v5, 15, v6
    v_lshlrev_b32 v5, 5, v5
    v_bfe_u32 v8, v6, 4, 1
    v_lshl_add_u32 v5, v8, 9, v5
    v_lshrrev_b32 v8, 5, v6
    v_lshl_add_u32 v5, v8, 4, v5
    s_add_u32 s68, s34, 0x1100000
    s_addc_u32 s69, s35, 0
    s_and_b32 s69, s69, 0xffff
    s_mov_b32 s70, 0x400000
    s_mov_b32 s71, 0x00020000
    s_waitcnt lgkmcnt(0)
    s_barrier
    ds_read_b128 v[40:43], v3 offset:192
    ds_read_b128 v[44:47], v3 offset:704
    ds_read_b128 v[48:51], v3 offset:1216
    ds_read_b128 v[52:55], v3 offset:1728
    ds_read_b128 v[56:59], v3 offset:2240
    ds_read_b128 v[60:63], v3 offset:2752
    ds_read_b128 v[64:67], v3 offset:3264
    ds_read_b128 v[68:71], v3 offset:3776
    ds_read_b64 v[104:105], v2 offset:4032
    ds_read_b64 v[106:107], v2 offset:4040
    ds_read_b64 v[108:109], v2 offset:3520
    ds_read_b64 v[110:111], v2 offset:3528
    ds_read_b64 v[112:113], v2 offset:3008
    ds_read_b64 v[114:115], v2 offset:3016
    s_waitcnt lgkmcnt(4)
    v_mfma_f32_16x16x32_bf16 v[8:11], v[104:107], v[40:43], 0
    ds_read_b64 v[116:117], v2 offset:2496
    v_mfma_f32_16x16x32_bf16 v[12:15], v[104:107], v[44:47], 0
    ds_read_b64 v[118:119], v2 offset:2504
    v_mfma_f32_16x16x32_bf16 v[16:19], v[104:107], v[48:51], 0
    ds_read_b64 v[120:121], v2 offset:1984
    v_mfma_f32_16x16x32_bf16 v[20:23], v[104:107], v[52:55], 0
    ds_read_b64 v[122:123], v2 offset:1992
    v_mfma_f32_16x16x32_bf16 v[24:27], v[104:107], v[56:59], 0
    ds_read_b64 v[124:125], v2 offset:1472
    v_mfma_f32_16x16x32_bf16 v[28:31], v[104:107], v[60:63], 0
    ds_read_b64 v[126:127], v2 offset:1480
    v_mfma_f32_16x16x32_bf16 v[32:35], v[104:107], v[64:67], 0
    ds_read_b64 v[128:129], v2 offset:960
    v_mfma_f32_16x16x32_bf16 v[36:39], v[104:107], v[68:71], 0
    ds_read_b64 v[130:131], v2 offset:968
    s_waitcnt lgkmcnt(10)
    v_mfma_f32_16x16x32_bf16 v[12:15], v[108:111], v[40:43], v[12:15]
    ds_read_b64 v[132:133], v2 offset:448
    v_mfma_f32_16x16x32_bf16 v[16:19], v[108:111], v[44:47], v[16:19]
    ds_read_b64 v[134:135], v2 offset:456
    v_mfma_f32_16x16x32_bf16 v[20:23], v[108:111], v[48:51], v[20:23]
    ds_read_b128 v[72:75], v3 offset:128
    v_mfma_f32_16x16x32_bf16 v[24:27], v[108:111], v[52:55], v[24:27]
    ds_read_b128 v[76:79], v3 offset:640
    v_mfma_f32_16x16x32_bf16 v[28:31], v[108:111], v[56:59], v[28:31]
    ds_read_b128 v[80:83], v3 offset:1152
    v_mfma_f32_16x16x32_bf16 v[32:35], v[108:111], v[60:63], v[32:35]
    ds_read_b128 v[84:87], v3 offset:1664
    v_mfma_f32_16x16x32_bf16 v[36:39], v[108:111], v[64:67], v[36:39]
    ds_read_b128 v[88:91], v3 offset:2176
    s_waitcnt lgkmcnt(14)
    v_mfma_f32_16x16x32_bf16 v[16:19], v[112:115], v[40:43], v[16:19]
    ds_read_b128 v[92:95], v3 offset:2688
    v_mfma_f32_16x16x32_bf16 v[20:23], v[112:115], v[44:47], v[20:23]
    ds_read_b128 v[96:99], v3 offset:3200
    v_mfma_f32_16x16x32_bf16 v[24:27], v[112:115], v[48:51], v[24:27]
    ds_read_b128 v[100:103], v3 offset:3712
    v_mfma_f32_16x16x32_bf16 v[28:31], v[112:115], v[52:55], v[28:31]
    ds_read_b64 v[136:137], v2 offset:3968
    v_mfma_f32_16x16x32_bf16 v[32:35], v[112:115], v[56:59], v[32:35]
    ds_read_b64 v[138:139], v2 offset:3976
    v_mfma_f32_16x16x32_bf16 v[36:39], v[112:115], v[60:63], v[36:39]
    ds_read_b64 v[140:141], v2 offset:3456
    s_waitcnt lgkmcnt(14)
    v_mfma_f32_16x16x32_bf16 v[20:23], v[116:119], v[40:43], v[20:23]
    ds_read_b64 v[142:143], v2 offset:3464
    v_mfma_f32_16x16x32_bf16 v[24:27], v[116:119], v[44:47], v[24:27]
    ds_read_b64 v[144:145], v2 offset:2944
    v_mfma_f32_16x16x32_bf16 v[28:31], v[116:119], v[48:51], v[28:31]
    ds_read_b64 v[146:147], v2 offset:2952
    v_mfma_f32_16x16x32_bf16 v[32:35], v[116:119], v[52:55], v[32:35]
    ds_read_b64 v[148:149], v2 offset:2432
    v_mfma_f32_16x16x32_bf16 v[36:39], v[116:119], v[56:59], v[36:39]
    ds_read_b64 v[150:151], v2 offset:2440
    s_waitcnt lgkmcnt(14)
    v_mfma_f32_16x16x32_bf16 v[24:27], v[120:123], v[40:43], v[24:27]
    ds_read_b64 v[152:153], v2 offset:1920
    v_mfma_f32_16x16x32_bf16 v[28:31], v[120:123], v[44:47], v[28:31]
    ds_read_b64 v[154:155], v2 offset:1928
    v_mfma_f32_16x16x32_bf16 v[32:35], v[120:123], v[48:51], v[32:35]
    ds_read_b64 v[156:157], v2 offset:1408
    v_mfma_f32_16x16x32_bf16 v[36:39], v[120:123], v[52:55], v[36:39]
    ds_read_b64 v[158:159], v2 offset:1416
    s_waitcnt lgkmcnt(14)
    v_mfma_f32_16x16x32_bf16 v[28:31], v[124:127], v[40:43], v[28:31]
    ds_read_b64 v[160:161], v2 offset:896
    v_mfma_f32_16x16x32_bf16 v[32:35], v[124:127], v[44:47], v[32:35]
    ds_read_b64 v[162:163], v2 offset:904
    v_mfma_f32_16x16x32_bf16 v[36:39], v[124:127], v[48:51], v[36:39]
    ds_read_b64 v[164:165], v2 offset:384
    s_waitcnt lgkmcnt(14)
    v_mfma_f32_16x16x32_bf16 v[32:35], v[128:131], v[40:43], v[32:35]
    ds_read_b64 v[166:167], v2 offset:392
    v_mfma_f32_16x16x32_bf16 v[36:39], v[128:131], v[44:47], v[36:39]
    s_waitcnt lgkmcnt(14)
    v_mfma_f32_16x16x32_bf16 v[36:39], v[132:135], v[40:43], v[36:39]
    s_waitcnt lgkmcnt(0)
    v_mfma_f32_16x16x32_bf16 v[8:11], v[136:139], v[72:75], v[8:11]
    ds_read_b128 v[40:43], v3 offset:64
    v_mfma_f32_16x16x32_bf16 v[12:15], v[136:139], v[76:79], v[12:15]
    ds_read_b128 v[44:47], v3 offset:576
    v_mfma_f32_16x16x32_bf16 v[16:19], v[136:139], v[80:83], v[16:19]
    ds_read_b128 v[48:51], v3 offset:1088
    v_mfma_f32_16x16x32_bf16 v[20:23], v[136:139], v[84:87], v[20:23]
    ds_read_b128 v[52:55], v3 offset:1600
    v_mfma_f32_16x16x32_bf16 v[24:27], v[136:139], v[88:91], v[24:27]
    ds_read_b128 v[56:59], v3 offset:2112
    v_mfma_f32_16x16x32_bf16 v[28:31], v[136:139], v[92:95], v[28:31]
    ds_read_b128 v[60:63], v3 offset:2624
    v_mfma_f32_16x16x32_bf16 v[32:35], v[136:139], v[96:99], v[32:35]
    ds_read_b128 v[64:67], v3 offset:3136
    v_mfma_f32_16x16x32_bf16 v[36:39], v[136:139], v[100:103], v[36:39]
    ds_read_b128 v[68:71], v3 offset:3648
    v_mfma_f32_16x16x32_bf16 v[12:15], v[140:143], v[72:75], v[12:15]
    ds_read_b64 v[104:105], v2 offset:3904
    v_mfma_f32_16x16x32_bf16 v[16:19], v[140:143], v[76:79], v[16:19]
    ds_read_b64 v[106:107], v2 offset:3912
    v_mfma_f32_16x16x32_bf16 v[20:23], v[140:143], v[80:83], v[20:23]
    ds_read_b64 v[108:109], v2 offset:3392
    v_mfma_f32_16x16x32_bf16 v[24:27], v[140:143], v[84:87], v[24:27]
    ds_read_b64 v[110:111], v2 offset:3400
    v_mfma_f32_16x16x32_bf16 v[28:31], v[140:143], v[88:91], v[28:31]
    ds_read_b64 v[112:113], v2 offset:2880
    v_mfma_f32_16x16x32_bf16 v[32:35], v[140:143], v[92:95], v[32:35]
    ds_read_b64 v[114:115], v2 offset:2888
    v_mfma_f32_16x16x32_bf16 v[36:39], v[140:143], v[96:99], v[36:39]
    ds_read_b64 v[116:117], v2 offset:2368
    v_mfma_f32_16x16x32_bf16 v[16:19], v[144:147], v[72:75], v[16:19]
    ds_read_b64 v[118:119], v2 offset:2376
    v_mfma_f32_16x16x32_bf16 v[20:23], v[144:147], v[76:79], v[20:23]
    ds_read_b64 v[120:121], v2 offset:1856
    v_mfma_f32_16x16x32_bf16 v[24:27], v[144:147], v[80:83], v[24:27]
    ds_read_b64 v[122:123], v2 offset:1864
    v_mfma_f32_16x16x32_bf16 v[28:31], v[144:147], v[84:87], v[28:31]
    ds_read_b64 v[124:125], v2 offset:1344
    v_mfma_f32_16x16x32_bf16 v[32:35], v[144:147], v[88:91], v[32:35]
    ds_read_b64 v[126:127], v2 offset:1352
    v_mfma_f32_16x16x32_bf16 v[36:39], v[144:147], v[92:95], v[36:39]
    ds_read_b64 v[128:129], v2 offset:832
    v_mfma_f32_16x16x32_bf16 v[20:23], v[148:151], v[72:75], v[20:23]
    ds_read_b64 v[130:131], v2 offset:840
    v_mfma_f32_16x16x32_bf16 v[24:27], v[148:151], v[76:79], v[24:27]
    ds_read_b64 v[132:133], v2 offset:320
    v_mfma_f32_16x16x32_bf16 v[28:31], v[148:151], v[80:83], v[28:31]
    ds_read_b64 v[134:135], v2 offset:328
    v_mfma_f32_16x16x32_bf16 v[32:35], v[148:151], v[84:87], v[32:35]
    v_mfma_f32_16x16x32_bf16 v[36:39], v[148:151], v[88:91], v[36:39]
    v_mfma_f32_16x16x32_bf16 v[24:27], v[152:155], v[72:75], v[24:27]
    v_mfma_f32_16x16x32_bf16 v[28:31], v[152:155], v[76:79], v[28:31]
    v_mfma_f32_16x16x32_bf16 v[32:35], v[152:155], v[80:83], v[32:35]
    v_mfma_f32_16x16x32_bf16 v[36:39], v[152:155], v[84:87], v[36:39]
    v_mfma_f32_16x16x32_bf16 v[28:31], v[156:159], v[72:75], v[28:31]
    v_mfma_f32_16x16x32_bf16 v[32:35], v[156:159], v[76:79], v[32:35]
    v_mfma_f32_16x16x32_bf16 v[36:39], v[156:159], v[80:83], v[36:39]
    v_mfma_f32_16x16x32_bf16 v[32:35], v[160:163], v[72:75], v[32:35]
    v_mfma_f32_16x16x32_bf16 v[36:39], v[160:163], v[76:79], v[36:39]
    v_mfma_f32_16x16x32_bf16 v[36:39], v[164:167], v[72:75], v[36:39]
    s_waitcnt lgkmcnt(0)
    v_mfma_f32_16x16x32_bf16 v[8:11], v[104:107], v[40:43], v[8:11]
    ds_read_b128 v[72:75], v3 offset:0
    v_mfma_f32_16x16x32_bf16 v[12:15], v[104:107], v[44:47], v[12:15]
    ds_read_b128 v[76:79], v3 offset:512
    v_mfma_f32_16x16x32_bf16 v[16:19], v[104:107], v[48:51], v[16:19]
    ds_read_b128 v[80:83], v3 offset:1024
    v_mfma_f32_16x16x32_bf16 v[20:23], v[104:107], v[52:55], v[20:23]
    ds_read_b128 v[84:87], v3 offset:1536
    v_mfma_f32_16x16x32_bf16 v[24:27], v[104:107], v[56:59], v[24:27]
    ds_read_b128 v[88:91], v3 offset:2048
    v_mfma_f32_16x16x32_bf16 v[28:31], v[104:107], v[60:63], v[28:31]
    ds_read_b128 v[92:95], v3 offset:2560
    v_mfma_f32_16x16x32_bf16 v[32:35], v[104:107], v[64:67], v[32:35]
    ds_read_b128 v[96:99], v3 offset:3072
    v_mfma_f32_16x16x32_bf16 v[36:39], v[104:107], v[68:71], v[36:39]
    ds_read_b128 v[100:103], v3 offset:3584
    v_mfma_f32_16x16x32_bf16 v[12:15], v[108:111], v[40:43], v[12:15]
    ds_read_b64 v[136:137], v2 offset:3840
    v_mfma_f32_16x16x32_bf16 v[16:19], v[108:111], v[44:47], v[16:19]
    ds_read_b64 v[138:139], v2 offset:3848
    v_mfma_f32_16x16x32_bf16 v[20:23], v[108:111], v[48:51], v[20:23]
    ds_read_b64 v[140:141], v2 offset:3328
    v_mfma_f32_16x16x32_bf16 v[24:27], v[108:111], v[52:55], v[24:27]
    ds_read_b64 v[142:143], v2 offset:3336
    v_mfma_f32_16x16x32_bf16 v[28:31], v[108:111], v[56:59], v[28:31]
    ds_read_b64 v[144:145], v2 offset:2816
    v_mfma_f32_16x16x32_bf16 v[32:35], v[108:111], v[60:63], v[32:35]
    ds_read_b64 v[146:147], v2 offset:2824
    v_mfma_f32_16x16x32_bf16 v[36:39], v[108:111], v[64:67], v[36:39]
    ds_read_b64 v[148:149], v2 offset:2304
    v_mfma_f32_16x16x32_bf16 v[16:19], v[112:115], v[40:43], v[16:19]
    ds_read_b64 v[150:151], v2 offset:2312
    v_mfma_f32_16x16x32_bf16 v[20:23], v[112:115], v[44:47], v[20:23]
    ds_read_b64 v[152:153], v2 offset:1792
    v_mfma_f32_16x16x32_bf16 v[24:27], v[112:115], v[48:51], v[24:27]
    ds_read_b64 v[154:155], v2 offset:1800
    v_mfma_f32_16x16x32_bf16 v[28:31], v[112:115], v[52:55], v[28:31]
    ds_read_b64 v[156:157], v2 offset:1280
    v_mfma_f32_16x16x32_bf16 v[32:35], v[112:115], v[56:59], v[32:35]
    ds_read_b64 v[158:159], v2 offset:1288
    v_mfma_f32_16x16x32_bf16 v[36:39], v[112:115], v[60:63], v[36:39]
    ds_read_b64 v[160:161], v2 offset:768
    v_mfma_f32_16x16x32_bf16 v[20:23], v[116:119], v[40:43], v[20:23]
    ds_read_b64 v[162:163], v2 offset:776
    v_mfma_f32_16x16x32_bf16 v[24:27], v[116:119], v[44:47], v[24:27]
    ds_read_b64 v[164:165], v2 offset:256
    v_mfma_f32_16x16x32_bf16 v[28:31], v[116:119], v[48:51], v[28:31]
    ds_read_b64 v[166:167], v2 offset:264
    v_mfma_f32_16x16x32_bf16 v[32:35], v[116:119], v[52:55], v[32:35]
    v_mfma_f32_16x16x32_bf16 v[36:39], v[116:119], v[56:59], v[36:39]
    v_mfma_f32_16x16x32_bf16 v[24:27], v[120:123], v[40:43], v[24:27]
    v_mfma_f32_16x16x32_bf16 v[28:31], v[120:123], v[44:47], v[28:31]
    v_mfma_f32_16x16x32_bf16 v[32:35], v[120:123], v[48:51], v[32:35]
    v_mfma_f32_16x16x32_bf16 v[36:39], v[120:123], v[52:55], v[36:39]
    v_mfma_f32_16x16x32_bf16 v[28:31], v[124:127], v[40:43], v[28:31]
    v_mfma_f32_16x16x32_bf16 v[32:35], v[124:127], v[44:47], v[32:35]
    v_mfma_f32_16x16x32_bf16 v[36:39], v[124:127], v[48:51], v[36:39]
    v_mfma_f32_16x16x32_bf16 v[32:35], v[128:131], v[40:43], v[32:35]
    v_mfma_f32_16x16x32_bf16 v[36:39], v[128:131], v[44:47], v[36:39]
    v_mfma_f32_16x16x32_bf16 v[36:39], v[132:135], v[40:43], v[36:39]
    s_waitcnt lgkmcnt(0)
    v_mfma_f32_16x16x32_bf16 v[8:11], v[136:139], v[72:75], v[8:11]
    v_mfma_f32_16x16x32_bf16 v[12:15], v[136:139], v[76:79], v[12:15]
    v_mfma_f32_16x16x32_bf16 v[16:19], v[136:139], v[80:83], v[16:19]
    v_mfma_f32_16x16x32_bf16 v[20:23], v[136:139], v[84:87], v[20:23]
    v_mfma_f32_16x16x32_bf16 v[24:27], v[136:139], v[88:91], v[24:27]
    v_mfma_f32_16x16x32_bf16 v[28:31], v[136:139], v[92:95], v[28:31]
    v_mfma_f32_16x16x32_bf16 v[32:35], v[136:139], v[96:99], v[32:35]
    v_mfma_f32_16x16x32_bf16 v[36:39], v[136:139], v[100:103], v[36:39]
    v_mfma_f32_16x16x32_bf16 v[12:15], v[140:143], v[72:75], v[12:15]
    v_mfma_f32_16x16x32_bf16 v[16:19], v[140:143], v[76:79], v[16:19]
    v_mfma_f32_16x16x32_bf16 v[20:23], v[140:143], v[80:83], v[20:23]
    v_mfma_f32_16x16x32_bf16 v[24:27], v[140:143], v[84:87], v[24:27]
    v_mfma_f32_16x16x32_bf16 v[28:31], v[140:143], v[88:91], v[28:31]
    v_mfma_f32_16x16x32_bf16 v[32:35], v[140:143], v[92:95], v[32:35]
    v_mfma_f32_16x16x32_bf16 v[36:39], v[140:143], v[96:99], v[36:39]
    v_mfma_f32_16x16x32_bf16 v[16:19], v[144:147], v[72:75], v[16:19]
    v_mfma_f32_16x16x32_bf16 v[20:23], v[144:147], v[76:79], v[20:23]
    v_mfma_f32_16x16x32_bf16 v[24:27], v[144:147], v[80:83], v[24:27]
    v_mfma_f32_16x16x32_bf16 v[28:31], v[144:147], v[84:87], v[28:31]
    v_mfma_f32_16x16x32_bf16 v[32:35], v[144:147], v[88:91], v[32:35]
    v_mfma_f32_16x16x32_bf16 v[36:39], v[144:147], v[92:95], v[36:39]
    v_mfma_f32_16x16x32_bf16 v[20:23], v[148:151], v[72:75], v[20:23]
    v_mfma_f32_16x16x32_bf16 v[24:27], v[148:151], v[76:79], v[24:27]
    v_mfma_f32_16x16x32_bf16 v[28:31], v[148:151], v[80:83], v[28:31]
    v_mfma_f32_16x16x32_bf16 v[32:35], v[148:151], v[84:87], v[32:35]
    v_mfma_f32_16x16x32_bf16 v[36:39], v[148:151], v[88:91], v[36:39]
    v_mfma_f32_16x16x32_bf16 v[24:27], v[152:155], v[72:75], v[24:27]
    v_mfma_f32_16x16x32_bf16 v[28:31], v[152:155], v[76:79], v[28:31]
    v_mfma_f32_16x16x32_bf16 v[32:35], v[152:155], v[80:83], v[32:35]
    v_mfma_f32_16x16x32_bf16 v[36:39], v[152:155], v[84:87], v[36:39]
    v_mfma_f32_16x16x32_bf16 v[28:31], v[156:159], v[72:75], v[28:31]
    v_mfma_f32_16x16x32_bf16 v[32:35], v[156:159], v[76:79], v[32:35]
    v_mfma_f32_16x16x32_bf16 v[36:39], v[156:159], v[80:83], v[36:39]
    v_mfma_f32_16x16x32_bf16 v[32:35], v[160:163], v[72:75], v[32:35]
    v_mfma_f32_16x16x32_bf16 v[36:39], v[160:163], v[76:79], v[36:39]
    v_mfma_f32_16x16x32_bf16 v[36:39], v[164:167], v[72:75], v[36:39]
    v_add_u32 v48, s50, v4
    v_add_u32 v49, s51, v4
    ds_read_b64 v[80:81], v48 offset:34304
    ds_read_b64 v[88:89], v49 offset:43008
    ds_read_b64 v[82:83], v48 offset:34816
    ds_read_b64 v[90:91], v49 offset:43520
    ds_read_b64 v[84:85], v48 offset:35328
    ds_read_b64 v[92:93], v49 offset:44032
    ds_read_b64 v[86:87], v48 offset:35840
    ds_read_b64 v[94:95], v49 offset:44544
    v_lshl_add_u32 v44, v6, 4, s52
    v_mov_b32 v50, s53
    v_mov_b32 v51, 1
    s_cmp_eq_u32 s43, 0
    s_cbranch_scc0 L_cv_h1
    ds_write_b128 v44, v[24:27] offset:51200
    ds_write_b128 v44, v[28:31] offset:52224
    ds_write_b128 v44, v[32:35] offset:53248
    ds_write_b128 v44, v[36:39] offset:54272
    ds_write_b32 v50, v51
    s_waitcnt lgkmcnt(5)
    v_lshlrev_b32 v112, 16, v80
    v_and_b32 v113, 0xffff0000, v80
    v_lshlrev_b32 v114, 16, v81
    v_and_b32 v115, 0xffff0000, v81
    v_pk_fma_f32 v[56:57], v[112:113], s[46:47], v[8:9] op_sel_hi:[1,0,1]
    v_pk_fma_f32 v[58:59], v[114:115], s[46:47], v[10:11] op_sel_hi:[1,0,1]
    v_lshlrev_b32 v112, 16, v82
    v_and_b32 v113, 0xffff0000, v82
    v_lshlrev_b32 v114, 16, v83
    v_and_b32 v115, 0xffff0000, v83
    v_pk_fma_f32 v[60:61], v[112:113], s[46:47], v[12:13] op_sel_hi:[1,0,1]
    v_pk_fma_f32 v[62:63], v[114:115], s[46:47], v[14:15] op_sel_hi:[1,0,1]
    v_lshlrev_b32 v112, 16, v84
    v_and_b32 v113, 0xffff0000, v84
    v_lshlrev_b32 v114, 16, v85
    v_and_b32 v115, 0xffff0000, v85
    v_pk_fma_f32 v[64:65], v[112:113], s[46:47], v[16:17] op_sel_hi:[1,0,1]
    v_pk_fma_f32 v[66:67], v[114:115], s[46:47], v[18:19] op_sel_hi:[1,0,1]
    v_lshlrev_b32 v112, 16, v86
    v_and_b32 v113, 0xffff0000, v86
    v_lshlrev_b32 v114, 16, v87
    v_and_b32 v115, 0xffff0000, v87
    v_pk_fma_f32 v[68:69], v[112:113], s[46:47], v[20:21] op_sel_hi:[1,0,1]
    v_pk_fma_f32 v[70:71], v[114:115], s[46:47], v[22:23] op_sel_hi:[1,0,1]
    s_branch L_cv_h2
L_cv_h1:
    ds_write_b128 v44, v[8:11] offset:51200
    ds_write_b128 v44, v[12:15] offset:52224
    ds_write_b128 v44, v[16:19] offset:53248
    ds_write_b128 v44, v[20:23] offset:54272
    ds_write_b32 v50, v51
    s_waitcnt lgkmcnt(5)
    v_lshlrev_b32 v112, 16, v80
    v_and_b32 v113, 0xffff0000, v80
    v_lshlrev_b32 v114, 16, v81
    v_and_b32 v115, 0xffff0000, v81
    v_pk_fma_f32 v[56:57], v[112:113], s[46:47], v[24:25] op_sel_hi:[1,0,1]
    v_pk_fma_f32 v[58:59], v[114:115], s[46:47], v[26:27] op_sel_hi:[1,0,1]
    v_lshlrev_b32 v112, 16, v82
    v_and_b32 v113, 0xffff0000, v82
    v_lshlrev_b32 v114, 16, v83
    v_and_b32 v115, 0xffff0000, v83
    v_pk_fma_f32 v[60:61], v[112:113], s[46:47], v[28:29] op_sel_hi:[1,0,1]
    v_pk_fma_f32 v[62:63], v[114:115], s[46:47], v[30:31] op_sel_hi:[1,0,1]
    v_lshlrev_b32 v112, 16, v84
    v_and_b32 v113, 0xffff0000, v84
    v_lshlrev_b32 v114, 16, v85
    v_and_b32 v115, 0xffff0000, v85
    v_pk_fma_f32 v[64:65], v[112:113], s[46:47], v[32:33] op_sel_hi:[1,0,1]
    v_pk_fma_f32 v[66:67], v[114:115], s[46:47], v[34:35] op_sel_hi:[1,0,1]
    v_lshlrev_b32 v112, 16, v86
    v_and_b32 v113, 0xffff0000, v86
    v_lshlrev_b32 v114, 16, v87
    v_and_b32 v115, 0xffff0000, v87
    v_pk_fma_f32 v[68:69], v[112:113], s[46:47], v[36:37] op_sel_hi:[1,0,1]
    v_pk_fma_f32 v[70:71], v[114:115], s[46:47], v[38:39] op_sel_hi:[1,0,1]
L_cv_h2:
    v_xor_b32 v45, 0x1000, v44
    v_mov_b32 v50, s54
    v_mov_b32 v113, 16
    v_mov_b32 v46, s55
    s_mov_b32 s47, 0
    v_lshlrev_b32 v136, 16, v88
    v_and_b32 v137, 0xffff0000, v88
    v_lshlrev_b32 v138, 16, v89
    v_and_b32 v139, 0xffff0000, v89
    v_lshlrev_b32 v140, 16, v90
    v_and_b32 v141, 0xffff0000, v90
    v_lshlrev_b32 v142, 16, v91
    v_and_b32 v143, 0xffff0000, v91
    v_lshlrev_b32 v144, 16, v92
    v_and_b32 v145, 0xffff0000, v92
    v_lshlrev_b32 v146, 16, v93
    v_and_b32 v147, 0xffff0000, v93
    v_lshlrev_b32 v148, 16, v94
    v_and_b32 v149, 0xffff0000, v94
    v_lshlrev_b32 v150, 16, v95
    v_and_b32 v151, 0xffff0000, v95
L_cv_spin:
    ds_read_b32 v51, v50
    ds_read_b32 v112, v113
    ds_read_b32 v47, v46
    ds_read_b32 v52, v46 offset:16
    ds_read_b128 v[96:99], v45 offset:51200
    ds_read_b128 v[100:103], v45 offset:52224
    ds_read_b128 v[104:107], v45 offset:53248
    ds_read_b128 v[108:111], v45 offset:54272
    s_waitcnt lgkmcnt(6)
    v_and_b32 v51, v51, v112
    s_nop 0
    v_readfirstlane_b32 s49, v51
    s_add_u32 s47, s47, 1
    s_cmp_eq_u32 s49, 1
    s_cbranch_scc1 L_cv_go
    s_waitcnt lgkmcnt(0)
    s_cmp_lt_u32 s47, 512000
    s_cbranch_scc1 L_cv_spin
L_cv_go:
    s_waitcnt lgkmcnt(3)
    v_pk_add_f32 v[56:57], v[56:57], v[96:97]
    v_pk_add_f32 v[58:59], v[58:59], v[98:99]
    v_pk_fma_f32 v[136:137], v[56:57], v[46:47], v[136:137] op_sel:[0,1,0] op_sel_hi:[1,1,1]
    v_pk_fma_f32 v[138:139], v[58:59], v[46:47], v[138:139] op_sel:[0,1,0] op_sel_hi:[1,1,1]
    v_pk_mul_f32 v[116:117], v[136:137], v[52:53] op_sel_hi:[1,0]
    v_pk_mul_f32 v[118:119], v[138:139], v[52:53] op_sel_hi:[1,0]
    v_cvt_pk_bf16_f32 v128, v116, v117
    v_cvt_pk_bf16_f32 v129, v118, v119
    s_waitcnt lgkmcnt(2)
    v_pk_add_f32 v[60:61], v[60:61], v[100:101]
    v_pk_add_f32 v[62:63], v[62:63], v[102:103]
    v_pk_fma_f32 v[140:141], v[60:61], v[46:47], v[140:141] op_sel:[0,1,0] op_sel_hi:[1,1,1]
    v_pk_fma_f32 v[142:143], v[62:63], v[46:47], v[142:143] op_sel:[0,1,0] op_sel_hi:[1,1,1]
    v_pk_mul_f32 v[116:117], v[140:141], v[52:53] op_sel_hi:[1,0]
    v_pk_mul_f32 v[118:119], v[142:143], v[52:53] op_sel_hi:[1,0]
    v_cvt_pk_bf16_f32 v130, v116, v117
    v_cvt_pk_bf16_f32 v131, v118, v119
    s_nop 0
    v_permlane16_swap_b32 v128, v130
    v_permlane16_swap_b32 v129, v131
    buffer_store_dwordx4 v[128:131], v5, s[68:71], s44 offen offset:0 sc1
    s_waitcnt lgkmcnt(1)
    v_pk_add_f32 v[64:65], v[64:65], v[104:105]
    v_pk_add_f32 v[66:67], v[66:67], v[106:107]
    v_pk_fma_f32 v[144:145], v[64:65], v[46:47], v[144:145] op_sel:[0,1,0] op_sel_hi:[1,1,1]
    v_pk_fma_f32 v[146:147], v[66:67], v[46:47], v[146:147] op_sel:[0,1,0] op_sel_hi:[1,1,1]
    v_pk_mul_f32 v[116:117], v[144:145], v[52:53] op_sel_hi:[1,0]
    v_pk_mul_f32 v[118:119], v[146:147], v[52:53] op_sel_hi:[1,0]
    v_cvt_pk_bf16_f32 v132, v116, v117
    v_cvt_pk_bf16_f32 v133, v118, v119
    s_waitcnt lgkmcnt(0)
    v_pk_add_f32 v[68:69], v[68:69], v[108:109]
    v_pk_add_f32 v[70:71], v[70:71], v[110:111]
    v_pk_fma_f32 v[148:149], v[68:69], v[46:47], v[148:149] op_sel:[0,1,0] op_sel_hi:[1,1,1]
    v_pk_fma_f32 v[150:151], v[70:71], v[46:47], v[150:151] op_sel:[0,1,0] op_sel_hi:[1,1,1]
    v_pk_mul_f32 v[116:117], v[148:149], v[52:53] op_sel_hi:[1,0]
    v_pk_mul_f32 v[118:119], v[150:151], v[52:53] op_sel_hi:[1,0]
    v_cvt_pk_bf16_f32 v134, v116, v117
    v_cvt_pk_bf16_f32 v135, v118, v119
    s_nop 0
    v_permlane16_swap_b32 v132, v134
    v_permlane16_swap_b32 v133, v135
    buffer_store_dwordx4 v[132:135], v5, s[68:71], s44 offen offset:1024 sc1
    v_cvt_pk_bf16_f32 v120, v136, v137
    v_cvt_pk_bf16_f32 v121, v138, v139
    v_cvt_pk_bf16_f32 v122, v140, v141
    v_cvt_pk_bf16_f32 v123, v142, v143
    s_nop 0
    v_permlane16_swap_b32 v120, v122
    v_permlane16_swap_b32 v121, v123
    buffer_store_dwordx4 v[120:123], v5, s[68:71], s45 offen offset:0 sc1
    v_cvt_pk_bf16_f32 v124, v144, v145
    v_cvt_pk_bf16_f32 v125, v146, v147
    v_cvt_pk_bf16_f32 v126, v148, v149
    v_cvt_pk_bf16_f32 v127, v150, v151
    s_nop 0
    v_permlane16_swap_b32 v124, v126
    v_permlane16_swap_b32 v125, v127
    buffer_store_dwordx4 v[124:127], v5, s[68:71], s45 offen offset:1024 sc1
    s_branch L_k12_end
L_side:
    s_and_b32 s60, s2, 7
    s_mul_i32 s60, s60, 22
    s_lshr_b32 s61, s2, 3
    s_add_u32 s62, s60, s61
    s_cmp_lt_u32 s61, 22
    s_cselect_b32 s62, s62, 999
    s_lshr_b32 s60, s62, 2
    s_and_b32 s61, s62, 3
    s_cmp_lt_u32 s62, 172
    s_cbranch_scc0 L_side_b3
    s_sub_u32 s42, s40, 4
    s_and_b32 s43, s42, 1
    s_lshr_b32 s44, s42, 1
    s_cmp_eq_u32 s43, 0
    s_cselect_b32 s64, s20, s22
    s_cselect_b32 s65, s21, s23
    s_mov_b32 s68, s64
    s_and_b32 s69, s65, 0xffff
    s_mov_b32 s70, 0x158000
    s_mov_b32 s71, 0x00020000
    s_mul_i32 s66, s43, 8224
    s_lshl_b32 s67, s44, 12
    s_add_u32 s66, s66, s67
    s_add_u32 s66, s66, 135680
    v_lshrrev_b32 v60, 2, v1
    v_mul_u32_u24 v60, 2752, v60
    v_and_b32 v61, 3, v1
    v_lshl_add_u32 v60, v61, 4, v60
    s_lshl_b32 s64, s61, 1
    s_add_u32 s64, s64, s44
    s_mul_i32 s64, s64, 176128
    s_lshl_b32 s65, s60, 6
    s_add_u32 s64, s64, s65
    v_mov_b32 v10, 72
    s_mov_b32 s57, 0
L_lw_wgd:
    ds_read_b32 v11, v10
    s_waitcnt lgkmcnt(0)
    v_readfirstlane_b32 s56, v11
    s_add_u32 s57, s57, 1
    s_cmp_ge_u32 s56, 4
    s_cbranch_scc1 L_lx_wgd
    s_sleep 2
    s_cmp_lt_u32 s57, 64000
    s_cbranch_scc1 L_lw_wgd
L_lx_wgd:
    s_mov_b32 m0, s66
    s_nop 0
    buffer_load_dwordx4 v60, s[68:71], s64 offen lds
    s_add_u32 s66, s66, 1024
    s_add_u32 s64, s64, 44032
    s_mov_b32 m0, s66
    s_nop 0
    buffer_load_dwordx4 v60, s[68:71], s64 offen lds
    s_add_u32 s66, s66, 1024
    s_add_u32 s64, s64, 44032
    s_mov_b32 m0, s66
    s_nop 0
    buffer_load_dwordx4 v60, s[68:71], s64 offen lds
    s_add_u32 s66, s66, 1024
    s_add_u32 s64, s64, 44032
    s_mov_b32 m0, s66
    s_nop 0
    buffer_load_dwordx4 v60, s[68:71], s64 offen lds
L_side_b3:
    s_waitcnt lgkmcnt(0)
    s_barrier
    s_cmp_lt_u32 s62, 172
    s_cbranch_scc0 L_k12_end
    s_sub_u32 s42, s40, 4
    s_lshl_b32 s45, s60, 1
    s_add_u32 s45, s45, s43
    s_mul_i32 s54, s42, 832
    s_add_u32 s54, s54, 152128
    s_add_u32 s64, s34, 0x620000
    s_addc_u32 s65, s35, 0
    s_and_b32 s65, s65, 0xffff
    s_mov_b32 s66, 0x2e6800
    s_mov_b32 s67, 0x00020000
    v_and_b32 v24, 31, v1
    v_lshl_add_u32 v5, v24, 3, s54
    v_lshrrev_b32 v6, 3, v24
    v_lshlrev_b32 v6, 5, v6
    v_bfe_u32 v11, v24, 1, 1
    v_lshl_add_u32 v6, v11, 4, v6
    v_and_b32 v11, 1, v24
    v_bfe_u32 v12, v24, 2, 1
    v_lshl_add_u32 v11, v12, 1, v11
    v_lshl_add_u32 v6, v11, 2, v6
    v_add_u32 v6, s54, v6
    v_mov_b32 v12, 0
    v_mov_b32 v13, 0
    v_mov_b32 v14, 0
    v_mov_b32 v15, 0
    v_mov_b32 v26, s54
    ds_write_b128 v26, v[12:15] offset:512
    v_add_u32 v26, 512, v26
    v_lshrrev_b32 v18, 4, v1
    v_and_b32 v19, 1, v18
    v_lshrrev_b32 v18, 1, v18
    v_and_b32 v20, 15, v1
    v_lshrrev_b32 v21, 2, v20
    v_lshl_add_u32 v21, v18, 2, v21
    v_lshlrev_b32 v21, 6, v21
    v_mul_u32_u24 v19, 8224, v19
    v_add_u32 v21, v19, v21
    v_and_b32 v20, 3, v20
    v_lshl_add_u32 v21, v20, 3, v21
    s_lshl_b32 s46, s43, 5
    s_lshl_b32 s47, s44, 12
    s_add_u32 s46, s46, s47
    s_add_u32 s46, s46, 135680
    v_add_u32 v21, s46, v21
    v_lshrrev_b32 v22, 5, v1
    v_lshl_add_u32 v23, v22, 4, s54
    v_lshlrev_b32 v25, 7, v24
    v_lshl_add_u32 v25, v22, 4, v25
    s_add_u32 s46, s54, 256
    v_add_u32 v25, s46, v25
    v_cmp_gt_u32 vcc, 2, v24
    s_mul_i32 s46, s45, 43
    s_lshr_b32 s46, s46, 8
    s_mul_i32 s47, s46, 6
    s_sub_u32 s47, s45, s47
    s_lshl_b32 s47, s47, 11
    s_mul_i32 s46, s46, 196608
    s_add_u32 s47, s47, s46
    s_lshl_b32 s46, s61, 1
    s_add_u32 s46, s46, s44
    s_mul_i32 s46, s46, 24576
    s_add_u32 s47, s47, s46
    s_lshl_b32 s46, s45, 10
    s_add_u32 s46, s46, 2949120
    v_lshlrev_b32 v27, 4, v1
    v_add_u32 v28, 0, v25
    v_cndmask_b32 v28, v26, v28, vcc
    v_add_u32 v29, 32, v25
    v_cndmask_b32 v29, v26, v29, vcc
    v_add_u32 v30, 64, v25
    v_cndmask_b32 v30, v26, v30, vcc
    v_add_u32 v31, 96, v25
    v_cndmask_b32 v31, v26, v31, vcc
    s_add_u32 s48, s34, 0x1000000
    s_addc_u32 s49, s35, 0
    s_and_b32 s49, s49, 0xffff
    s_mov_b32 s50, 0x500000
    s_mov_b32 s51, 0x00020000
    v_mov_b32 v10, 163328
    ds_read_b32 v11, v10
    v_and_b32 v4, 31, v1
    v_lshlrev_b32 v4, 4, v4
    s_lshl_b32 s52, s61, 1
    s_add_u32 s52, s52, s44
    s_lshl_b32 s52, s52, 9
    s_add_u32 s52, s52, 45056
    s_waitcnt lgkmcnt(0)
    v_readfirstlane_b32 s59, v11
    s_mov_b32 s57, 255
    s_mov_b32 s58, 0
L_pe_wp:
    s_bitcmp1_b32 s57, 0
    s_cbranch_scc0 L_pe_wp_0
    s_add_u32 s53, s52, 0
    buffer_load_dwordx4 v[32:35], v4, s[48:51], s53 offen sc1
L_pe_wp_0:
    s_bitcmp1_b32 s57, 1
    s_cbranch_scc0 L_pe_wp_1
    s_add_u32 s53, s52, 4096
    buffer_load_dwordx4 v[48:51], v4, s[48:51], s53 offen sc1
L_pe_wp_1:
    s_bitcmp1_b32 s57, 2
    s_cbranch_scc0 L_pe_wp_2
    s_add_u32 s53, s52, 24576
    buffer_load_dwordx4 v[36:39], v4, s[48:51], s53 offen sc1
L_pe_wp_2:
    s_bitcmp1_b32 s57, 3
    s_cbranch_scc0 L_pe_wp_3
    s_add_u32 s53, s52, 28672
    buffer_load_dwordx4 v[52:55], v4, s[48:51], s53 offen sc1
L_pe_wp_3:
    s_bitcmp1_b32 s57, 4
    s_cbranch_scc0 L_pe_wp_4
    s_add_u32 s53, s52, 49152
    buffer_load_dwordx4 v[40:43], v4, s[48:51], s53 offen sc1
L_pe_wp_4:
    s_bitcmp1_b32 s57, 5
    s_cbranch_scc0 L_pe_wp_5
    s_add_u32 s53, s52, 53248
    buffer_load_dwordx4 v[56:59], v4, s[48:51], s53 offen sc1
L_pe_wp_5:
    s_bitcmp1_b32 s57, 6
    s_cbranch_scc0 L_pe_wp_6
    s_add_u32 s53, s52, 73728
    buffer_load_dwordx4 v[44:47], v4, s[48:51], s53 offen sc1
L_pe_wp_6:
    s_bitcmp1_b32 s57, 7
    s_cbranch_scc0 L_pe_wp_7
    s_add_u32 s53, s52, 77824
    buffer_load_dwordx4 v[60:63], v4, s[48:51], s53 offen sc1
L_pe_wp_7:
    s_waitcnt vmcnt(0)
    s_mov_b32 s57, 0
    v_sad_u32 v64, v33, s59, 0
    v_sad_u32 v65, v35, s59, 0
    v_sad_u32 v64, v49, s59, v64
    v_sad_u32 v65, v51, s59, v65
    v_sad_u32 v64, v37, s59, v64
    v_sad_u32 v65, v39, s59, v65
    v_sad_u32 v64, v53, s59, v64
    v_sad_u32 v65, v55, s59, v65
    v_sad_u32 v64, v41, s59, v64
    v_sad_u32 v65, v43, s59, v65
    v_sad_u32 v64, v57, s59, v64
    v_sad_u32 v65, v59, s59, v65
    v_sad_u32 v64, v45, s59, v64
    v_sad_u32 v65, v47, s59, v65
    v_sad_u32 v64, v61, s59, v64
    v_sad_u32 v65, v63, s59, v65
    v_or_b32 v64, v64, v65
    v_cmp_ne_u32 vcc, 0, v64
    s_cmp_eq_u64 vcc, 0
    s_cbranch_scc1 L_ps_wp
    v_sad_u32 v64, v33, s59, 0
    v_sad_u32 v64, v35, s59, v64
    v_cmp_ne_u32 vcc, 0, v64
    s_cmp_lg_u64 vcc, 0
    s_cselect_b32 s56, 1, 0
    s_or_b32 s57, s57, s56
    v_sad_u32 v65, v49, s59, 0
    v_sad_u32 v65, v51, s59, v65
    v_cmp_ne_u32 vcc, 0, v65
    s_cmp_lg_u64 vcc, 0
    s_cselect_b32 s56, 2, 0
    s_or_b32 s57, s57, s56
    v_sad_u32 v64, v37, s59, 0
    v_sad_u32 v64, v39, s59, v64
    v_cmp_ne_u32 vcc, 0, v64
    s_cmp_lg_u64 vcc, 0
    s_cselect_b32 s56, 4, 0
    s_or_b32 s57, s57, s56
    v_sad_u32 v65, v53, s59, 0
    v_sad_u32 v65, v55, s59, v65
    v_cmp_ne_u32 vcc, 0, v65
    s_cmp_lg_u64 vcc, 0
    s_cselect_b32 s56, 8, 0
    s_or_b32 s57, s57, s56
    v_sad_u32 v64, v41, s59, 0
    v_sad_u32 v64, v43, s59, v64
    v_cmp_ne_u32 vcc, 0, v64
    s_cmp_lg_u64 vcc, 0
    s_cselect_b32 s56, 16, 0
    s_or_b32 s57, s57, s56
    v_sad_u32 v65, v57, s59, 0
    v_sad_u32 v65, v59, s59, v65
    v_cmp_ne_u32 vcc, 0, v65
    s_cmp_lg_u64 vcc, 0
    s_cselect_b32 s56, 32, 0
    s_or_b32 s57, s57, s56
    v_sad_u32 v64, v45, s59, 0
    v_sad_u32 v64, v47, s59, v64
    v_cmp_ne_u32 vcc, 0, v64
    s_cmp_lg_u64 vcc, 0
    s_cselect_b32 s56, 64, 0
    s_or_b32 s57, s57, s56
    v_sad_u32 v65, v61, s59, 0
    v_sad_u32 v65, v63, s59, v65
    v_cmp_ne_u32 vcc, 0, v65
    s_cmp_lg_u64 vcc, 0
    s_cselect_b32 s56, 128, 0
    s_or_b32 s57, s57, s56
    s_cmp_eq_u32 s57, 0
    s_cbranch_scc1 L_ps_wp
    s_sleep 8
    s_add_u32 s58, s58, 1
    s_cmp_lt_u32 s58, 8000
    s_cbranch_scc1 L_pe_wp
L_ps_wp:
    v_add_f32 v32, v32, v36
    v_add_f32 v34, v34, v38
    v_add_f32 v40, v40, v44
    v_add_f32 v42, v42, v46
    v_add_f32 v32, v32, v40
    v_add_f32 v34, v34, v42
    v_add_f32 v48, v48, v52
    v_add_f32 v50, v50, v54
    v_add_f32 v56, v56, v60
    v_add_f32 v58, v58, v62
    v_add_f32 v48, v48, v56
    v_add_f32 v50, v50, v58
    v_mov_b32 v36, v32
    v_mov_b32 v38, v34
    v_cvt_pk_bf16_f32 v40, v36, v38
    v_lshlrev_b32 v36, 16, v40
    v_and_b32 v38, 0xffff0000, v40
    v_cvt_pk_bf16_f32 v40, v48, v50
    v_lshlrev_b32 v32, 16, v40
    v_and_b32 v34, 0xffff0000, v40
    v_add_f32 v8, 1.0, v32
    v_add_f32 v9, 1.0, v34
    v_cvt_pk_bf16_f32 v16, v8, v9
    v_cvt_pk_bf16_f32 v17, v36, v38
    v_lshlrev_b32 v8, 16, v16
    v_and_b32 v9, 0xffff0000, v16
    ds_write_b32 v6, v16 offset:256
    ds_write_b32 v6, v17 offset:384
    v_mov_b32 v66, 163380
    v_mov_b32 v67, 1
    s_mov_b64 exec, 1
    ds_add_u32 v66, v67
    s_mov_b64 exec, -1
    s_mov_b32 s57, 0
L_ls_wp:
    ds_read_b32 v67, v66
    s_waitcnt lgkmcnt(0)
    v_readfirstlane_b32 s56, v67
    s_add_u32 s57, s57, 1
    s_cmp_ge_u32 s56, 4
    s_cbranch_scc1 L_lg_wp
    s_cmp_lt_u32 s57, 128000
    s_cbranch_scc1 L_ls_wp
L_lg_wp:
    ds_read_b64_tr_b16 v[32:33], v21 offset:0
    ds_read_b64_tr_b16 v[34:35], v21 offset:512
    ds_read_b128 v[80:83], v28
    ds_read_b64_tr_b16 v[36:37], v21 offset:1024
    ds_read_b64_tr_b16 v[38:39], v21 offset:1536
    ds_read_b128 v[84:87], v29
    ds_read_b64_tr_b16 v[40:41], v21 offset:2048
    ds_read_b64_tr_b16 v[42:43], v21 offset:2560
    ds_read_b128 v[88:91], v30
    ds_read_b64_tr_b16 v[44:45], v21 offset:3072
    ds_read_b64_tr_b16 v[46:47], v21 offset:3584
    ds_read_b128 v[92:95], v31
    s_waitcnt lgkmcnt(9)
    v_mfma_f32_32x32x16_bf16 v[96:111], v[32:35], v[80:83], 0
    s_waitcnt lgkmcnt(6)
    v_mfma_f32_32x32x16_bf16 v[96:111], v[36:39], v[84:87], v[96:111]
    s_waitcnt lgkmcnt(3)
    v_mfma_f32_32x32x16_bf16 v[96:111], v[40:43], v[88:91], v[96:111]
    s_waitcnt lgkmcnt(0)
    v_mfma_f32_32x32x16_bf16 v[96:111], v[44:47], v[92:95], v[96:111]
    s_add_u32 s56, s54, 576
    v_lshlrev_b32 v28, 7, v24
    v_lshl_add_u32 v28, v22, 4, v28
    v_add_u32 v28, s56, v28
    v_cmp_gt_u32 vcc, 2, v24
    s_and_saveexec_b64 s[38:39], vcc
    s_nop 5
    ds_write_b128 v28, v[96:99] offset:0
    ds_write_b128 v28, v[100:103] offset:32
    ds_write_b128 v28, v[104:107] offset:64
    ds_write_b128 v28, v[108:111] offset:96
    s_mov_b64 exec, s[38:39]
    v_mov_b32 v66, 163388
    v_mov_b32 v67, 1
    s_mov_b64 exec, 1
    ds_add_u32 v66, v67
    s_mov_b64 exec, -1
    s_mov_b32 s59, 0
L_ls_wq:
    ds_read_b32 v67, v66
    s_waitcnt lgkmcnt(0)
    v_readfirstlane_b32 s58, v67
    s_add_u32 s59, s59, 1
    s_cmp_ge_u32 s58, 4
    s_cbranch_scc1 L_lg_wq
    s_cmp_lt_u32 s59, 128000
    s_cbranch_scc1 L_ls_wq
L_lg_wq:
    s_cmp_eq_u32 s44, 0
    s_cbranch_scc0 L_k12_end
    v_lshlrev_b32 v28, 2, v24
    v_add_u32 v28, s56, v28
    ds_read_b32 v32, v28
    ds_read_b32 v33, v28 offset:128
    ds_read_b32 v34, v28 offset:1664
    ds_read_b32 v35, v28 offset:1792
    s_waitcnt lgkmcnt(0)
    v_add_f32 v32, v32, v34
    v_add_f32 v33, v33, v35
    v_cvt_pk_bf16_f32 v34, v32, v33
    v_lshlrev_b32 v36, 16, v34
    v_and_b32 v37, 0xffff0000, v34
    v_sub_f32 v32, v32, v36
    v_sub_f32 v33, v33, v37
    v_cvt_pk_bf16_f32 v35, v32, v33
    s_mov_b32 s36, 0x05040100
    s_mov_b32 s37, 0x07060302
    v_perm_b32 v36, v35, v34, s36
    v_perm_b32 v37, v35, v34, s37
    s_lshl_b32 s45, s61, 8
    s_add_u32 s45, s45, s46
    v_lshlrev_b32 v28, 3, v24
    s_mov_b32 exec_hi, 0
    buffer_store_dwordx2 v[36:37], v28, s[64:67], s45 offen sc1
L_k12_end:
    s_mov_b64 exec, -1
    v_mbcnt_lo_u32_b32 v7, -1, 0
    v_mbcnt_hi_u32_b32 v7, -1, v7
    s_add_u32 s48, s34, 0x1000000
    s_addc_u32 s49, s35, 0
    s_and_b32 s49, s49, 0xffff
    s_mov_b32 s50, 0x500000
    s_mov_b32 s51, 0x00020000
    s_bfe_u32 s74, s2, 0x40003
    s_cmp_eq_u32 s40, 8
    s_cbranch_scc1 L_tr_x
    s_cmp_lt_u32 s40, 8
    s_cbranch_scc0 L_tr_bar
    s_cmp_lt_u32 s40, 4
    s_cbranch_scc0 L_tr_bar
    v_mov_b32 v10, 163352
    v_mov_b32 v11, 1
    s_mov_b64 exec, 1
    ds_add_u32 v10, v11
    s_mov_b64 exec, -1
    s_branch L_tr_bar
L_tr_x:
    s_waitcnt vmcnt(0)
    v_mov_b32 v10, 163332
    v_mov_b32 v11, 1
    s_mov_b64 exec, 1
    ds_add_rtn_u32 v11, v10, v11
    s_waitcnt lgkmcnt(0)
    v_readfirstlane_b32 s56, v11
    s_mov_b64 exec, -1
    s_cmp_eq_u32 s56, 8
    s_cbranch_scc0 L_tr_noh
    s_lshl_b32 s56, s74, 7
    s_add_u32 s56, s56, 393216
    v_lshlrev_b32 v10, 11, v7
    v_mov_b32 v11, 1
    s_mov_b64 exec, 0xff
    buffer_atomic_add v11, v10, s[48:51], s56 offen sc1
    s_mov_b64 exec, -1
L_tr_noh:
L_tr_bar:
    v_mov_b32 v12, 163328
    ds_read_b32 v13, v12
    s_mov_b32 s4, s34
    s_mov_b32 s5, s35
    s_mov_b32 s6, s30
    s_mov_b32 s7, s31
    s_mov_b32 s52, s24
    s_mov_b32 s53, s25
    s_waitcnt lgkmcnt(0)
    v_readfirstlane_b32 s59, v13
    s_and_b32 s24, s2, 7
    s_lshr_b32 s25, s2, 3
    s_and_b32 s26, s24, 1
    s_lshl_b32 s26, s26, 3
    s_and_b32 s27, s25, 7
    s_add_u32 s26, s26, s27
    s_lshr_b32 s27, s24, 1
    s_lshl_b32 s27, s27, 2
    s_lshr_b32 s28, s25, 3
    s_add_u32 s27, s27, s28
    s_and_b32 s41, s40, 3
    s_cmp_lt_u32 s40, 4
    s_cbranch_scc1 L_k3_comp
    s_sub_u32 s50, s40, 4
    s_and_b32 s51, s50, 1
    s_lshr_b32 s50, s50, 1
    s_cmp_lt_u32 s40, 8
    s_cbranch_scc0 L_k3_st
    v_lshrrev_b32 v14, 4, v7
    v_lshlrev_b32 v15, 2, v14
    v_sub_u32 v15, v7, v15
    v_and_b32 v15, 15, v15
    v_lshlrev_b32 v15, 4, v15
    v_bfe_u32 v16, v7, 4, 1
    v_lshl_add_u32 v15, v16, 12, v15
    v_lshrrev_b32 v16, 5, v7
    v_lshl_add_u32 v15, v16, 14, v15
    s_lshl_b32 s29, s41, 16
    s_lshl_b32 s30, s26, 8
    s_add_u32 s29, s29, s30
    v_add_u32 v9, s29, v15
    v_add_u32 v10, 31744, v9
    s_add_u32 s12, s4, 0x1100000
    s_addc_u32 s13, s5, 0
    s_and_b32 s13, s13, 0xffff
    s_mov_b32 s14, 0x400000
    s_mov_b32 s15, 0x00020000
    s_cmp_eq_u32 s27, 15
    s_cselect_b32 s49, 8192, 0
    s_lshl_b32 s28, s41, 11
    s_add_u32 s28, s28, 12352
    s_mul_i32 s46, s41, 5120
    s_add_u32 s64, s4, 0x1040000
    s_addc_u32 s65, s5, 0
    s_and_b32 s65, s65, 0xffff
    s_mov_b32 s66, 0x24800
    s_mov_b32 s67, 0x00020000
    s_and_b32 s36, s2, 7
    s_lshl_b32 s36, s36, 2
    s_bfe_u32 s37, s2, 0x20003
    s_add_u32 s36, s36, s37
    s_lshr_b32 s37, s2, 5
    s_mov_b32 s60, s52
    s_and_b32 s61, s53, 0xffff
    s_mov_b32 s62, 0x158000
    s_mov_b32 s63, 0x00020000
    s_mul_i32 s54, s41, 22
    s_cmp_eq_u32 s41, 3
    s_cselect_b32 s55, 1, 0
    s_sub_u32 s54, s54, s55
    s_lshl_b32 s54, s54, 14
    s_lshl_b32 s55, s37, 7
    s_add_u32 s54, s54, s55
    s_lshr_b32 s55, s41, 1
    s_sub_u32 s39, 22, s55
    s_lshl_b32 s39, s39, 14
    s_sub_u32 s55, 0, s55
    s_lshl_b32 s55, s55, 14
    s_mul_i32 s38, s37, 11
    s_lshr_b32 s38, s38, 2
    s_lshl_b32 s38, s38, 14
    s_lshl_b32 s56, s41, 12
    s_add_u32 s56, s56, 146432
    v_lshrrev_b32 v14, 3, v7
    v_bfe_u32 v15, v7, 4, 1
    v_lshlrev_b32 v15, 2, v15
    v_and_b32 v22, 7, v7
    v_xor_b32 v15, v15, v22
    v_lshlrev_b32 v15, 4, v15
    v_lshl_add_u32 v22, v14, 10, v15
    v_lshrrev_b32 v14, 5, v7
    v_bfe_u32 v15, v7, 2, 2
    v_lshl_add_u32 v14, v14, 2, v15
    v_lshlrev_b32 v14, 7, v14
    v_bfe_u32 v15, v7, 4, 1
    v_lshl_add_u32 v14, v15, 5, v14
    v_and_b32 v15, 3, v7
    v_lshl_add_u32 v14, v15, 3, v14
    v_bfe_u32 v15, v7, 3, 1
    v_lshl_add_u32 v2, v15, 6, v14
    v_xor_b32 v15, 1, v15
    v_lshl_add_u32 v3, v15, 6, v14
    s_lshl_b32 s29, s50, 12
    s_add_u32 s29, s29, 146432
    v_add_u32 v32, s29, v2
    v_add_u32 v33, s29, v3
    s_mul_i32 s29, s50, 5120
    v_add_u32 v2, s29, v2
    v_add_u32 v3, s29, v3
    v_add_u32 v4, 61632, v2
    v_add_u32 v5, 61632, v3
    v_add_u32 v6, 123264, v2
    v_add_u32 v8, 123264, v3
    s_mov_b32 s45, s50
    s_lshl_b32 s47, s51, 5
    v_bfe_u32 v14, v7, 2, 2
    v_add_u32 v15, s45, v14
    v_and_b32 v15, 3, v15
    v_lshlrev_b32 v15, 6, v15
    v_lshl_add_u32 v15, v14, 8, v15
    s_add_u32 s29, s47, 12352
    v_add_u32 v15, s29, v15
    v_and_b32 v14, 3, v7
    v_lshl_add_u32 v15, v14, 3, v15
    v_bfe_u32 v14, v7, 4, 1
    v_lshl_add_u32 v15, v14, 10, v15
    v_lshrrev_b32 v14, 5, v7
    v_lshlrev_b32 v14, 11, v14
    v_add_u32 v11, v14, v15
    v_add_u32 v12, 61632, v11
    v_add_u32 v13, 123264, v11
    v_mov_b32 v24, 0
    v_mov_b32 v25, 0
    v_mov_b32 v26, 0
    v_mov_b32 v27, 0
    s_mul_i32 s29, s45, 640
    s_add_u32 s29, s29, 143808
    s_lshl_b32 s43, s47, 3
    s_add_u32 s43, s43, s29
    s_lshl_b32 s42, s47, 1
    s_add_u32 s42, s42, s29
    s_add_u32 s42, s42, 512
    s_add_u32 s68, s4, 0x1020000
    s_addc_u32 s69, s5, 0
    s_and_b32 s69, s69, 0xffff
    s_mov_b32 s70, 0x4000
    s_mov_b32 s71, 0x00020000
    s_lshl_b32 s29, s26, 10
    s_lshl_b32 s30, s45, 8
    s_add_u32 s29, s29, s30
    s_lshl_b32 s47, s47, 2
    s_add_u32 s47, s47, s29
    v_and_b32 v23, 15, v7
    v_lshlrev_b32 v23, 3, v23
    s_and_b32 s72, s2, 7
    s_lshl_b32 s72, s72, 1
    s_add_u32 s72, s72, 1
    v_lshl_add_u32 v37, v7, 4, s28
    s_mov_b32 s58, 0
    v_and_b32 v21, 15, v7
    v_lshlrev_b32 v21, 7, v21
    s_cmp_eq_u32 s27, 15
    s_cbranch_scc0 L_x15
    s_waitcnt vmcnt(0)
    v_mov_b32 v14, 163332
    v_mov_b32 v15, 1
    s_mov_b64 exec, 1
    ds_add_rtn_u32 v15, v14, v15
    s_waitcnt lgkmcnt(0)
    v_readfirstlane_b32 s29, v15
    s_mov_b64 exec, -1
    s_cmp_eq_u32 s29, 8
    s_cbranch_scc0 L_la_nos
    s_lshl_b32 s30, s74, 7
    s_add_u32 s30, s30, 131072
    v_lshlrev_b32 v14, 11, v7
    v_mov_b32 v15, 1
    s_mov_b64 exec, 0xff
    buffer_atomic_add v15, v14, s[64:67], s30 offen sc1
    s_mov_b64 exec, -1
L_la_nos:
    s_branch L_s15
L_x15:
    v_mov_b32 v14, 163340
    s_mov_b32 s31, 0
L_lw_pzf:
    ds_read_b32 v15, v14
    s_waitcnt lgkmcnt(0)
    v_readfirstlane_b32 s30, v15
    s_add_u32 s31, s31, 1
    s_cmp_ge_u32 s30, 1
    s_cbranch_scc1 L_lx_pzf
    s_sleep 1
    s_cmp_lt_u32 s31, 64000
    s_cbranch_scc1 L_lw_pzf
L_lx_pzf:
    v_mov_b32 v14, 163336
    s_mov_b32 s31, 0
L_lw_cvd:
    ds_read_b32 v15, v14
    s_waitcnt lgkmcnt(0)
    v_readfirstlane_b32 s30, v15
    s_add_u32 s31, s31, 1
    s_cmp_ge_u32 s30, 4
    s_cbranch_scc1 L_lx_cvd
    s_sleep 1
    s_cmp_lt_u32 s31, 64000
    s_cbranch_scc1 L_lw_cvd
L_lx_cvd:
    s_sub_u32 s73, s72, 0
    s_and_b32 s73, s73, 15
    s_lshl_b32 s73, s73, 18
    s_add_u32 s73, s73, s49
    s_add_u32 m0, s28, 82176
    s_nop 0
    buffer_load_dwordx4 v9, s[12:15], s73 offen sc1 lds
    buffer_load_dwordx4 v10, s[12:15], s73 offen offset:1024 sc1 lds
    s_sub_u32 s73, s72, 1
    s_and_b32 s73, s73, 15
    s_lshl_b32 s73, s73, 18
    s_add_u32 s73, s73, s49
    s_add_u32 m0, s28, 102720
    s_nop 0
    buffer_load_dwordx4 v9, s[12:15], s73 offen sc1 lds
    buffer_load_dwordx4 v10, s[12:15], s73 offen offset:1024 sc1 lds
    s_sub_u32 s73, s72, 2
    s_and_b32 s73, s73, 15
    s_lshl_b32 s73, s73, 18
    s_add_u32 s73, s73, s49
    s_add_u32 m0, s28, 123264
    s_nop 0
    buffer_load_dwordx4 v9, s[12:15], s73 offen sc1 lds
    buffer_load_dwordx4 v10, s[12:15], s73 offen offset:1024 sc1 lds
    s_mul_i32 s29, s41, 640
    s_add_u32 s29, s29, 144320
    v_and_b32 v14, 31, v7
    v_lshl_add_u32 v14, v14, 2, s29
    v_mov_b32 v15, 0
    ds_write_b32 v14, v15
    s_waitcnt lgkmcnt(0)
    s_waitcnt vmcnt(4)
L_vf0:
    v_add_u32 v112, 82176, v37
    ds_read_b128 v[104:107], v112
    ds_read_b128 v[108:111], v112 offset:1024
    s_waitcnt lgkmcnt(1)
    v_xor_b32 v105, s59, v105
    v_xor_b32 v107, s59, v107
    s_waitcnt lgkmcnt(0)
    v_xor_b32 v109, s59, v109
    v_xor_b32 v111, s59, v111
    v_min3_u32 v104, v105, v107, v109
    v_min_u32 v104, v104, v111
    v_cmp_eq_u32 vcc, 0, v104
    s_cbranch_vccz L_vk0
    s_add_u32 s58, s58, 1
    s_cmp_lt_u32 s58, 8000
    s_cbranch_scc0 L_vk0
    s_sub_u32 s73, s72, 0
    s_and_b32 s73, s73, 15
    s_lshl_b32 s73, s73, 18
    s_add_u32 s73, s73, s49
    s_add_u32 m0, s28, 82176
    s_nop 0
    buffer_load_dwordx4 v9, s[12:15], s73 offen sc1 lds
    buffer_load_dwordx4 v10, s[12:15], s73 offen offset:1024 sc1 lds
    s_sub_u32 s73, s72, 1
    s_and_b32 s73, s73, 15
    s_lshl_b32 s73, s73, 18
    s_add_u32 s73, s73, s49
    s_add_u32 m0, s28, 102720
    s_nop 0
    buffer_load_dwordx4 v9, s[12:15], s73 offen sc1 lds
    buffer_load_dwordx4 v10, s[12:15], s73 offen offset:1024 sc1 lds
    s_sub_u32 s73, s72, 2
    s_and_b32 s73, s73, 15
    s_lshl_b32 s73, s73, 18
    s_add_u32 s73, s73, s49
    s_add_u32 m0, s28, 123264
    s_nop 0
    buffer_load_dwordx4 v9, s[12:15], s73 offen sc1 lds
    buffer_load_dwordx4 v10, s[12:15], s73 offen offset:1024 sc1 lds
    s_waitcnt vmcnt(4)
    s_branch L_vf0
L_vk0:
    s_barrier
    s_sub_u32 s73, s72, 3
    s_and_b32 s73, s73, 15
    s_lshl_b32 s73, s73, 18
    s_add_u32 s73, s73, s49
    s_add_u32 m0, s28, 0
    s_nop 0
    buffer_load_dwordx4 v9, s[12:15], s73 offen sc1 lds
    buffer_load_dwordx4 v10, s[12:15], s73 offen offset:1024 sc1 lds
    s_sub_u32 s73, s72, 4
    s_and_b32 s73, s73, 15
    s_lshl_b32 s73, s73, 18
    s_add_u32 s73, s73, s49
    s_add_u32 m0, s28, 20544
    s_nop 0
    buffer_load_dwordx4 v9, s[12:15], s73 offen sc1 lds
    buffer_load_dwordx4 v10, s[12:15], s73 offen offset:1024 sc1 lds
    v_mov_b32 v14, 163332
    v_mov_b32 v15, 1
    s_mov_b64 exec, 1
    ds_add_rtn_u32 v15, v14, v15
    s_waitcnt lgkmcnt(0)
    v_readfirstlane_b32 s29, v15
    s_mov_b64 exec, -1
    s_cmp_eq_u32 s29, 8
    s_cbranch_scc0 L_la_no
    s_lshl_b32 s30, s74, 7
    s_add_u32 s30, s30, 131072
    v_lshlrev_b32 v14, 11, v7
    v_mov_b32 v15, 1
    s_mov_b64 exec, 0xff
    buffer_atomic_add v15, v14, s[64:67], s30 offen sc1
    s_mov_b64 exec, -1
L_la_no:
    s_waitcnt vmcnt(6)
L_vf1:
    v_add_u32 v112, 102720, v37
    ds_read_b128 v[104:107], v112
    ds_read_b128 v[108:111], v112 offset:1024
    s_waitcnt lgkmcnt(1)
    v_xor_b32 v105, s59, v105
    v_xor_b32 v107, s59, v107
    s_waitcnt lgkmcnt(0)
    v_xor_b32 v109, s59, v109
    v_xor_b32 v111, s59, v111
    v_min3_u32 v104, v105, v107, v109
    v_min_u32 v104, v104, v111
    v_cmp_eq_u32 vcc, 0, v104
    s_cbranch_vccz L_vk1
    s_add_u32 s58, s58, 1
    s_cmp_lt_u32 s58, 8000
    s_cbranch_scc0 L_vk1
    s_sub_u32 s73, s72, 1
    s_and_b32 s73, s73, 15
    s_lshl_b32 s73, s73, 18
    s_add_u32 s73, s73, s49
    s_add_u32 m0, s28, 102720
    s_nop 0
    buffer_load_dwordx4 v9, s[12:15], s73 offen sc1 lds
    buffer_load_dwordx4 v10, s[12:15], s73 offen offset:1024 sc1 lds
    s_waitcnt vmcnt(0)
    s_branch L_vf1
L_vk1:
    s_barrier
    s_sub_u32 s73, s72, 5
    s_and_b32 s73, s73, 15
    s_lshl_b32 s73, s73, 18
    s_add_u32 s73, s73, s49
    s_add_u32 m0, s28, 41088
    s_nop 0
    buffer_load_dwordx4 v9, s[12:15], s73 offen sc1 lds
    buffer_load_dwordx4 v10, s[12:15], s73 offen offset:1024 sc1 lds
    s_sub_u32 s73, s72, 6
    s_and_b32 s73, s73, 15
    s_lshl_b32 s73, s73, 18
    s_add_u32 s73, s73, s49
    s_add_u32 m0, s28, 61632
    s_nop 0
    buffer_load_dwordx4 v9, s[12:15], s73 offen sc1 lds
    buffer_load_dwordx4 v10, s[12:15], s73 offen offset:1024 sc1 lds
    s_waitcnt vmcnt(8)
L_vf2:
    v_add_u32 v112, 123264, v37
    ds_read_b128 v[104:107], v112
    ds_read_b128 v[108:111], v112 offset:1024
    s_waitcnt lgkmcnt(1)
    v_xor_b32 v105, s59, v105
    v_xor_b32 v107, s59, v107
    s_waitcnt lgkmcnt(0)
    v_xor_b32 v109, s59, v109
    v_xor_b32 v111, s59, v111
    v_min3_u32 v104, v105, v107, v109
    v_min_u32 v104, v104, v111
    v_cmp_eq_u32 vcc, 0, v104
    s_cbranch_vccz L_vk2
    s_add_u32 s58, s58, 1
    s_cmp_lt_u32 s58, 8000
    s_cbranch_scc0 L_vk2
    s_sub_u32 s73, s72, 2
    s_and_b32 s73, s73, 15
    s_lshl_b32 s73, s73, 18
    s_add_u32 s73, s73, s49
    s_add_u32 m0, s28, 123264
    s_nop 0
    buffer_load_dwordx4 v9, s[12:15], s73 offen sc1 lds
    buffer_load_dwordx4 v10, s[12:15], s73 offen offset:1024 sc1 lds
    s_waitcnt vmcnt(0)
    s_branch L_vf2
L_vk2:
    s_barrier
    s_sub_u32 s73, s72, 7
    s_and_b32 s73, s73, 15
    s_lshl_b32 s73, s73, 18
    s_add_u32 s73, s73, s49
    s_add_u32 m0, s28, 82176
    s_nop 0
    buffer_load_dwordx4 v9, s[12:15], s73 offen sc1 lds
    buffer_load_dwordx4 v10, s[12:15], s73 offen offset:1024 sc1 lds
    s_waitcnt vmcnt(8)
L_vf3:
    v_add_u32 v112, 0, v37
    ds_read_b128 v[104:107], v112
    ds_read_b128 v[108:111], v112 offset:1024
    s_waitcnt lgkmcnt(1)
    v_xor_b32 v105, s59, v105
    v_xor_b32 v107, s59, v107
    s_waitcnt lgkmcnt(0)
    v_xor_b32 v109, s59, v109
    v_xor_b32 v111, s59, v111
    v_min3_u32 v104, v105, v107, v109
    v_min_u32 v104, v104, v111
    v_cmp_eq_u32 vcc, 0, v104
    s_cbranch_vccz L_vk3
    s_add_u32 s58, s58, 1
    s_cmp_lt_u32 s58, 8000
    s_cbranch_scc0 L_vk3
    s_sub_u32 s73, s72, 3
    s_and_b32 s73, s73, 15
    s_lshl_b32 s73, s73, 18
    s_add_u32 s73, s73, s49
    s_add_u32 m0, s28, 0
    s_nop 0
    buffer_load_dwordx4 v9, s[12:15], s73 offen sc1 lds
    buffer_load_dwordx4 v10, s[12:15], s73 offen offset:1024 sc1 lds
    s_waitcnt vmcnt(0)
    s_branch L_vf3
L_vk3:
    s_barrier
    s_sub_u32 s73, s72, 8
    s_and_b32 s73, s73, 15
    s_lshl_b32 s73, s73, 18
    s_add_u32 s73, s73, s49
    s_add_u32 m0, s28, 102720
    s_nop 0
    buffer_load_dwordx4 v9, s[12:15], s73 offen sc1 lds
    buffer_load_dwordx4 v10, s[12:15], s73 offen offset:1024 sc1 lds
    s_add_u32 m0, s56, 2048
    s_add_u32 s57, s54, 16384
    buffer_load_dwordx4 v22, s[60:63], s57 offen lds
    s_waitcnt vmcnt(9)
L_vf4:
    v_add_u32 v112, 20544, v37
    ds_read_b128 v[104:107], v112
    ds_read_b128 v[108:111], v112 offset:1024
    s_waitcnt lgkmcnt(1)
    v_xor_b32 v105, s59, v105
    v_xor_b32 v107, s59, v107
    s_waitcnt lgkmcnt(0)
    v_xor_b32 v109, s59, v109
    v_xor_b32 v111, s59, v111
    v_min3_u32 v104, v105, v107, v109
    v_min_u32 v104, v104, v111
    v_cmp_eq_u32 vcc, 0, v104
    s_cbranch_vccz L_vk4
    s_add_u32 s58, s58, 1
    s_cmp_lt_u32 s58, 8000
    s_cbranch_scc0 L_vk4
    s_sub_u32 s73, s72, 4
    s_and_b32 s73, s73, 15
    s_lshl_b32 s73, s73, 18
    s_add_u32 s73, s73, s49
    s_add_u32 m0, s28, 20544
    s_nop 0
    buffer_load_dwordx4 v9, s[12:15], s73 offen sc1 lds
    buffer_load_dwordx4 v10, s[12:15], s73 offen offset:1024 sc1 lds
    s_waitcnt vmcnt(0)
    s_branch L_vf4
L_vk4:
    s_barrier
    s_sub_u32 s73, s72, 9
    s_and_b32 s73, s73, 15
    s_lshl_b32 s73, s73, 18
    s_add_u32 s73, s73, s49
    s_add_u32 m0, s28, 123264
    s_nop 0
    buffer_load_dwordx4 v9, s[12:15], s73 offen sc1 lds
    buffer_load_dwordx4 v10, s[12:15], s73 offen offset:1024 sc1 lds
    s_add_u32 m0, s56, 3072
    s_add_u32 s57, s54, 24576
    buffer_load_dwordx4 v22, s[60:63], s57 offen lds
    s_waitcnt vmcnt(10)
L_vf5:
    v_add_u32 v112, 41088, v37
    ds_read_b128 v[104:107], v112
    ds_read_b128 v[108:111], v112 offset:1024
    s_waitcnt lgkmcnt(1)
    v_xor_b32 v105, s59, v105
    v_xor_b32 v107, s59, v107
    s_waitcnt lgkmcnt(0)
    v_xor_b32 v109, s59, v109
    v_xor_b32 v111, s59, v111
    v_min3_u32 v104, v105, v107, v109
    v_min_u32 v104, v104, v111
    v_cmp_eq_u32 vcc, 0, v104
    s_cbranch_vccz L_vk5
    s_add_u32 s58, s58, 1
    s_cmp_lt_u32 s58, 8000
    s_cbranch_scc0 L_vk5
    s_sub_u32 s73, s72, 5
    s_and_b32 s73, s73, 15
    s_lshl_b32 s73, s73, 18
    s_add_u32 s73, s73, s49
    s_add_u32 m0, s28, 41088
    s_nop 0
    buffer_load_dwordx4 v9, s[12:15], s73 offen sc1 lds
    buffer_load_dwordx4 v10, s[12:15], s73 offen offset:1024 sc1 lds
    s_waitcnt vmcnt(0)
    s_branch L_vf5
L_vk5:
    s_barrier
    s_sub_u32 s73, s72, 10
    s_and_b32 s73, s73, 15
    s_lshl_b32 s73, s73, 18
    s_add_u32 s73, s73, s49
    s_add_u32 m0, s28, 0
    s_nop 0
    buffer_load_dwordx4 v9, s[12:15], s73 offen sc1 lds
    buffer_load_dwordx4 v10, s[12:15], s73 offen offset:1024 sc1 lds
    s_waitcnt vmcnt(10)
L_vf6:
    v_add_u32 v112, 61632, v37
    ds_read_b128 v[104:107], v112
    ds_read_b128 v[108:111], v112 offset:1024
    s_waitcnt lgkmcnt(1)
    v_xor_b32 v105, s59, v105
    v_xor_b32 v107, s59, v107
    s_waitcnt lgkmcnt(0)
    v_xor_b32 v109, s59, v109
    v_xor_b32 v111, s59, v111
    v_min3_u32 v104, v105, v107, v109
    v_min_u32 v104, v104, v111
    v_cmp_eq_u32 vcc, 0, v104
    s_cbranch_vccz L_vk6
    s_add_u32 s58, s58, 1
    s_cmp_lt_u32 s58, 8000
    s_cbranch_scc0 L_vk6
    s_sub_u32 s73, s72, 6
    s_and_b32 s73, s73, 15
    s_lshl_b32 s73, s73, 18
    s_add_u32 s73, s73, s49
    s_add_u32 m0, s28, 61632
    s_nop 0
    buffer_load_dwordx4 v9, s[12:15], s73 offen sc1 lds
    buffer_load_dwordx4 v10, s[12:15], s73 offen offset:1024 sc1 lds
    s_waitcnt vmcnt(0)
    s_branch L_vf6
L_vk6:
    s_barrier
    s_sub_u32 s73, s72, 11
    s_and_b32 s73, s73, 15
    s_lshl_b32 s73, s73, 18
    s_add_u32 s73, s73, s49
    s_add_u32 m0, s28, 20544
    s_nop 0
    buffer_load_dwordx4 v9, s[12:15], s73 offen sc1 lds
    buffer_load_dwordx4 v10, s[12:15], s73 offen offset:1024 sc1 lds
    s_waitcnt vmcnt(10)
L_vf7:
    v_add_u32 v112, 82176, v37
    ds_read_b128 v[104:107], v112
    ds_read_b128 v[108:111], v112 offset:1024
    s_waitcnt lgkmcnt(1)
    v_xor_b32 v105, s59, v105
    v_xor_b32 v107, s59, v107
    s_waitcnt lgkmcnt(0)
    v_xor_b32 v109, s59, v109
    v_xor_b32 v111, s59, v111
    v_min3_u32 v104, v105, v107, v109
    v_min_u32 v104, v104, v111
    v_cmp_eq_u32 vcc, 0, v104
    s_cbranch_vccz L_vk7
    s_add_u32 s58, s58, 1
    s_cmp_lt_u32 s58, 8000
    s_cbranch_scc0 L_vk7
    s_sub_u32 s73, s72, 7
    s_and_b32 s73, s73, 15
    s_lshl_b32 s73, s73, 18
    s_add_u32 s73, s73, s49
    s_add_u32 m0, s28, 82176
    s_nop 0
    buffer_load_dwordx4 v9, s[12:15], s73 offen sc1 lds
    buffer_load_dwordx4 v10, s[12:15], s73 offen offset:1024 sc1 lds
    s_waitcnt vmcnt(0)
    s_branch L_vf7
L_vk7:
    s_barrier
    s_sub_u32 s73, s72, 12
    s_and_b32 s73, s73, 15
    s_lshl_b32 s73, s73, 18
    s_add_u32 s73, s73, s49
    s_add_u32 m0, s28, 41088
    s_nop 0
    buffer_load_dwordx4 v9, s[12:15], s73 offen sc1 lds
    buffer_load_dwordx4 v10, s[12:15], s73 offen offset:1024 sc1 lds
    s_waitcnt vmcnt(10)
L_vf8:
    v_add_u32 v112, 102720, v37
    ds_read_b128 v[104:107], v112
    ds_read_b128 v[108:111], v112 offset:1024
    s_waitcnt lgkmcnt(1)
    v_xor_b32 v105, s59, v105
    v_xor_b32 v107, s59, v107
    s_waitcnt lgkmcnt(0)
    v_xor_b32 v109, s59, v109
    v_xor_b32 v111, s59, v111
    v_min3_u32 v104, v105, v107, v109
    v_min_u32 v104, v104, v111
    v_cmp_eq_u32 vcc, 0, v104
    s_cbranch_vccz L_vk8
    s_add_u32 s58, s58, 1
    s_cmp_lt_u32 s58, 8000
    s_cbranch_scc0 L_vk8
    s_sub_u32 s73, s72, 8
    s_and_b32 s73, s73, 15
    s_lshl_b32 s73, s73, 18
    s_add_u32 s73, s73, s49
    s_add_u32 m0, s28, 102720
    s_nop 0
    buffer_load_dwordx4 v9, s[12:15], s73 offen sc1 lds
    buffer_load_dwordx4 v10, s[12:15], s73 offen offset:1024 sc1 lds
    s_waitcnt vmcnt(0)
    s_branch L_vf8
L_vk8:
    s_barrier
    s_sub_u32 s73, s72, 13
    s_and_b32 s73, s73, 15
    s_lshl_b32 s73, s73, 18
    s_add_u32 s73, s73, s49
    s_add_u32 m0, s28, 61632
    s_nop 0
    buffer_load_dwordx4 v9, s[12:15], s73 offen sc1 lds
    buffer_load_dwordx4 v10, s[12:15], s73 offen offset:1024 sc1 lds
    s_waitcnt vmcnt(8)
L_vf9:
    v_add_u32 v112, 123264, v37
    ds_read_b128 v[104:107], v112
    ds_read_b128 v[108:111], v112 offset:1024
    s_waitcnt lgkmcnt(1)
    v_xor_b32 v105, s59, v105
    v_xor_b32 v107, s59, v107
    s_waitcnt lgkmcnt(0)
    v_xor_b32 v109, s59, v109
    v_xor_b32 v111, s59, v111
    v_min3_u32 v104, v105, v107, v109
    v_min_u32 v104, v104, v111
    v_cmp_eq_u32 vcc, 0, v104
    s_cbranch_vccz L_vk9
    s_add_u32 s58, s58, 1
    s_cmp_lt_u32 s58, 8000
    s_cbranch_scc0 L_vk9
    s_sub_u32 s73, s72, 9
    s_and_b32 s73, s73, 15
    s_lshl_b32 s73, s73, 18
    s_add_u32 s73, s73, s49
    s_add_u32 m0, s28, 123264
    s_nop 0
    buffer_load_dwordx4 v9, s[12:15], s73 offen sc1 lds
    buffer_load_dwordx4 v10, s[12:15], s73 offen offset:1024 sc1 lds
    s_waitcnt vmcnt(0)
    s_branch L_vf9
L_vk9:
    s_barrier
    s_and_b32 s31, s2, 7
    s_lshl_b32 s31, s31, 11
    s_add_u32 s31, s31, 131072
    buffer_load_dword v20, v21, s[64:67], s31 offen sc1
    s_sub_u32 s73, s72, 14
    s_and_b32 s73, s73, 15
    s_lshl_b32 s73, s73, 18
    s_add_u32 s73, s73, s49
    s_add_u32 m0, s28, 82176
    s_nop 0
    buffer_load_dwordx4 v9, s[12:15], s73 offen sc1 lds
    buffer_load_dwordx4 v10, s[12:15], s73 offen offset:1024 sc1 lds
    ds_read_b64_tr_b16 v[48:49], v32 offset:0
    ds_read_b64_tr_b16 v[50:51], v32 offset:1024
    ds_read_b64_tr_b16 v[52:53], v33 offset:0
    ds_read_b64_tr_b16 v[54:55], v33 offset:1024
    ds_read_b64_tr_b16 v[56:57], v32 offset:2048
    ds_read_b64_tr_b16 v[58:59], v32 offset:3072
    ds_read_b64_tr_b16 v[60:61], v33 offset:2048
    ds_read_b64_tr_b16 v[62:63], v33 offset:3072
    s_waitcnt lgkmcnt(0)
    s_waitcnt vmcnt(9)
L_vf10:
    v_add_u32 v112, 0, v37
    ds_read_b128 v[104:107], v112
    ds_read_b128 v[108:111], v112 offset:1024
    s_waitcnt lgkmcnt(1)
    v_xor_b32 v105, s59, v105
    v_xor_b32 v107, s59, v107
    s_waitcnt lgkmcnt(0)
    v_xor_b32 v109, s59, v109
    v_xor_b32 v111, s59, v111
    v_min3_u32 v104, v105, v107, v109
    v_min_u32 v104, v104, v111
    v_cmp_eq_u32 vcc, 0, v104
    s_cbranch_vccz L_vk10
    s_add_u32 s58, s58, 1
    s_cmp_lt_u32 s58, 8000
    s_cbranch_scc0 L_vk10
    s_sub_u32 s73, s72, 10
    s_and_b32 s73, s73, 15
    s_lshl_b32 s73, s73, 18
    s_add_u32 s73, s73, s49
    s_add_u32 m0, s28, 0
    s_nop 0
    buffer_load_dwordx4 v9, s[12:15], s73 offen sc1 lds
    buffer_load_dwordx4 v10, s[12:15], s73 offen offset:1024 sc1 lds
    s_waitcnt vmcnt(0)
    s_branch L_vf10
L_vk10:
    s_barrier
    s_sub_u32 s73, s72, 15
    s_and_b32 s73, s73, 15
    s_lshl_b32 s73, s73, 18
    s_add_u32 s73, s73, s49
    s_add_u32 m0, s28, 102720
    s_nop 0
    buffer_load_dwordx4 v9, s[12:15], s73 offen sc1 lds
    buffer_load_dwordx4 v10, s[12:15], s73 offen offset:1024 sc1 lds
    s_waitcnt vmcnt(9)
L_vf11:
    v_add_u32 v112, 20544, v37
    ds_read_b128 v[104:107], v112
    ds_read_b128 v[108:111], v112 offset:1024
    s_waitcnt lgkmcnt(1)
    v_xor_b32 v105, s59, v105
    v_xor_b32 v107, s59, v107
    s_waitcnt lgkmcnt(0)
    v_xor_b32 v109, s59, v109
    v_xor_b32 v111, s59, v111
    v_min3_u32 v104, v105, v107, v109
    v_min_u32 v104, v104, v111
    v_cmp_eq_u32 vcc, 0, v104
    s_cbranch_vccz L_vk11
    s_add_u32 s58, s58, 1
    s_cmp_lt_u32 s58, 8000
    s_cbranch_scc0 L_vk11
    s_sub_u32 s73, s72, 11
    s_and_b32 s73, s73, 15
    s_lshl_b32 s73, s73, 18
    s_add_u32 s73, s73, s49
    s_add_u32 m0, s28, 20544
    s_nop 0
    buffer_load_dwordx4 v9, s[12:15], s73 offen sc1 lds
    buffer_load_dwordx4 v10, s[12:15], s73 offen offset:1024 sc1 lds
    s_waitcnt vmcnt(0)
    s_branch L_vf11
L_vk11:
    s_barrier
    s_waitcnt vmcnt(4)
    s_mov_b32 s57, 0
L_go_chk:
    v_cmp_gt_u32 vcc, 16, v20
    s_cbranch_vccz L_go_ok
    s_add_u32 s57, s57, 1
    s_cmp_lt_u32 s57, 8000
    s_cbranch_scc0 L_go_ok
    s_and_b32 s31, s2, 7
    s_lshl_b32 s31, s31, 11
    s_add_u32 s31, s31, 131072
    buffer_load_dword v20, v21, s[64:67], s31 offen sc1
    s_waitcnt vmcnt(0)
    s_branch L_go_chk
L_go_ok:
    s_add_u32 s16, s4, 0x8f0000
    s_addc_u32 s17, s5, 0
    s_and_b32 s17, s17, 0xffff
    s_mov_b32 s18, 0x16800
    s_mov_b32 s19, 0x00020000
    v_lshlrev_b32 v14, 4, v7
    s_mul_i32 s29, s27, 6
    s_add_u32 s29, s29, s41
    s_lshl_b32 s29, s29, 10
    v_add_u32 v15, s29, v14
    s_lshr_b32 s30, s41, 1
    s_mul_i32 s30, s30, 5120
    s_and_b32 s31, s41, 1
    s_lshl_b32 s31, s31, 10
    s_add_u32 s30, s30, s31
    s_add_u32 m0, s30, 125312
    s_nop 0
    buffer_load_dwordx4 v15, s[16:19], 0 offen sc1 lds
    s_cmp_lt_u32 s41, 2
    s_cbranch_scc0 L_xf_st
    v_add_u32 v15, 4096, v15
    s_add_u32 m0, s31, 135552
    s_nop 0
    buffer_load_dwordx4 v15, s[16:19], 0 offen sc1 lds
    s_branch L_xf_done
L_xf_st:
    s_cmp_eq_u32 s41, 2
    s_cbranch_scc0 L_xf_rep
    s_lshl_b32 s29, s26, 10
    v_add_u32 v15, s29, v14
    s_mov_b32 m0, 140672
    s_nop 0
    buffer_load_dwordx4 v15, s[68:71], 0 offen sc1 lds
    s_branch L_xf_done
L_xf_rep:
    buffer_load_dwordx4 v15, s[16:19], 0 offen sc1 lds
L_xf_done:
    s_add_u32 m0, s56, 2048
    s_add_u32 s57, s54, 49152
    buffer_load_dwordx4 v22, s[60:63], s57 offen lds
    s_waitcnt vmcnt(10)
L_vf12:
    v_add_u32 v112, 41088, v37
    ds_read_b128 v[104:107], v112
    ds_read_b128 v[108:111], v112 offset:1024
    s_waitcnt lgkmcnt(1)
    v_xor_b32 v105, s59, v105
    v_xor_b32 v107, s59, v107
    s_waitcnt lgkmcnt(0)
    v_xor_b32 v109, s59, v109
    v_xor_b32 v111, s59, v111
    v_min3_u32 v104, v105, v107, v109
    v_min_u32 v104, v104, v111
    v_cmp_eq_u32 vcc, 0, v104
    s_cbranch_vccz L_vk12
    s_add_u32 s58, s58, 1
    s_cmp_lt_u32 s58, 8000
    s_cbranch_scc0 L_vk12
    s_sub_u32 s73, s72, 12
    s_and_b32 s73, s73, 15
    s_lshl_b32 s73, s73, 18
    s_add_u32 s73, s73, s49
    s_add_u32 m0, s28, 41088
    s_nop 0
    buffer_load_dwordx4 v9, s[12:15], s73 offen sc1 lds
    buffer_load_dwordx4 v10, s[12:15], s73 offen offset:1024 sc1 lds
    s_waitcnt vmcnt(0)
    s_branch L_vf12
L_vk12:
    s_barrier
    s_add_u32 m0, s56, 3072
    s_add_u32 s57, s54, 57344
    buffer_load_dwordx4 v22, s[60:63], s57 offen lds
    s_add_u32 m0, s46, 3072
    s_add_u32 s57, s54, 90112
    buffer_load_dwordx4 v22, s[60:63], s57 offen lds
    s_add_u32 m0, s46, 4096
    s_add_u32 s57, s54, 98304
    buffer_load_dwordx4 v22, s[60:63], s57 offen lds
    s_waitcnt vmcnt(4)
L_vf13:
    v_add_u32 v112, 61632, v37
    ds_read_b128 v[104:107], v112
    ds_read_b128 v[108:111], v112 offset:1024
    s_waitcnt lgkmcnt(1)
    v_xor_b32 v105, s59, v105
    v_xor_b32 v107, s59, v107
    s_waitcnt lgkmcnt(0)
    v_xor_b32 v109, s59, v109
    v_xor_b32 v111, s59, v111
    v_min3_u32 v104, v105, v107, v109
    v_min_u32 v104, v104, v111
    v_cmp_eq_u32 vcc, 0, v104
    s_cbranch_vccz L_vk13
    s_add_u32 s58, s58, 1
    s_cmp_lt_u32 s58, 8000
    s_cbranch_scc0 L_vk13
    s_sub_u32 s73, s72, 13
    s_and_b32 s73, s73, 15
    s_lshl_b32 s73, s73, 18
    s_add_u32 s73, s73, s49
    s_add_u32 m0, s28, 61632
    s_nop 0
    buffer_load_dwordx4 v9, s[12:15], s73 offen sc1 lds
    buffer_load_dwordx4 v10, s[12:15], s73 offen offset:1024 sc1 lds
    s_waitcnt vmcnt(0)
    s_branch L_vf13
L_vk13:
    s_barrier
    s_add_u32 m0, s46, 23616
    s_add_u32 s57, s54, 131072
    buffer_load_dwordx4 v22, s[60:63], s57 offen lds
    s_add_u32 m0, s46, 24640
    s_add_u32 s57, s54, 139264
    buffer_load_dwordx4 v22, s[60:63], s57 offen lds
    s_waitcnt vmcnt(10)
L_vf14:
    v_add_u32 v112, 82176, v37
    ds_read_b128 v[104:107], v112
    ds_read_b128 v[108:111], v112 offset:1024
    s_waitcnt lgkmcnt(1)
    v_xor_b32 v105, s59, v105
    v_xor_b32 v107, s59, v107
    s_waitcnt lgkmcnt(0)
    v_xor_b32 v109, s59, v109
    v_xor_b32 v111, s59, v111
    v_min3_u32 v104, v105, v107, v109
    v_min_u32 v104, v104, v111
    v_cmp_eq_u32 vcc, 0, v104
    s_cbranch_vccz L_vk14
    s_add_u32 s58, s58, 1
    s_cmp_lt_u32 s58, 8000
    s_cbranch_scc0 L_vk14
    s_sub_u32 s73, s72, 14
    s_and_b32 s73, s73, 15
    s_lshl_b32 s73, s73, 18
    s_add_u32 s73, s73, s49
    s_add_u32 m0, s28, 82176
    s_nop 0
    buffer_load_dwordx4 v9, s[12:15], s73 offen sc1 lds
    buffer_load_dwordx4 v10, s[12:15], s73 offen offset:1024 sc1 lds
    s_waitcnt vmcnt(0)
    s_branch L_vf14
L_vk14:
    s_barrier
    s_add_u32 m0, s46, 44160
    s_add_u32 s57, s54, 172032
    buffer_load_dwordx4 v22, s[60:63], s57 offen lds
    s_add_u32 m0, s46, 45184
    s_add_u32 s57, s54, 180224
    buffer_load_dwordx4 v22, s[60:63], s57 offen lds
    s_waitcnt vmcnt(6)
L_vf15:
    v_add_u32 v112, 102720, v37
    ds_read_b128 v[104:107], v112
    ds_read_b128 v[108:111], v112 offset:1024
    s_waitcnt lgkmcnt(1)
    v_xor_b32 v105, s59, v105
    v_xor_b32 v107, s59, v107
    s_waitcnt lgkmcnt(0)
    v_xor_b32 v109, s59, v109
    v_xor_b32 v111, s59, v111
    v_min3_u32 v104, v105, v107, v109
    v_min_u32 v104, v104, v111
    v_cmp_eq_u32 vcc, 0, v104
    s_cbranch_vccz L_vk15
    s_add_u32 s58, s58, 1
    s_cmp_lt_u32 s58, 8000
    s_cbranch_scc0 L_vk15
    s_sub_u32 s73, s72, 15
    s_and_b32 s73, s73, 15
    s_lshl_b32 s73, s73, 18
    s_add_u32 s73, s73, s49
    s_add_u32 m0, s28, 102720
    s_nop 0
    buffer_load_dwordx4 v9, s[12:15], s73 offen sc1 lds
    buffer_load_dwordx4 v10, s[12:15], s73 offen offset:1024 sc1 lds
    s_waitcnt vmcnt(0)
    s_branch L_vf15
L_vk15:
    s_barrier
    s_add_u32 m0, s46, 64704
    s_add_u32 s57, s54, 212992
    buffer_load_dwordx4 v22, s[60:63], s57 offen lds
    s_add_u32 m0, s46, 65728
    s_add_u32 s57, s54, 221184
    buffer_load_dwordx4 v22, s[60:63], s57 offen lds
    ds_read_b64_tr_b16 v[64:65], v32 offset:0
    ds_read_b64_tr_b16 v[66:67], v32 offset:1024
    ds_read_b64_tr_b16 v[68:69], v33 offset:0
    ds_read_b64_tr_b16 v[70:71], v33 offset:1024
    ds_read_b64_tr_b16 v[72:73], v32 offset:2048
    ds_read_b64_tr_b16 v[74:75], v32 offset:3072
    ds_read_b64_tr_b16 v[76:77], v33 offset:2048
    ds_read_b64_tr_b16 v[78:79], v33 offset:3072
    s_waitcnt lgkmcnt(0)
    s_waitcnt vmcnt(4)
    s_barrier
    s_add_u32 m0, s46, 85248
    s_add_u32 s57, s54, 253952
    buffer_load_dwordx4 v22, s[60:63], s57 offen lds
    s_add_u32 m0, s46, 86272
    s_add_u32 s57, s54, 262144
    buffer_load_dwordx4 v22, s[60:63], s57 offen lds
    s_add_u32 m0, s56, 2048
    s_add_u32 s57, s54, s55
    s_add_u32 s57, s57, 344064
    buffer_load_dwordx4 v22, s[60:63], s57 offen lds
    s_add_u32 m0, s56, 3072
    s_add_u32 s57, s54, s55
    s_add_u32 s57, s57, 352256
    buffer_load_dwordx4 v22, s[60:63], s57 offen lds
    v_mov_b32 v14, 163376
    s_mov_b32 s31, 0
L_lw_lag0:
    ds_read_b32 v15, v14
    s_waitcnt lgkmcnt(0)
    v_readfirstlane_b32 s30, v15
    s_add_u32 s31, s31, 1
    s_cmp_ge_u32 s30, 4
    s_cbranch_scc1 L_lx_lag0
    s_sleep 1
    s_cmp_lt_u32 s31, 64000
    s_cbranch_scc1 L_lw_lag0
L_lx_lag0:
    s_add_u32 m0, s46, 105792
    s_add_u32 s57, s54, 294912
    buffer_load_dwordx4 v22, s[60:63], s57 offen lds
    s_add_u32 m0, s46, 106816
    s_add_u32 s57, s54, 303104
    buffer_load_dwordx4 v22, s[60:63], s57 offen lds
    s_branch L_tail0
L_s15w_0:
    s_barrier
    s_add_u32 m0, s56, 2048
    s_add_u32 s57, s54, 16384
    buffer_load_dwordx4 v22, s[60:63], s57 offen lds
    s_add_u32 m0, s56, 3072
    s_add_u32 s57, s54, 24576
    buffer_load_dwordx4 v22, s[60:63], s57 offen lds
    s_add_u32 m0, s46, 3072
    s_add_u32 s57, s54, 90112
    buffer_load_dwordx4 v22, s[60:63], s57 offen lds
    s_add_u32 m0, s46, 4096
    s_add_u32 s57, s54, 98304
    buffer_load_dwordx4 v22, s[60:63], s57 offen lds
    s_add_u32 m0, s46, 23616
    s_add_u32 s57, s54, 131072
    buffer_load_dwordx4 v22, s[60:63], s57 offen lds
    s_add_u32 m0, s46, 24640
    s_add_u32 s57, s54, 139264
    buffer_load_dwordx4 v22, s[60:63], s57 offen lds
    s_add_u32 m0, s46, 44160
    s_add_u32 s57, s54, 172032
    buffer_load_dwordx4 v22, s[60:63], s57 offen lds
    s_add_u32 m0, s46, 45184
    s_add_u32 s57, s54, 180224
    buffer_load_dwordx4 v22, s[60:63], s57 offen lds
    s_add_u32 m0, s46, 64704
    s_add_u32 s57, s54, 212992
    buffer_load_dwordx4 v22, s[60:63], s57 offen lds
    s_add_u32 m0, s46, 65728
    s_add_u32 s57, s54, 221184
    buffer_load_dwordx4 v22, s[60:63], s57 offen lds
    s_add_u32 m0, s46, 85248
    s_add_u32 s57, s54, 253952
    buffer_load_dwordx4 v22, s[60:63], s57 offen lds
    s_add_u32 m0, s46, 86272
    s_add_u32 s57, s54, 262144
    buffer_load_dwordx4 v22, s[60:63], s57 offen lds
    s_add_u32 m0, s46, 105792
    s_add_u32 s57, s54, 294912
    buffer_load_dwordx4 v22, s[60:63], s57 offen lds
    s_add_u32 m0, s46, 106816
    s_add_u32 s57, s54, 303104
    buffer_load_dwordx4 v22, s[60:63], s57 offen lds
    s_waitcnt vmcnt(12)
    s_barrier
    ds_read_b64_tr_b16 v[48:49], v32 offset:0
    ds_read_b64_tr_b16 v[50:51], v32 offset:1024
    ds_read_b64_tr_b16 v[52:53], v33 offset:0
    ds_read_b64_tr_b16 v[54:55], v33 offset:1024
    ds_read_b64_tr_b16 v[56:57], v32 offset:2048
    ds_read_b64_tr_b16 v[58:59], v32 offset:3072
    ds_read_b64_tr_b16 v[60:61], v33 offset:2048
    ds_read_b64_tr_b16 v[62:63], v33 offset:3072
    s_waitcnt lgkmcnt(0)
    s_barrier
    s_add_u32 m0, s56, 2048
    s_add_u32 s57, s54, 49152
    buffer_load_dwordx4 v22, s[60:63], s57 offen lds
    s_add_u32 m0, s56, 3072
    s_add_u32 s57, s54, 57344
    buffer_load_dwordx4 v22, s[60:63], s57 offen lds
    s_waitcnt vmcnt(0)
    s_barrier
    ds_read_b64_tr_b16 v[64:65], v32 offset:0
    ds_read_b64_tr_b16 v[66:67], v32 offset:1024
    ds_read_b64_tr_b16 v[68:69], v33 offset:0
    ds_read_b64_tr_b16 v[70:71], v33 offset:1024
    ds_read_b64_tr_b16 v[72:73], v32 offset:2048
    ds_read_b64_tr_b16 v[74:75], v32 offset:3072
    ds_read_b64_tr_b16 v[76:77], v33 offset:2048
    ds_read_b64_tr_b16 v[78:79], v33 offset:3072
    s_waitcnt lgkmcnt(0)
    s_barrier
    s_add_u32 m0, s56, 2048
    s_add_u32 s57, s54, s55
    s_add_u32 s57, s57, 344064
    buffer_load_dwordx4 v22, s[60:63], s57 offen lds
    s_add_u32 m0, s56, 3072
    s_add_u32 s57, s54, s55
    s_add_u32 s57, s57, 352256
    buffer_load_dwordx4 v22, s[60:63], s57 offen lds
    s_cmp_eq_u32 s40, 4
    s_cbranch_scc0 L_s15_go
    v_and_b32 v21, 15, v7
    v_lshlrev_b32 v21, 7, v21
    s_and_b32 s31, s2, 7
    s_lshl_b32 s31, s31, 11
    s_add_u32 s31, s31, 131072
    s_mov_b32 s57, 0
L_gp_s:
    buffer_load_dword v20, v21, s[64:67], s31 offen sc1
    s_waitcnt vmcnt(0)
    v_cmp_gt_u32 vcc, 16, v20
    s_cbranch_vccz L_gp_oks
    s_sleep 4
    s_add_u32 s57, s57, 1
    s_cmp_lt_u32 s57, 8000
    s_cbranch_scc1 L_gp_s
L_gp_oks:
L_s15_go:
    s_waitcnt vmcnt(0)
    s_barrier
    s_branch L_tail0
L_tail0:
    ds_read_b64_tr_b16 v[80:81], v2 offset:0
    ds_read_b64_tr_b16 v[82:83], v2 offset:1024
    ds_read_b64_tr_b16 v[84:85], v3 offset:0
    ds_read_b64_tr_b16 v[86:87], v3 offset:1024
    ds_read_b64_tr_b16 v[88:89], v2 offset:2048
    ds_read_b64_tr_b16 v[90:91], v2 offset:3072
    ds_read_b64_tr_b16 v[92:93], v3 offset:2048
    ds_read_b64_tr_b16 v[94:95], v3 offset:3072
    ds_read_b64_tr_b16 v[96:97], v2 offset:4096
    ds_read_b64_tr_b16 v[98:99], v2 offset:20544
    ds_read_b64_tr_b16 v[100:101], v3 offset:4096
    ds_read_b64_tr_b16 v[102:103], v3 offset:20544
    s_waitcnt vmcnt(0)
    v_mov_b32 v14, 163348
    v_mov_b32 v15, 1
    s_mov_b64 exec, 1
    ds_add_u32 v14, v15
    s_mov_b64 exec, -1
    s_branch L_k3_c
L_k3_st:
    s_and_b32 s29, s41, 1
    s_mul_i32 s29, s29, 192
    s_cmp_eq_u32 s27, 15
    s_cselect_b32 s30, 0x40000000, 0
    v_add_u32 v14, s29, v7
    v_add_u32 v14, 0, v14
    v_mul_u32_u24 v15, 43691, v14
    v_lshrrev_b32 v15, 19, v15
    v_mul_u32_u24 v34, 12, v15
    v_sub_u32 v14, v14, v34
    v_lshlrev_b32 v14, 4, v14
    v_mul_u32_u24 v15, 2752, v15
    v_add_u32 v34, v14, v15
    v_add_u32 v34, s30, v34
    v_add_u32 v14, s29, v7
    v_add_u32 v14, 64, v14
    v_mul_u32_u24 v15, 43691, v14
    v_lshrrev_b32 v15, 19, v15
    v_mul_u32_u24 v35, 12, v15
    v_sub_u32 v14, v14, v35
    v_lshlrev_b32 v14, 4, v14
    v_mul_u32_u24 v15, 2752, v15
    v_add_u32 v35, v14, v15
    v_subrev_u32 v35, 1024, v35
    v_add_u32 v35, s30, v35
    v_add_u32 v14, s29, v7
    v_add_u32 v14, 128, v14
    v_mul_u32_u24 v15, 43691, v14
    v_lshrrev_b32 v15, 19, v15
    v_mul_u32_u24 v36, 12, v15
    v_sub_u32 v14, v14, v36
    v_lshlrev_b32 v14, 4, v14
    v_mul_u32_u24 v15, 2752, v15
    v_add_u32 v36, v14, v15
    v_subrev_u32 v36, 2048, v36
    v_add_u32 v36, s30, v36
    s_cmp_lt_u32 s41, 2
    s_cselect_b32 s54, s20, s22
    s_cselect_b32 s55, s21, s23
    s_mov_b32 s8, s54
    s_and_b32 s9, s55, 0xffff
    s_mov_b32 s10, 0x158000
    s_mov_b32 s11, 0x00020000
    s_mul_i32 s48, s27, 192
    s_and_b32 s28, s41, 1
    s_mul_i32 s28, s28, 3072
    s_lshr_b32 s29, s41, 1
    s_mul_i32 s29, s29, 6176
    s_add_u32 s28, s28, s29
    s_mul_i32 s46, s41, 5120
    s_add_u32 s64, s4, 0x1040000
    s_addc_u32 s65, s5, 0
    s_and_b32 s65, s65, 0xffff
    s_mov_b32 s66, 0x24800
    s_mov_b32 s67, 0x00020000
    s_and_b32 s36, s2, 7
    s_lshl_b32 s36, s36, 2
    s_bfe_u32 s37, s2, 0x20003
    s_add_u32 s36, s36, s37
    s_lshr_b32 s37, s2, 5
    s_mov_b32 s60, s52
    s_and_b32 s61, s53, 0xffff
    s_mov_b32 s62, 0x158000
    s_mov_b32 s63, 0x00020000
    s_mul_i32 s54, s41, 22
    s_cmp_eq_u32 s41, 3
    s_cselect_b32 s55, 1, 0
    s_sub_u32 s54, s54, s55
    s_lshl_b32 s54, s54, 14
    s_lshl_b32 s55, s37, 7
    s_add_u32 s54, s54, s55
    s_lshr_b32 s55, s41, 1
    s_sub_u32 s39, 22, s55
    s_lshl_b32 s39, s39, 14
    s_sub_u32 s55, 0, s55
    s_lshl_b32 s55, s55, 14
    s_mul_i32 s38, s37, 11
    s_lshr_b32 s38, s38, 2
    s_lshl_b32 s38, s38, 14
    s_lshl_b32 s56, s41, 12
    s_add_u32 s56, s56, 146432
    v_lshrrev_b32 v14, 3, v7
    v_bfe_u32 v15, v7, 4, 1
    v_lshlrev_b32 v15, 2, v15
    v_and_b32 v22, 7, v7
    v_xor_b32 v15, v15, v22
    v_lshlrev_b32 v15, 4, v15
    v_lshl_add_u32 v22, v14, 10, v15
    v_lshrrev_b32 v14, 5, v7
    v_bfe_u32 v15, v7, 2, 2
    v_lshl_add_u32 v14, v14, 2, v15
    v_lshlrev_b32 v14, 7, v14
    v_bfe_u32 v15, v7, 4, 1
    v_lshl_add_u32 v14, v15, 5, v14
    v_and_b32 v15, 3, v7
    v_lshl_add_u32 v14, v15, 3, v14
    v_bfe_u32 v15, v7, 3, 1
    v_lshl_add_u32 v2, v15, 6, v14
    v_xor_b32 v15, 1, v15
    v_lshl_add_u32 v3, v15, 6, v14
    s_lshl_b32 s29, s50, 12
    s_add_u32 s29, s29, 146432
    v_add_u32 v32, s29, v2
    v_add_u32 v33, s29, v3
    s_mul_i32 s29, s50, 5120
    v_add_u32 v2, s29, v2
    v_add_u32 v3, s29, v3
    v_add_u32 v4, 61632, v2
    v_add_u32 v5, 61632, v3
    v_add_u32 v6, 123264, v2
    v_add_u32 v8, 123264, v3
    s_mov_b32 s45, s50
    s_lshl_b32 s47, s51, 5
    v_bfe_u32 v14, v7, 2, 2
    v_add_u32 v15, s45, v14
    v_and_b32 v15, 3, v15
    v_lshlrev_b32 v15, 6, v15
    v_lshl_add_u32 v15, v14, 8, v15
    s_add_u32 s29, s47, 12352
    v_add_u32 v15, s29, v15
    v_and_b32 v14, 3, v7
    v_lshl_add_u32 v15, v14, 3, v15
    v_bfe_u32 v14, v7, 4, 1
    v_lshl_add_u32 v15, v14, 10, v15
    v_lshrrev_b32 v14, 5, v7
    v_lshlrev_b32 v14, 11, v14
    v_add_u32 v11, v14, v15
    v_add_u32 v12, 61632, v11
    v_add_u32 v13, 123264, v11
    v_mov_b32 v24, 0
    v_mov_b32 v25, 0
    v_mov_b32 v26, 0
    v_mov_b32 v27, 0
    s_mul_i32 s29, s45, 640
    s_add_u32 s29, s29, 143808
    s_lshl_b32 s43, s47, 3
    s_add_u32 s43, s43, s29
    s_lshl_b32 s42, s47, 1
    s_add_u32 s42, s42, s29
    s_add_u32 s42, s42, 512
    s_add_u32 s68, s4, 0x1020000
    s_addc_u32 s69, s5, 0
    s_and_b32 s69, s69, 0xffff
    s_mov_b32 s70, 0x4000
    s_mov_b32 s71, 0x00020000
    s_lshl_b32 s29, s26, 10
    s_lshl_b32 s30, s45, 8
    s_add_u32 s29, s29, s30
    s_lshl_b32 s47, s47, 2
    s_add_u32 s47, s47, s29
    v_and_b32 v23, 15, v7
    v_lshlrev_b32 v23, 3, v23
    s_and_b32 s72, s2, 7
    s_lshl_b32 s72, s72, 1
    s_add_u32 s72, s72, 1
    v_mov_b32 v14, 163384
    s_mov_b32 s31, 0
L_lw_wga:
    ds_read_b32 v15, v14
    s_waitcnt lgkmcnt(0)
    v_readfirstlane_b32 s30, v15
    s_add_u32 s31, s31, 1
    s_cmp_ge_u32 s30, 1
    s_cbranch_scc1 L_lx_wga
    s_sleep 2
    s_cmp_lt_u32 s31, 64000
    s_cbranch_scc1 L_lw_wga
L_lx_wga:
    s_sub_u32 s73, s72, 0
    s_and_b32 s73, s73, 15
    s_mul_i32 s73, s73, 88064
    s_add_u32 s73, s73, s48
    s_add_u32 m0, s28, 82176
    s_nop 0
    buffer_load_dwordx4 v34, s[8:11], s73 offen lds
    buffer_load_dwordx4 v35, s[8:11], s73 offen offset:1024 lds
    buffer_load_dwordx4 v36, s[8:11], s73 offen offset:2048 lds
    s_sub_u32 s73, s72, 1
    s_and_b32 s73, s73, 15
    s_mul_i32 s73, s73, 88064
    s_add_u32 s73, s73, s48
    s_add_u32 m0, s28, 102720
    s_nop 0
    buffer_load_dwordx4 v34, s[8:11], s73 offen lds
    buffer_load_dwordx4 v35, s[8:11], s73 offen offset:1024 lds
    buffer_load_dwordx4 v36, s[8:11], s73 offen offset:2048 lds
    s_sub_u32 s73, s72, 2
    s_and_b32 s73, s73, 15
    s_mul_i32 s73, s73, 88064
    s_add_u32 s73, s73, s48
    s_add_u32 m0, s28, 123264
    s_nop 0
    buffer_load_dwordx4 v34, s[8:11], s73 offen lds
    buffer_load_dwordx4 v35, s[8:11], s73 offen offset:1024 lds
    buffer_load_dwordx4 v36, s[8:11], s73 offen offset:2048 lds
    s_cmp_eq_u32 s40, 10
    s_cbranch_scc0 L_pz_skip
    v_and_b32 v21, 15, v7
    v_lshlrev_b32 v21, 7, v21
    s_and_b32 s31, s2, 7
    s_lshl_b32 s31, s31, 11
    s_add_u32 s31, s31, 131136
    s_mov_b32 s57, 0
L_pz_poll:
    buffer_load_dword v20, v21, s[64:67], s31 offen sc1
    s_waitcnt vmcnt(0)
    v_cmp_gt_u32 vcc, 16, v20
    s_cbranch_vccz L_pz_ok
    s_sleep 4
    s_add_u32 s57, s57, 1
    s_cmp_lt_u32 s57, 8000
    s_cbranch_scc1 L_pz_poll
L_pz_ok:
    v_mov_b32 v14, 163340
    v_mov_b32 v15, 1
    s_mov_b64 exec, 1
    ds_write_b32 v14, v15
    s_mov_b64 exec, -1
L_pz_skip:
    s_cmp_eq_u32 s27, 15
    s_cbranch_scc1 L_s15
    v_mov_b32 v14, 163352
    s_mov_b32 s31, 0
L_lw_cvf:
    ds_read_b32 v15, v14
    s_waitcnt lgkmcnt(0)
    v_readfirstlane_b32 s30, v15
    s_add_u32 s31, s31, 1
    s_cmp_ge_u32 s30, 4
    s_cbranch_scc1 L_lx_cvf
    s_sleep 2
    s_cmp_lt_u32 s31, 64000
    s_cbranch_scc1 L_lw_cvf
L_lx_cvf:
    s_sub_u32 s73, s72, 3
    s_and_b32 s73, s73, 15
    s_mul_i32 s73, s73, 88064
    s_add_u32 s73, s73, s48
    s_add_u32 m0, s28, 0
    s_nop 0
    buffer_load_dwordx4 v34, s[8:11], s73 offen lds
    buffer_load_dwordx4 v35, s[8:11], s73 offen offset:1024 lds
    buffer_load_dwordx4 v36, s[8:11], s73 offen offset:2048 lds
    s_sub_u32 s73, s72, 4
    s_and_b32 s73, s73, 15
    s_mul_i32 s73, s73, 88064
    s_add_u32 s73, s73, s48
    s_add_u32 m0, s28, 20544
    s_nop 0
    buffer_load_dwordx4 v34, s[8:11], s73 offen lds
    buffer_load_dwordx4 v35, s[8:11], s73 offen offset:1024 lds
    buffer_load_dwordx4 v36, s[8:11], s73 offen offset:2048 lds
    s_sub_u32 s73, s72, 5
    s_and_b32 s73, s73, 15
    s_mul_i32 s73, s73, 88064
    s_add_u32 s73, s73, s48
    s_add_u32 m0, s28, 41088
    s_nop 0
    buffer_load_dwordx4 v34, s[8:11], s73 offen lds
    buffer_load_dwordx4 v35, s[8:11], s73 offen offset:1024 lds
    buffer_load_dwordx4 v36, s[8:11], s73 offen offset:2048 lds
    s_sub_u32 s73, s72, 6
    s_and_b32 s73, s73, 15
    s_mul_i32 s73, s73, 88064
    s_add_u32 s73, s73, s48
    s_add_u32 m0, s28, 61632
    s_nop 0
    buffer_load_dwordx4 v34, s[8:11], s73 offen lds
    buffer_load_dwordx4 v35, s[8:11], s73 offen offset:1024 lds
    buffer_load_dwordx4 v36, s[8:11], s73 offen offset:2048 lds
    s_waitcnt lgkmcnt(0)
    s_waitcnt vmcnt(18)
    s_barrier
    s_waitcnt vmcnt(15)
    s_barrier
    s_waitcnt vmcnt(12)
    s_barrier
    s_sub_u32 s73, s72, 7
    s_and_b32 s73, s73, 15
    s_mul_i32 s73, s73, 88064
    s_add_u32 s73, s73, s48
    s_add_u32 m0, s28, 82176
    s_nop 0
    buffer_load_dwordx4 v34, s[8:11], s73 offen lds
    buffer_load_dwordx4 v35, s[8:11], s73 offen offset:1024 lds
    buffer_load_dwordx4 v36, s[8:11], s73 offen offset:2048 lds
    s_waitcnt vmcnt(12)
    s_barrier
    s_sub_u32 s73, s72, 8
    s_and_b32 s73, s73, 15
    s_mul_i32 s73, s73, 88064
    s_add_u32 s73, s73, s48
    s_add_u32 m0, s28, 102720
    s_nop 0
    buffer_load_dwordx4 v34, s[8:11], s73 offen lds
    buffer_load_dwordx4 v35, s[8:11], s73 offen offset:1024 lds
    buffer_load_dwordx4 v36, s[8:11], s73 offen offset:2048 lds
    s_add_u32 m0, s56, 0
    s_add_u32 s57, s54, 0
    buffer_load_dwordx4 v22, s[60:63], s57 offen lds
    s_waitcnt vmcnt(13)
    s_barrier
    s_sub_u32 s73, s72, 9
    s_and_b32 s73, s73, 15
    s_mul_i32 s73, s73, 88064
    s_add_u32 s73, s73, s48
    s_add_u32 m0, s28, 123264
    s_nop 0
    buffer_load_dwordx4 v34, s[8:11], s73 offen lds
    buffer_load_dwordx4 v35, s[8:11], s73 offen offset:1024 lds
    buffer_load_dwordx4 v36, s[8:11], s73 offen offset:2048 lds
    s_add_u32 m0, s56, 1024
    s_add_u32 s57, s54, 8192
    buffer_load_dwordx4 v22, s[60:63], s57 offen lds
    s_waitcnt vmcnt(14)
    s_barrier
    s_sub_u32 s73, s72, 10
    s_and_b32 s73, s73, 15
    s_mul_i32 s73, s73, 88064
    s_add_u32 s73, s73, s48
    s_add_u32 m0, s28, 0
    s_nop 0
    buffer_load_dwordx4 v34, s[8:11], s73 offen lds
    buffer_load_dwordx4 v35, s[8:11], s73 offen offset:1024 lds
    buffer_load_dwordx4 v36, s[8:11], s73 offen offset:2048 lds
    s_waitcnt vmcnt(14)
    s_barrier
    s_sub_u32 s73, s72, 11
    s_and_b32 s73, s73, 15
    s_mul_i32 s73, s73, 88064
    s_add_u32 s73, s73, s48
    s_add_u32 m0, s28, 20544
    s_nop 0
    buffer_load_dwordx4 v34, s[8:11], s73 offen lds
    buffer_load_dwordx4 v35, s[8:11], s73 offen offset:1024 lds
    buffer_load_dwordx4 v36, s[8:11], s73 offen offset:2048 lds
    s_waitcnt vmcnt(14)
    s_barrier
    s_sub_u32 s73, s72, 12
    s_and_b32 s73, s73, 15
    s_mul_i32 s73, s73, 88064
    s_add_u32 s73, s73, s48
    s_add_u32 m0, s28, 41088
    s_nop 0
    buffer_load_dwordx4 v34, s[8:11], s73 offen lds
    buffer_load_dwordx4 v35, s[8:11], s73 offen offset:1024 lds
    buffer_load_dwordx4 v36, s[8:11], s73 offen offset:2048 lds
    s_waitcnt vmcnt(14)
    s_barrier
    s_sub_u32 s73, s72, 13
    s_and_b32 s73, s73, 15
    s_mul_i32 s73, s73, 88064
    s_add_u32 s73, s73, s48
    s_add_u32 m0, s28, 61632
    s_nop 0
    buffer_load_dwordx4 v34, s[8:11], s73 offen lds
    buffer_load_dwordx4 v35, s[8:11], s73 offen offset:1024 lds
    buffer_load_dwordx4 v36, s[8:11], s73 offen offset:2048 lds
    s_waitcnt vmcnt(12)
    s_barrier
    s_sub_u32 s73, s72, 14
    s_and_b32 s73, s73, 15
    s_mul_i32 s73, s73, 88064
    s_add_u32 s73, s73, s48
    s_add_u32 m0, s28, 82176
    s_nop 0
    buffer_load_dwordx4 v34, s[8:11], s73 offen lds
    buffer_load_dwordx4 v35, s[8:11], s73 offen offset:1024 lds
    buffer_load_dwordx4 v36, s[8:11], s73 offen offset:2048 lds
    ds_read_b64_tr_b16 v[48:49], v32 offset:0
    ds_read_b64_tr_b16 v[50:51], v32 offset:1024
    ds_read_b64_tr_b16 v[52:53], v33 offset:0
    ds_read_b64_tr_b16 v[54:55], v33 offset:1024
    ds_read_b64_tr_b16 v[56:57], v32 offset:2048
    ds_read_b64_tr_b16 v[58:59], v32 offset:3072
    ds_read_b64_tr_b16 v[60:61], v33 offset:2048
    ds_read_b64_tr_b16 v[62:63], v33 offset:3072
    s_waitcnt lgkmcnt(0)
    s_waitcnt vmcnt(12)
    s_barrier
    s_sub_u32 s73, s72, 15
    s_and_b32 s73, s73, 15
    s_mul_i32 s73, s73, 88064
    s_add_u32 s73, s73, s48
    s_add_u32 m0, s28, 102720
    s_nop 0
    buffer_load_dwordx4 v34, s[8:11], s73 offen lds
    buffer_load_dwordx4 v35, s[8:11], s73 offen offset:1024 lds
    buffer_load_dwordx4 v36, s[8:11], s73 offen offset:2048 lds
    s_waitcnt vmcnt(12)
    s_barrier
    s_add_u32 m0, s56, 0
    s_add_u32 s57, s54, 32768
    buffer_load_dwordx4 v22, s[60:63], s57 offen lds
    s_add_u32 m0, s46, 123264
    s_add_u32 s57, s54, 311296
    buffer_load_dwordx4 v22, s[60:63], s57 offen lds
    s_add_u32 m0, s46, 124288
    s_add_u32 s57, s54, 319488
    buffer_load_dwordx4 v22, s[60:63], s57 offen lds
    s_waitcnt vmcnt(12)
    s_barrier
    s_add_u32 m0, s56, 1024
    s_add_u32 s57, s54, 40960
    buffer_load_dwordx4 v22, s[60:63], s57 offen lds
    s_add_u32 m0, s46, 0
    s_add_u32 s57, s54, 65536
    buffer_load_dwordx4 v22, s[60:63], s57 offen lds
    s_add_u32 m0, s46, 1024
    s_add_u32 s57, s54, 73728
    buffer_load_dwordx4 v22, s[60:63], s57 offen lds
    s_add_u32 m0, s46, 2048
    s_add_u32 s57, s54, 81920
    buffer_load_dwordx4 v22, s[60:63], s57 offen lds
    s_waitcnt vmcnt(13)
    s_barrier
    s_add_u32 m0, s46, 20544
    s_add_u32 s57, s54, 106496
    buffer_load_dwordx4 v22, s[60:63], s57 offen lds
    s_add_u32 m0, s46, 21568
    s_add_u32 s57, s54, 114688
    buffer_load_dwordx4 v22, s[60:63], s57 offen lds
    s_add_u32 m0, s46, 22592
    s_add_u32 s57, s54, 122880
    buffer_load_dwordx4 v22, s[60:63], s57 offen lds
    s_waitcnt vmcnt(13)
    s_barrier
    s_add_u32 m0, s46, 41088
    s_add_u32 s57, s54, 147456
    buffer_load_dwordx4 v22, s[60:63], s57 offen lds
    s_add_u32 m0, s46, 42112
    s_add_u32 s57, s54, 155648
    buffer_load_dwordx4 v22, s[60:63], s57 offen lds
    s_add_u32 m0, s46, 43136
    s_add_u32 s57, s54, 163840
    buffer_load_dwordx4 v22, s[60:63], s57 offen lds
    s_waitcnt vmcnt(9)
    s_barrier
    s_add_u32 m0, s46, 61632
    s_add_u32 s57, s54, 188416
    buffer_load_dwordx4 v22, s[60:63], s57 offen lds
    s_add_u32 m0, s46, 62656
    s_add_u32 s57, s54, 196608
    buffer_load_dwordx4 v22, s[60:63], s57 offen lds
    s_add_u32 m0, s46, 63680
    s_add_u32 s57, s54, 204800
    buffer_load_dwordx4 v22, s[60:63], s57 offen lds
    ds_read_b64_tr_b16 v[64:65], v32 offset:0
    ds_read_b64_tr_b16 v[66:67], v32 offset:1024
    ds_read_b64_tr_b16 v[68:69], v33 offset:0
    ds_read_b64_tr_b16 v[70:71], v33 offset:1024
    ds_read_b64_tr_b16 v[72:73], v32 offset:2048
    ds_read_b64_tr_b16 v[74:75], v32 offset:3072
    ds_read_b64_tr_b16 v[76:77], v33 offset:2048
    ds_read_b64_tr_b16 v[78:79], v33 offset:3072
    s_waitcnt lgkmcnt(0)
    s_waitcnt vmcnt(6)
    s_barrier
    s_add_u32 m0, s46, 82176
    s_add_u32 s57, s54, 229376
    buffer_load_dwordx4 v22, s[60:63], s57 offen lds
    s_add_u32 m0, s46, 83200
    s_add_u32 s57, s54, 237568
    buffer_load_dwordx4 v22, s[60:63], s57 offen lds
    s_add_u32 m0, s46, 84224
    s_add_u32 s57, s54, 245760
    buffer_load_dwordx4 v22, s[60:63], s57 offen lds
    s_add_u32 m0, s56, 0
    s_add_u32 s57, s54, s55
    s_add_u32 s57, s57, 327680
    buffer_load_dwordx4 v22, s[60:63], s57 offen lds
    s_add_u32 m0, s56, 1024
    s_add_u32 s57, s54, s55
    s_add_u32 s57, s57, 335872
    buffer_load_dwordx4 v22, s[60:63], s57 offen lds
    v_mov_b32 v14, 163376
    s_mov_b32 s31, 0
L_lw_lag1:
    ds_read_b32 v15, v14
    s_waitcnt lgkmcnt(0)
    v_readfirstlane_b32 s30, v15
    s_add_u32 s31, s31, 1
    s_cmp_ge_u32 s30, 4
    s_cbranch_scc1 L_lx_lag1
    s_sleep 1
    s_cmp_lt_u32 s31, 64000
    s_cbranch_scc1 L_lw_lag1
L_lx_lag1:
    s_add_u32 m0, s46, 102720
    s_add_u32 s57, s54, 270336
    buffer_load_dwordx4 v22, s[60:63], s57 offen lds
    s_add_u32 m0, s46, 103744
    s_add_u32 s57, s54, 278528
    buffer_load_dwordx4 v22, s[60:63], s57 offen lds
    s_add_u32 m0, s46, 104768
    s_add_u32 s57, s54, 286720
    buffer_load_dwordx4 v22, s[60:63], s57 offen lds
    s_branch L_tail1
L_s15w_1:
    s_barrier
    s_add_u32 m0, s56, 0
    s_add_u32 s57, s54, 0
    buffer_load_dwordx4 v22, s[60:63], s57 offen lds
    s_add_u32 m0, s56, 1024
    s_add_u32 s57, s54, 8192
    buffer_load_dwordx4 v22, s[60:63], s57 offen lds
    s_add_u32 m0, s46, 123264
    s_add_u32 s57, s54, 311296
    buffer_load_dwordx4 v22, s[60:63], s57 offen lds
    s_add_u32 m0, s46, 124288
    s_add_u32 s57, s54, 319488
    buffer_load_dwordx4 v22, s[60:63], s57 offen lds
    s_add_u32 m0, s46, 0
    s_add_u32 s57, s54, 65536
    buffer_load_dwordx4 v22, s[60:63], s57 offen lds
    s_add_u32 m0, s46, 1024
    s_add_u32 s57, s54, 73728
    buffer_load_dwordx4 v22, s[60:63], s57 offen lds
    s_add_u32 m0, s46, 2048
    s_add_u32 s57, s54, 81920
    buffer_load_dwordx4 v22, s[60:63], s57 offen lds
    s_add_u32 m0, s46, 20544
    s_add_u32 s57, s54, 106496
    buffer_load_dwordx4 v22, s[60:63], s57 offen lds
    s_add_u32 m0, s46, 21568
    s_add_u32 s57, s54, 114688
    buffer_load_dwordx4 v22, s[60:63], s57 offen lds
    s_add_u32 m0, s46, 22592
    s_add_u32 s57, s54, 122880
    buffer_load_dwordx4 v22, s[60:63], s57 offen lds
    s_add_u32 m0, s46, 41088
    s_add_u32 s57, s54, 147456
    buffer_load_dwordx4 v22, s[60:63], s57 offen lds
    s_add_u32 m0, s46, 42112
    s_add_u32 s57, s54, 155648
    buffer_load_dwordx4 v22, s[60:63], s57 offen lds
    s_add_u32 m0, s46, 43136
    s_add_u32 s57, s54, 163840
    buffer_load_dwordx4 v22, s[60:63], s57 offen lds
    s_add_u32 m0, s46, 61632
    s_add_u32 s57, s54, 188416
    buffer_load_dwordx4 v22, s[60:63], s57 offen lds
    s_add_u32 m0, s46, 62656
    s_add_u32 s57, s54, 196608
    buffer_load_dwordx4 v22, s[60:63], s57 offen lds
    s_add_u32 m0, s46, 63680
    s_add_u32 s57, s54, 204800
    buffer_load_dwordx4 v22, s[60:63], s57 offen lds
    s_add_u32 m0, s46, 82176
    s_add_u32 s57, s54, 229376
    buffer_load_dwordx4 v22, s[60:63], s57 offen lds
    s_add_u32 m0, s46, 83200
    s_add_u32 s57, s54, 237568
    buffer_load_dwordx4 v22, s[60:63], s57 offen lds
    s_add_u32 m0, s46, 84224
    s_add_u32 s57, s54, 245760
    buffer_load_dwordx4 v22, s[60:63], s57 offen lds
    s_add_u32 m0, s46, 102720
    s_add_u32 s57, s54, 270336
    buffer_load_dwordx4 v22, s[60:63], s57 offen lds
    s_add_u32 m0, s46, 103744
    s_add_u32 s57, s54, 278528
    buffer_load_dwordx4 v22, s[60:63], s57 offen lds
    s_add_u32 m0, s46, 104768
    s_add_u32 s57, s54, 286720
    buffer_load_dwordx4 v22, s[60:63], s57 offen lds
    s_waitcnt vmcnt(20)
    s_barrier
    ds_read_b64_tr_b16 v[48:49], v32 offset:0
    ds_read_b64_tr_b16 v[50:51], v32 offset:1024
    ds_read_b64_tr_b16 v[52:53], v33 offset:0
    ds_read_b64_tr_b16 v[54:55], v33 offset:1024
    ds_read_b64_tr_b16 v[56:57], v32 offset:2048
    ds_read_b64_tr_b16 v[58:59], v32 offset:3072
    ds_read_b64_tr_b16 v[60:61], v33 offset:2048
    ds_read_b64_tr_b16 v[62:63], v33 offset:3072
    s_waitcnt lgkmcnt(0)
    s_barrier
    s_add_u32 m0, s56, 0
    s_add_u32 s57, s54, 32768
    buffer_load_dwordx4 v22, s[60:63], s57 offen lds
    s_add_u32 m0, s56, 1024
    s_add_u32 s57, s54, 40960
    buffer_load_dwordx4 v22, s[60:63], s57 offen lds
    s_waitcnt vmcnt(0)
    s_barrier
    ds_read_b64_tr_b16 v[64:65], v32 offset:0
    ds_read_b64_tr_b16 v[66:67], v32 offset:1024
    ds_read_b64_tr_b16 v[68:69], v33 offset:0
    ds_read_b64_tr_b16 v[70:71], v33 offset:1024
    ds_read_b64_tr_b16 v[72:73], v32 offset:2048
    ds_read_b64_tr_b16 v[74:75], v32 offset:3072
    ds_read_b64_tr_b16 v[76:77], v33 offset:2048
    ds_read_b64_tr_b16 v[78:79], v33 offset:3072
    s_waitcnt lgkmcnt(0)
    s_barrier
    s_add_u32 m0, s56, 0
    s_add_u32 s57, s54, s55
    s_add_u32 s57, s57, 327680
    buffer_load_dwordx4 v22, s[60:63], s57 offen lds
    s_add_u32 m0, s56, 1024
    s_add_u32 s57, s54, s55
    s_add_u32 s57, s57, 335872
    buffer_load_dwordx4 v22, s[60:63], s57 offen lds
    s_waitcnt vmcnt(0)
    s_barrier
    s_branch L_tail1
L_tail1:
    ds_read_b64_tr_b16 v[80:81], v2 offset:0
    ds_read_b64_tr_b16 v[82:83], v2 offset:1024
    ds_read_b64_tr_b16 v[84:85], v3 offset:0
    ds_read_b64_tr_b16 v[86:87], v3 offset:1024
    ds_read_b64_tr_b16 v[88:89], v2 offset:2048
    ds_read_b64_tr_b16 v[90:91], v2 offset:3072
    ds_read_b64_tr_b16 v[92:93], v3 offset:2048
    ds_read_b64_tr_b16 v[94:95], v3 offset:3072
    ds_read_b64_tr_b16 v[96:97], v2 offset:4096
    ds_read_b64_tr_b16 v[98:99], v2 offset:20544
    ds_read_b64_tr_b16 v[100:101], v3 offset:4096
    ds_read_b64_tr_b16 v[102:103], v3 offset:20544
    s_waitcnt vmcnt(0)
    v_mov_b32 v14, 163348
    v_mov_b32 v15, 1
    s_mov_b64 exec, 1
    ds_add_u32 v14, v15
    s_mov_b64 exec, -1
L_k3_c:
    v_mov_b32 v9, v32
    v_mov_b32 v10, v33
    s_add_u32 s20, s4, 0xa80000
    s_addc_u32 s21, s5, 0
    s_and_b32 s21, s21, 0xffff
    s_mov_b32 s22, 0x560000
    s_mov_b32 s23, 0x00020000
    s_add_u32 s64, s4, 0x1040000
    s_addc_u32 s65, s5, 0
    s_and_b32 s65, s65, 0xffff
    s_mov_b32 s66, 0x24800
    s_mov_b32 s67, 0x00020000
    s_add_u32 s12, s4, 0x1100000
    s_addc_u32 s13, s5, 0
    s_and_b32 s13, s13, 0xffff
    s_mov_b32 s14, 0x400000
    s_mov_b32 s15, 0x00020000
    s_add_u32 s16, s4, 0x10000
    s_addc_u32 s17, s5, 0
    s_and_b32 s17, s17, 0xffff
    s_mov_b32 s18, 0x4000
    s_mov_b32 s19, 0x00020000
    s_mov_b32 s68, s6
    s_and_b32 s69, s7, 0xffff
    s_mov_b32 s70, 0x200000
    s_mov_b32 s71, 0x00020000
    s_lshl_b32 s32, s37, 6
    s_lshl_b32 s33, s50, 4
    s_add_u32 s32, s32, s33
    s_lshl_b32 s33, s36, 6
    s_lshl_b32 s34, s51, 5
    s_add_u32 s33, s33, s34
    v_and_b32 v11, 31, v7
    v_lshrrev_b32 v15, 5, v7
    v_lshlrev_b32 v12, 1, v11
    v_lshl_add_u32 v12, v15, 15, v12
    v_lshlrev_b32 v13, 4, v15
    v_lshl_add_u32 v14, v11, 10, v13
    v_lshlrev_b32 v1, 4, v7
    v_mov_b32 v152, 0
    v_mov_b32 v153, 0
    v_mov_b32 v154, 0
    v_mov_b32 v155, 0
    v_mov_b32 v156, 0
    v_mov_b32 v157, 0
    v_mov_b32 v158, 0
    v_mov_b32 v159, 0
    s_lshl_b32 s35, s32, 13
    s_lshl_b32 s34, s33, 1
    s_add_u32 s35, s35, s34
    s_lshl_b32 s38, s32, 2
    s_add_u32 s38, s38, 10240
    s_lshl_b32 s39, s33, 10
    s_lshl_b32 s34, s32, 1
    s_add_u32 s39, s39, s34
    s_lshl_b32 s38, s32, 5
    v_lshrrev_b32 v0, 5, v7
    v_lshlrev_b32 v0, 7, v0
    s_add_u32 s31, s35, 8192
    buffer_load_short_d16_hi v152, v12, s[12:15], s31 offen sc1
    s_add_u32 s31, s35, 12288
    buffer_load_short_d16_hi v153, v12, s[12:15], s31 offen sc1
    s_add_u32 s31, s35, 24576
    buffer_load_short_d16_hi v154, v12, s[12:15], s31 offen sc1
    s_add_u32 s31, s35, 28672
    buffer_load_short_d16_hi v155, v12, s[12:15], s31 offen sc1
    s_add_u32 s31, s35, 73728
    buffer_load_short_d16_hi v156, v12, s[12:15], s31 offen sc1
    s_add_u32 s31, s35, 77824
    buffer_load_short_d16_hi v157, v12, s[12:15], s31 offen sc1
    s_add_u32 s31, s35, 90112
    buffer_load_short_d16_hi v158, v12, s[12:15], s31 offen sc1
    s_add_u32 s31, s35, 94208
    buffer_load_short_d16_hi v159, v12, s[12:15], s31 offen sc1
    buffer_load_dwordx2 v[160:161], v0, s[16:19], s38 offen offset:0 sc1
    buffer_load_dwordx2 v[162:163], v0, s[16:19], s38 offen offset:64 sc1
    buffer_load_dwordx2 v[164:165], v0, s[16:19], s38 offen offset:256 sc1
    buffer_load_dwordx2 v[166:167], v0, s[16:19], s38 offen offset:320 sc1
    s_lshl_b32 s44, s36, 1
    s_add_u32 s44, s44, s51
    s_mul_i32 s44, s44, 88064
    s_mul_i32 s45, s50, 22
    s_cmp_eq_u32 s50, 3
    s_cselect_b32 s46, 1, 0
    s_sub_u32 s45, s45, s46
    s_lshl_b32 s45, s45, 10
    s_add_u32 s44, s44, s45
    s_lshr_b32 s46, s50, 1
    s_sub_u32 s73, 22, s46
    s_lshl_b32 s73, s73, 10
    s_sub_u32 s47, 0, s46
    s_lshl_b32 s47, s47, 10
    s_mul_i32 s72, s37, 11
    s_lshr_b32 s72, s72, 2
    s_lshl_b32 s72, s72, 10
    v_and_b32 v11, 7, v7
    v_lshlrev_b32 v11, 7, v11
    s_lshl_b32 s48, s36, 5
    s_mul_i32 s49, s50, 7
    s_add_u32 s48, s48, s49
    s_lshl_b32 s48, s48, 7
    v_mov_b32 v15, 163344
    s_mov_b32 s57, 0
L_lw_gate:
    ds_read_b32 v0, v15
    s_waitcnt lgkmcnt(0)
    v_readfirstlane_b32 s56, v0
    s_add_u32 s57, s57, 1
    s_cmp_ge_u32 s56, 4
    s_cbranch_scc1 L_lx_gate
    s_sleep 1
    s_cmp_lt_u32 s57, 64000
    s_cbranch_scc1 L_lw_gate
L_lx_gate:
    s_mov_b32 s58, 0
    s_mov_b64 exec, 0xff
L_c_poll:
    buffer_load_dword v0, v11, s[64:67], s48 offen sc1
    s_waitcnt vmcnt(0)
L_c_look:
    v_cmp_ne_u32 vcc, s59, v0
    s_cmp_eq_u64 vcc, 0
    s_cbranch_scc1 L_c_seen
    s_sleep 2
    s_add_u32 s58, s58, 1
    s_cmp_lt_u32 s58, 8000
    s_cbranch_scc1 L_c_poll
L_c_seen:
    s_mov_b64 exec, -1
    s_add_u32 s34, s44, 0
    buffer_load_dwordx4 v[104:107], v1, s[20:23], s34 offen sc1
    s_add_u32 s34, s44, 1024
    buffer_load_dwordx4 v[108:111], v1, s[20:23], s34 offen sc1
    s_add_u32 s34, s44, 2048
    buffer_load_dwordx4 v[112:115], v1, s[20:23], s34 offen sc1
    s_add_u32 s34, s44, 3072
    buffer_load_dwordx4 v[116:119], v1, s[20:23], s34 offen sc1
    s_add_u32 s34, s44, 4096
    buffer_load_dwordx4 v[120:123], v1, s[20:23], s34 offen sc1
    s_add_u32 s34, s44, 5120
    buffer_load_dwordx4 v[124:127], v1, s[20:23], s34 offen sc1
    v_mov_b32 v15, 163348
    s_mov_b32 s57, 0
L_lw_wd:
    ds_read_b32 v0, v15
    s_waitcnt lgkmcnt(0)
    v_readfirstlane_b32 s56, v0
    s_add_u32 s57, s57, 1
    s_cmp_ge_u32 s56, 8
    s_cbranch_scc1 L_lx_wd
    s_sleep 1
    s_cmp_lt_u32 s57, 64000
    s_cbranch_scc1 L_lw_wd
L_lx_wd:
    s_waitcnt vmcnt(5)
    v_mfma_f32_32x32x16_bf16 v[16:31], v[48:51], v[104:107], 0
    ds_read_b64_tr_b16 v[48:49], v2 offset:21568
    ds_read_b64_tr_b16 v[50:51], v2 offset:22592
    v_mfma_f32_32x32x16_bf16 v[32:47], v[52:55], v[104:107], 0
    ds_read_b64_tr_b16 v[52:53], v3 offset:21568
    ds_read_b64_tr_b16 v[54:55], v3 offset:22592
    s_add_u32 s34, s44, 6144
    buffer_load_dwordx4 v[128:131], v1, s[20:23], s34 offen sc1
    s_waitcnt vmcnt(5)
    v_mfma_f32_32x32x16_bf16 v[16:31], v[56:59], v[108:111], v[16:31]
    ds_read_b64_tr_b16 v[56:57], v2 offset:23616
    ds_read_b64_tr_b16 v[58:59], v2 offset:24640
    v_mfma_f32_32x32x16_bf16 v[32:47], v[60:63], v[108:111], v[32:47]
    ds_read_b64_tr_b16 v[60:61], v3 offset:23616
    ds_read_b64_tr_b16 v[62:63], v3 offset:24640
    s_add_u32 s34, s44, 7168
    buffer_load_dwordx4 v[132:135], v1, s[20:23], s34 offen sc1
    s_waitcnt vmcnt(5)
    v_mfma_f32_32x32x16_bf16 v[16:31], v[64:67], v[112:115], v[16:31]
    ds_read_b64_tr_b16 v[64:65], v2 offset:41088
    ds_read_b64_tr_b16 v[66:67], v2 offset:42112
    v_mfma_f32_32x32x16_bf16 v[32:47], v[68:71], v[112:115], v[32:47]
    ds_read_b64_tr_b16 v[68:69], v3 offset:41088
    ds_read_b64_tr_b16 v[70:71], v3 offset:42112
    s_add_u32 s34, s44, 8192
    buffer_load_dwordx4 v[136:139], v1, s[20:23], s34 offen sc1
    s_waitcnt vmcnt(5)
    v_mfma_f32_32x32x16_bf16 v[16:31], v[72:75], v[116:119], v[16:31]
    ds_read_b64_tr_b16 v[72:73], v2 offset:43136
    ds_read_b64_tr_b16 v[74:75], v2 offset:44160
    v_mfma_f32_32x32x16_bf16 v[32:47], v[76:79], v[116:119], v[32:47]
    ds_read_b64_tr_b16 v[76:77], v3 offset:43136
    ds_read_b64_tr_b16 v[78:79], v3 offset:44160
    s_add_u32 s34, s44, 9216
    buffer_load_dwordx4 v[140:143], v1, s[20:23], s34 offen sc1
    s_waitcnt vmcnt(5)
    v_mfma_f32_32x32x16_bf16 v[16:31], v[80:83], v[120:123], v[16:31]
    ds_read_b64_tr_b16 v[80:81], v2 offset:45184
    ds_read_b64_tr_b16 v[82:83], v4 offset:0
    v_mfma_f32_32x32x16_bf16 v[32:47], v[84:87], v[120:123], v[32:47]
    ds_read_b64_tr_b16 v[84:85], v3 offset:45184
    ds_read_b64_tr_b16 v[86:87], v5 offset:0
    s_add_u32 s34, s44, 10240
    buffer_load_dwordx4 v[144:147], v1, s[20:23], s34 offen sc1
    s_waitcnt vmcnt(5)
    v_mfma_f32_32x32x16_bf16 v[16:31], v[88:91], v[124:127], v[16:31]
    ds_read_b64_tr_b16 v[88:89], v4 offset:1024
    ds_read_b64_tr_b16 v[90:91], v4 offset:2048
    v_mfma_f32_32x32x16_bf16 v[32:47], v[92:95], v[124:127], v[32:47]
    ds_read_b64_tr_b16 v[92:93], v5 offset:1024
    ds_read_b64_tr_b16 v[94:95], v5 offset:2048
    s_add_u32 s34, s44, 11264
    buffer_load_dwordx4 v[148:151], v1, s[20:23], s34 offen sc1
    s_waitcnt vmcnt(5)
    v_mfma_f32_32x32x16_bf16 v[16:31], v[96:99], v[128:131], v[16:31]
    ds_read_b64_tr_b16 v[96:97], v4 offset:3072
    ds_read_b64_tr_b16 v[98:99], v4 offset:4096
    v_mfma_f32_32x32x16_bf16 v[32:47], v[100:103], v[128:131], v[32:47]
    ds_read_b64_tr_b16 v[100:101], v5 offset:3072
    ds_read_b64_tr_b16 v[102:103], v5 offset:4096
    s_add_u32 s34, s44, 12288
    buffer_load_dwordx4 v[104:107], v1, s[20:23], s34 offen sc1
    s_waitcnt vmcnt(5)
    s_waitcnt lgkmcnt(12)
    v_mfma_f32_32x32x16_bf16 v[16:31], v[48:51], v[132:135], v[16:31]
    ds_read_b64_tr_b16 v[48:49], v4 offset:20544
    ds_read_b64_tr_b16 v[50:51], v4 offset:21568
    v_mfma_f32_32x32x16_bf16 v[32:47], v[52:55], v[132:135], v[32:47]
    ds_read_b64_tr_b16 v[52:53], v5 offset:20544
    ds_read_b64_tr_b16 v[54:55], v5 offset:21568
    s_add_u32 s34, s44, 13312
    buffer_load_dwordx4 v[108:111], v1, s[20:23], s34 offen sc1
    s_waitcnt vmcnt(5)
    s_waitcnt lgkmcnt(12)
    v_mfma_f32_32x32x16_bf16 v[16:31], v[56:59], v[136:139], v[16:31]
    ds_read_b64_tr_b16 v[56:57], v4 offset:22592
    ds_read_b64_tr_b16 v[58:59], v4 offset:23616
    v_mfma_f32_32x32x16_bf16 v[32:47], v[60:63], v[136:139], v[32:47]
    ds_read_b64_tr_b16 v[60:61], v5 offset:22592
    ds_read_b64_tr_b16 v[62:63], v5 offset:23616
    s_add_u32 s34, s44, 14336
    buffer_load_dwordx4 v[112:115], v1, s[20:23], s34 offen sc1
    s_waitcnt vmcnt(5)
    s_waitcnt lgkmcnt(12)
    v_mfma_f32_32x32x16_bf16 v[16:31], v[64:67], v[140:143], v[16:31]
    ds_read_b64_tr_b16 v[64:65], v4 offset:24640
    ds_read_b64_tr_b16 v[66:67], v4 offset:41088
    v_mfma_f32_32x32x16_bf16 v[32:47], v[68:71], v[140:143], v[32:47]
    ds_read_b64_tr_b16 v[68:69], v5 offset:24640
    ds_read_b64_tr_b16 v[70:71], v5 offset:41088
    s_add_u32 s34, s44, 15360
    buffer_load_dwordx4 v[116:119], v1, s[20:23], s34 offen sc1
    s_waitcnt vmcnt(5)
    s_waitcnt lgkmcnt(12)
    v_mfma_f32_32x32x16_bf16 v[16:31], v[72:75], v[144:147], v[16:31]
    ds_read_b64_tr_b16 v[72:73], v4 offset:42112
    ds_read_b64_tr_b16 v[74:75], v4 offset:43136
    v_mfma_f32_32x32x16_bf16 v[32:47], v[76:79], v[144:147], v[32:47]
    ds_read_b64_tr_b16 v[76:77], v5 offset:42112
    ds_read_b64_tr_b16 v[78:79], v5 offset:43136
    s_add_u32 s34, s44, 16384
    buffer_load_dwordx4 v[120:123], v1, s[20:23], s34 offen sc1
    s_waitcnt vmcnt(5)
    s_waitcnt lgkmcnt(12)
    v_mfma_f32_32x32x16_bf16 v[16:31], v[80:83], v[148:151], v[16:31]
    ds_read_b64_tr_b16 v[80:81], v4 offset:44160
    ds_read_b64_tr_b16 v[82:83], v4 offset:45184
    v_mfma_f32_32x32x16_bf16 v[32:47], v[84:87], v[148:151], v[32:47]
    ds_read_b64_tr_b16 v[84:85], v5 offset:44160
    ds_read_b64_tr_b16 v[86:87], v5 offset:45184
    s_add_u32 s34, s44, 17408
    buffer_load_dwordx4 v[124:127], v1, s[20:23], s34 offen sc1
    s_waitcnt vmcnt(5)
    s_waitcnt lgkmcnt(12)
    v_mfma_f32_32x32x16_bf16 v[16:31], v[88:91], v[104:107], v[16:31]
    ds_read_b64_tr_b16 v[88:89], v6 offset:0
    ds_read_b64_tr_b16 v[90:91], v6 offset:1024
    v_mfma_f32_32x32x16_bf16 v[32:47], v[92:95], v[104:107], v[32:47]
    ds_read_b64_tr_b16 v[92:93], v8 offset:0
    ds_read_b64_tr_b16 v[94:95], v8 offset:1024
    s_add_u32 s34, s44, 18432
    buffer_load_dwordx4 v[128:131], v1, s[20:23], s34 offen sc1
    s_waitcnt vmcnt(5)
    s_waitcnt lgkmcnt(12)
    v_mfma_f32_32x32x16_bf16 v[16:31], v[96:99], v[108:111], v[16:31]
    ds_read_b64_tr_b16 v[96:97], v9 offset:0
    ds_read_b64_tr_b16 v[98:99], v9 offset:1024
    v_mfma_f32_32x32x16_bf16 v[32:47], v[100:103], v[108:111], v[32:47]
    ds_read_b64_tr_b16 v[100:101], v10 offset:0
    ds_read_b64_tr_b16 v[102:103], v10 offset:1024
    s_add_u32 s34, s44, 19456
    buffer_load_dwordx4 v[132:135], v1, s[20:23], s34 offen sc1
    s_waitcnt vmcnt(5)
    s_waitcnt lgkmcnt(12)
    v_mfma_f32_32x32x16_bf16 v[16:31], v[48:51], v[112:115], v[16:31]
    ds_read_b64_tr_b16 v[48:49], v9 offset:2048
    ds_read_b64_tr_b16 v[50:51], v9 offset:3072
    v_mfma_f32_32x32x16_bf16 v[32:47], v[52:55], v[112:115], v[32:47]
    ds_read_b64_tr_b16 v[52:53], v10 offset:2048
    ds_read_b64_tr_b16 v[54:55], v10 offset:3072
    s_add_u32 s34, s44, s47
    s_add_u32 s34, s34, 20480
    buffer_load_dwordx4 v[136:139], v1, s[20:23], s34 offen sc1
    s_waitcnt vmcnt(5)
    s_waitcnt lgkmcnt(12)
    v_mfma_f32_32x32x16_bf16 v[16:31], v[56:59], v[116:119], v[16:31]
    v_mfma_f32_32x32x16_bf16 v[32:47], v[60:63], v[116:119], v[32:47]
    s_add_u32 s34, s44, s47
    s_add_u32 s34, s34, 21504
    buffer_load_dwordx4 v[140:143], v1, s[20:23], s34 offen sc1
    s_waitcnt vmcnt(5)
    s_waitcnt lgkmcnt(12)
    v_mfma_f32_32x32x16_bf16 v[16:31], v[64:67], v[120:123], v[16:31]
    v_mfma_f32_32x32x16_bf16 v[32:47], v[68:71], v[120:123], v[32:47]
    s_lshl_b32 s29, s50, 2
    s_add_u32 s29, s29, 163360
    v_mov_b32 v15, s29
    v_mov_b32 v0, 1
    s_waitcnt lgkmcnt(0)
    s_mov_b64 exec, 1
    ds_add_u32 v15, v0
    s_mov_b64 exec, -1
    s_waitcnt vmcnt(4)
    s_waitcnt lgkmcnt(12)
    v_mfma_f32_32x32x16_bf16 v[16:31], v[72:75], v[124:127], v[16:31]
    v_mfma_f32_32x32x16_bf16 v[32:47], v[76:79], v[124:127], v[32:47]
    s_waitcnt vmcnt(3)
    s_waitcnt lgkmcnt(12)
    v_mfma_f32_32x32x16_bf16 v[16:31], v[80:83], v[128:131], v[16:31]
    v_mfma_f32_32x32x16_bf16 v[32:47], v[84:87], v[128:131], v[32:47]
    s_waitcnt vmcnt(2)
    s_waitcnt lgkmcnt(8)
    s_cmp_lt_u32 s50, 2
    s_cbranch_scc0 L_c_skip
    v_mfma_f32_32x32x16_bf16 v[16:31], v[88:91], v[132:135], v[16:31]
    v_mfma_f32_32x32x16_bf16 v[32:47], v[92:95], v[132:135], v[32:47]
L_c_skip:
    s_waitcnt vmcnt(1)
    s_waitcnt lgkmcnt(4)
    v_mfma_f32_32x32x16_bf16 v[16:31], v[96:99], v[136:139], v[16:31]
    v_mfma_f32_32x32x16_bf16 v[32:47], v[100:103], v[136:139], v[32:47]
    ds_read_b32 v2, v15
    s_waitcnt vmcnt(0)
    s_waitcnt lgkmcnt(0)
    v_mfma_f32_32x32x16_bf16 v[16:31], v[48:51], v[140:143], v[16:31]
    v_mfma_f32_32x32x16_bf16 v[32:47], v[52:55], v[140:143], v[32:47]
    s_mul_i32 s30, s51, 61632
    s_mul_i32 s31, s50, 5120
    s_add_u32 s31, s31, s30
    v_add_u32 v10, s31, v1
    v_add_u32 v11, s30, v1
    s_waitcnt lgkmcnt(0)
    v_readfirstlane_b32 s56, v2
    s_cmp_ge_u32 s56, 2
    s_cbranch_scc1 L_c_qok
    v_mov_b32 v15, s29
    s_mov_b32 s57, 0
L_lw_q:
    ds_read_b32 v0, v15
    s_waitcnt lgkmcnt(0)
    v_readfirstlane_b32 s56, v0
    s_add_u32 s57, s57, 1
    s_cmp_ge_u32 s56, 2
    s_cbranch_scc1 L_lx_q
    s_sleep 0
    s_cmp_lt_u32 s57, 64000
    s_cbranch_scc1 L_lw_q
L_lx_q:
L_c_qok:
    s_cmp_eq_u32 s50, 0
    s_cbranch_scc0 L_c_k1
    ds_write_b128 v10, v[24:27] offset:0
    ds_write_b128 v10, v[28:31] offset:1024
    ds_write_b128 v10, v[32:35] offset:20544
    ds_write_b128 v10, v[36:39] offset:21568
    ds_write_b128 v10, v[40:43] offset:41088
    ds_write_b128 v10, v[44:47] offset:42112
    s_waitcnt lgkmcnt(0)
    s_barrier
    ds_read_b128 v[48:51], v11 offset:5120
    ds_read_b128 v[52:55], v11 offset:6144
    ds_read_b128 v[56:59], v11 offset:10240
    ds_read_b128 v[60:63], v11 offset:11264
    ds_read_b128 v[64:67], v11 offset:15360
    ds_read_b128 v[68:71], v11 offset:16384
    s_waitcnt lgkmcnt(4)
    v_pk_add_f32 v[16:17], v[16:17], v[48:49]
    v_pk_add_f32 v[18:19], v[18:19], v[50:51]
    v_pk_add_f32 v[20:21], v[20:21], v[52:53]
    v_pk_add_f32 v[22:23], v[22:23], v[54:55]
    s_waitcnt lgkmcnt(2)
    v_pk_add_f32 v[16:17], v[16:17], v[56:57]
    v_pk_add_f32 v[18:19], v[18:19], v[58:59]
    v_pk_add_f32 v[20:21], v[20:21], v[60:61]
    v_pk_add_f32 v[22:23], v[22:23], v[62:63]
    s_waitcnt lgkmcnt(0)
    v_pk_add_f32 v[16:17], v[16:17], v[64:65]
    v_pk_add_f32 v[18:19], v[18:19], v[66:67]
    v_pk_add_f32 v[20:21], v[20:21], v[68:69]
    v_pk_add_f32 v[22:23], v[22:23], v[70:71]
    s_waitcnt vmcnt(0)
    v_pk_fma_f32 v[16:17], v[160:161], v[16:17], v[152:153]
    v_pk_fma_f32 v[18:19], v[162:163], v[18:19], v[154:155]
    v_pk_fma_f32 v[20:21], v[164:165], v[20:21], v[156:157]
    v_pk_fma_f32 v[22:23], v[166:167], v[22:23], v[158:159]
    v_cvt_pk_bf16_f32 v48, v16, v17
    v_cvt_pk_bf16_f32 v49, v18, v19
    v_cvt_pk_bf16_f32 v50, v20, v21
    v_cvt_pk_bf16_f32 v51, v22, v23
    s_nop 0
    v_permlane32_swap_b32 v48, v50
    v_permlane32_swap_b32 v49, v51
    buffer_store_dwordx4 v[48:51], v14, s[68:71], s39 offen
    s_branch L_c_done
L_c_k1:
    s_cmp_eq_u32 s50, 1
    s_cbranch_scc0 L_c_k2
    ds_write_b128 v10, v[16:19] offset:0
    ds_write_b128 v10, v[20:23] offset:1024
    ds_write_b128 v10, v[32:35] offset:20544
    ds_write_b128 v10, v[36:39] offset:21568
    ds_write_b128 v10, v[40:43] offset:41088
    ds_write_b128 v10, v[44:47] offset:42112
    s_waitcnt lgkmcnt(0)
    s_barrier
    ds_read_b128 v[48:51], v11 offset:0
    ds_read_b128 v[52:55], v11 offset:1024
    ds_read_b128 v[56:59], v11 offset:30784
    ds_read_b128 v[60:63], v11 offset:31808
    ds_read_b128 v[64:67], v11 offset:35904
    ds_read_b128 v[68:71], v11 offset:36928
    s_waitcnt lgkmcnt(4)
    v_pk_add_f32 v[24:25], v[24:25], v[48:49]
    v_pk_add_f32 v[26:27], v[26:27], v[50:51]
    v_pk_add_f32 v[28:29], v[28:29], v[52:53]
    v_pk_add_f32 v[30:31], v[30:31], v[54:55]
    s_waitcnt lgkmcnt(2)
    v_pk_add_f32 v[24:25], v[24:25], v[56:57]
    v_pk_add_f32 v[26:27], v[26:27], v[58:59]
    v_pk_add_f32 v[28:29], v[28:29], v[60:61]
    v_pk_add_f32 v[30:31], v[30:31], v[62:63]
    s_waitcnt lgkmcnt(0)
    v_pk_add_f32 v[24:25], v[24:25], v[64:65]
    v_pk_add_f32 v[26:27], v[26:27], v[66:67]
    v_pk_add_f32 v[28:29], v[28:29], v[68:69]
    v_pk_add_f32 v[30:31], v[30:31], v[70:71]
    s_waitcnt vmcnt(0)
    v_pk_fma_f32 v[24:25], v[160:161], v[24:25], v[152:153]
    v_pk_fma_f32 v[26:27], v[162:163], v[26:27], v[154:155]
    v_pk_fma_f32 v[28:29], v[164:165], v[28:29], v[156:157]
    v_pk_fma_f32 v[30:31], v[166:167], v[30:31], v[158:159]
    v_cvt_pk_bf16_f32 v48, v24, v25
    v_cvt_pk_bf16_f32 v49, v26, v27
    v_cvt_pk_bf16_f32 v50, v28, v29
    v_cvt_pk_bf16_f32 v51, v30, v31
    s_nop 0
    v_permlane32_swap_b32 v48, v50
    v_permlane32_swap_b32 v49, v51
    buffer_store_dwordx4 v[48:51], v14, s[68:71], s39 offen
    s_branch L_c_done
L_c_k2:
    s_cmp_eq_u32 s50, 2
    s_cbranch_scc0 L_c_k3
    ds_write_b128 v10, v[16:19] offset:0
    ds_write_b128 v10, v[20:23] offset:1024
    ds_write_b128 v10, v[24:27] offset:20544
    ds_write_b128 v10, v[28:31] offset:21568
    ds_write_b128 v10, v[40:43] offset:41088
    ds_write_b128 v10, v[44:47] offset:42112
    s_waitcnt lgkmcnt(0)
    s_barrier
    ds_read_b128 v[48:51], v11 offset:20544
    ds_read_b128 v[52:55], v11 offset:21568
    ds_read_b128 v[56:59], v11 offset:25664
    ds_read_b128 v[60:63], v11 offset:26688
    ds_read_b128 v[64:67], v11 offset:56448
    ds_read_b128 v[68:71], v11 offset:57472
    s_waitcnt lgkmcnt(4)
    v_pk_add_f32 v[32:33], v[32:33], v[48:49]
    v_pk_add_f32 v[34:35], v[34:35], v[50:51]
    v_pk_add_f32 v[36:37], v[36:37], v[52:53]
    v_pk_add_f32 v[38:39], v[38:39], v[54:55]
    s_waitcnt lgkmcnt(2)
    v_pk_add_f32 v[32:33], v[32:33], v[56:57]
    v_pk_add_f32 v[34:35], v[34:35], v[58:59]
    v_pk_add_f32 v[36:37], v[36:37], v[60:61]
    v_pk_add_f32 v[38:39], v[38:39], v[62:63]
    s_waitcnt lgkmcnt(0)
    v_pk_add_f32 v[32:33], v[32:33], v[64:65]
    v_pk_add_f32 v[34:35], v[34:35], v[66:67]
    v_pk_add_f32 v[36:37], v[36:37], v[68:69]
    v_pk_add_f32 v[38:39], v[38:39], v[70:71]
    s_waitcnt vmcnt(0)
    v_pk_fma_f32 v[32:33], v[160:161], v[32:33], v[152:153]
    v_pk_fma_f32 v[34:35], v[162:163], v[34:35], v[154:155]
    v_pk_fma_f32 v[36:37], v[164:165], v[36:37], v[156:157]
    v_pk_fma_f32 v[38:39], v[166:167], v[38:39], v[158:159]
    v_cvt_pk_bf16_f32 v48, v32, v33
    v_cvt_pk_bf16_f32 v49, v34, v35
    v_cvt_pk_bf16_f32 v50, v36, v37
    v_cvt_pk_bf16_f32 v51, v38, v39
    s_nop 0
    v_permlane32_swap_b32 v48, v50
    v_permlane32_swap_b32 v49, v51
    buffer_store_dwordx4 v[48:51], v14, s[68:71], s39 offen
    s_branch L_c_done
L_c_k3:
    ds_write_b128 v10, v[16:19] offset:0
    ds_write_b128 v10, v[20:23] offset:1024
    ds_write_b128 v10, v[24:27] offset:20544
    ds_write_b128 v10, v[28:31] offset:21568
    ds_write_b128 v10, v[32:35] offset:41088
    ds_write_b128 v10, v[36:39] offset:42112
    s_waitcnt lgkmcnt(0)
    s_barrier
    ds_read_b128 v[48:51], v11 offset:41088
    ds_read_b128 v[52:55], v11 offset:42112
    ds_read_b128 v[56:59], v11 offset:46208
    ds_read_b128 v[60:63], v11 offset:47232
    ds_read_b128 v[64:67], v11 offset:51328
    ds_read_b128 v[68:71], v11 offset:52352
    s_waitcnt lgkmcnt(4)
    v_pk_add_f32 v[40:41], v[40:41], v[48:49]
    v_pk_add_f32 v[42:43], v[42:43], v[50:51]
    v_pk_add_f32 v[44:45], v[44:45], v[52:53]
    v_pk_add_f32 v[46:47], v[46:47], v[54:55]
    s_waitcnt lgkmcnt(2)
    v_pk_add_f32 v[40:41], v[40:41], v[56:57]
    v_pk_add_f32 v[42:43], v[42:43], v[58:59]
    v_pk_add_f32 v[44:45], v[44:45], v[60:61]
    v_pk_add_f32 v[46:47], v[46:47], v[62:63]
    s_waitcnt lgkmcnt(0)
    v_pk_add_f32 v[40:41], v[40:41], v[64:65]
    v_pk_add_f32 v[42:43], v[42:43], v[66:67]
    v_pk_add_f32 v[44:45], v[44:45], v[68:69]
    v_pk_add_f32 v[46:47], v[46:47], v[70:71]
    s_waitcnt vmcnt(0)
    v_pk_fma_f32 v[40:41], v[160:161], v[40:41], v[152:153]
    v_pk_fma_f32 v[42:43], v[162:163], v[42:43], v[154:155]
    v_pk_fma_f32 v[44:45], v[164:165], v[44:45], v[156:157]
    v_pk_fma_f32 v[46:47], v[166:167], v[46:47], v[158:159]
    v_cvt_pk_bf16_f32 v48, v40, v41
    v_cvt_pk_bf16_f32 v49, v42, v43
    v_cvt_pk_bf16_f32 v50, v44, v45
    v_cvt_pk_bf16_f32 v51, v46, v47
    s_nop 0
    v_permlane32_swap_b32 v48, v50
    v_permlane32_swap_b32 v49, v51
    buffer_store_dwordx4 v[48:51], v14, s[68:71], s39 offen
L_c_done:
    s_branch L_k3_done
L_s15:
    s_waitcnt vmcnt(0)
    v_mov_b32 v14, 163340
    s_mov_b32 s31, 0
L_lw_s15p:
    ds_read_b32 v15, v14
    s_waitcnt lgkmcnt(0)
    v_readfirstlane_b32 s30, v15
    s_add_u32 s31, s31, 1
    s_cmp_ge_u32 s30, 1
    s_cbranch_scc1 L_lx_s15p
    s_sleep 1
    s_cmp_lt_u32 s31, 64000
    s_cbranch_scc1 L_lw_s15p
L_lx_s15p:
    v_mov_b32 v14, 163356
    s_mov_b32 s31, 0
L_lw_s15c:
    ds_read_b32 v15, v14
    s_waitcnt lgkmcnt(0)
    v_readfirstlane_b32 s30, v15
    s_add_u32 s31, s31, 1
    s_cmp_ge_u32 s30, 4
    s_cbranch_scc1 L_lx_s15c
    s_sleep 1
    s_cmp_lt_u32 s31, 64000
    s_cbranch_scc1 L_lw_s15c
L_lx_s15c:
    s_add_u32 s12, s4, 0x1100000
    s_addc_u32 s13, s5, 0
    s_and_b32 s13, s13, 0xffff
    s_mov_b32 s14, 0x400000
    s_mov_b32 s15, 0x00020000
    v_and_b32 v14, 15, v7
    v_lshlrev_b32 v14, 4, v14
    v_bfe_u32 v15, v7, 4, 1
    v_lshl_add_u32 v14, v15, 12, v14
    v_lshrrev_b32 v15, 5, v7
    v_lshl_add_u32 v46, v15, 14, v14
    s_sub_u32 s29, s40, 4
    s_lshl_b32 s48, s29, 19
    s_lshl_b32 s30, s26, 8
    s_add_u32 s48, s48, s30
    s_add_u32 s48, s48, 8192
    s_mov_b32 s58, 0
    s_add_u32 s73, s48, 0
    buffer_load_dwordx4 v[48:51], v46, s[12:15], s73 offen sc1
    s_add_u32 s73, s48, 32768
    buffer_load_dwordx4 v[52:55], v46, s[12:15], s73 offen sc1
    s_add_u32 s73, s48, 65536
    buffer_load_dwordx4 v[56:59], v46, s[12:15], s73 offen sc1
    s_add_u32 s73, s48, 98304
    buffer_load_dwordx4 v[60:63], v46, s[12:15], s73 offen sc1
    s_add_u32 s73, s48, 131072
    buffer_load_dwordx4 v[64:67], v46, s[12:15], s73 offen sc1
    s_add_u32 s73, s48, 163840
    buffer_load_dwordx4 v[68:71], v46, s[12:15], s73 offen sc1
    s_add_u32 s73, s48, 196608
    buffer_load_dwordx4 v[72:75], v46, s[12:15], s73 offen sc1
    s_add_u32 s73, s48, 229376
    buffer_load_dwordx4 v[76:79], v46, s[12:15], s73 offen sc1
    s_add_u32 s73, s48, 262144
    buffer_load_dwordx4 v[80:83], v46, s[12:15], s73 offen sc1
    s_add_u32 s73, s48, 294912
    buffer_load_dwordx4 v[84:87], v46, s[12:15], s73 offen sc1
    s_add_u32 s73, s48, 327680
    buffer_load_dwordx4 v[88:91], v46, s[12:15], s73 offen sc1
    s_add_u32 s73, s48, 360448
    buffer_load_dwordx4 v[92:95], v46, s[12:15], s73 offen sc1
    s_add_u32 s73, s48, 393216
    buffer_load_dwordx4 v[96:99], v46, s[12:15], s73 offen sc1
    s_add_u32 s73, s48, 425984
    buffer_load_dwordx4 v[100:103], v46, s[12:15], s73 offen sc1
    s_add_u32 s73, s48, 458752
    buffer_load_dwordx4 v[104:107], v46, s[12:15], s73 offen sc1
    s_add_u32 s73, s48, 491520
    buffer_load_dwordx4 v[108:111], v46, s[12:15], s73 offen sc1
    v_mov_b32 v112, 0
    v_mov_b32 v120, 0
    v_mov_b32 v113, 0
    v_mov_b32 v121, 0
    v_mov_b32 v114, 0
    v_mov_b32 v122, 0
    v_mov_b32 v115, 0
    v_mov_b32 v123, 0
    v_mov_b32 v116, 0
    v_mov_b32 v124, 0
    v_mov_b32 v117, 0
    v_mov_b32 v125, 0
    v_mov_b32 v118, 0
    v_mov_b32 v126, 0
    v_mov_b32 v119, 0
    v_mov_b32 v127, 0
L_s15v0:
    s_waitcnt vmcnt(15)
    v_cmp_eq_u32 vcc, s59, v49
    v_cmp_eq_u32 s[30:31], s59, v51
    s_or_b64 vcc, vcc, s[30:31]
    s_cmp_eq_u64 vcc, 0
    s_cbranch_scc0 L_s15r0
L_s15k0:
    v_lshlrev_b32 v128, 16, v48
    v_and_b32 v129, 0xffff0000, v48
    v_pk_add_f32 v[112:113], v[112:113], v[128:129]
    v_pk_fma_f32 v[120:121], v[128:129], v[128:129], v[120:121]
    v_lshlrev_b32 v130, 16, v49
    v_and_b32 v131, 0xffff0000, v49
    v_pk_add_f32 v[114:115], v[114:115], v[130:131]
    v_pk_fma_f32 v[122:123], v[130:131], v[130:131], v[122:123]
    v_lshlrev_b32 v128, 16, v50
    v_and_b32 v129, 0xffff0000, v50
    v_pk_add_f32 v[116:117], v[116:117], v[128:129]
    v_pk_fma_f32 v[124:125], v[128:129], v[128:129], v[124:125]
    v_lshlrev_b32 v130, 16, v51
    v_and_b32 v131, 0xffff0000, v51
    v_pk_add_f32 v[118:119], v[118:119], v[130:131]
    v_pk_fma_f32 v[126:127], v[130:131], v[130:131], v[126:127]
L_s15v1:
    s_waitcnt vmcnt(14)
    v_cmp_eq_u32 vcc, s59, v53
    v_cmp_eq_u32 s[30:31], s59, v55
    s_or_b64 vcc, vcc, s[30:31]
    s_cmp_eq_u64 vcc, 0
    s_cbranch_scc0 L_s15r1
L_s15k1:
    v_lshlrev_b32 v128, 16, v52
    v_and_b32 v129, 0xffff0000, v52
    v_pk_add_f32 v[112:113], v[112:113], v[128:129]
    v_pk_fma_f32 v[120:121], v[128:129], v[128:129], v[120:121]
    v_lshlrev_b32 v130, 16, v53
    v_and_b32 v131, 0xffff0000, v53
    v_pk_add_f32 v[114:115], v[114:115], v[130:131]
    v_pk_fma_f32 v[122:123], v[130:131], v[130:131], v[122:123]
    v_lshlrev_b32 v128, 16, v54
    v_and_b32 v129, 0xffff0000, v54
    v_pk_add_f32 v[116:117], v[116:117], v[128:129]
    v_pk_fma_f32 v[124:125], v[128:129], v[128:129], v[124:125]
    v_lshlrev_b32 v130, 16, v55
    v_and_b32 v131, 0xffff0000, v55
    v_pk_add_f32 v[118:119], v[118:119], v[130:131]
    v_pk_fma_f32 v[126:127], v[130:131], v[130:131], v[126:127]
L_s15v2:
    s_waitcnt vmcnt(13)
    v_cmp_eq_u32 vcc, s59, v57
    v_cmp_eq_u32 s[30:31], s59, v59
    s_or_b64 vcc, vcc, s[30:31]
    s_cmp_eq_u64 vcc, 0
    s_cbranch_scc0 L_s15r2
L_s15k2:
    v_lshlrev_b32 v128, 16, v56
    v_and_b32 v129, 0xffff0000, v56
    v_pk_add_f32 v[112:113], v[112:113], v[128:129]
    v_pk_fma_f32 v[120:121], v[128:129], v[128:129], v[120:121]
    v_lshlrev_b32 v130, 16, v57
    v_and_b32 v131, 0xffff0000, v57
    v_pk_add_f32 v[114:115], v[114:115], v[130:131]
    v_pk_fma_f32 v[122:123], v[130:131], v[130:131], v[122:123]
    v_lshlrev_b32 v128, 16, v58
    v_and_b32 v129, 0xffff0000, v58
    v_pk_add_f32 v[116:117], v[116:117], v[128:129]
    v_pk_fma_f32 v[124:125], v[128:129], v[128:129], v[124:125]
    v_lshlrev_b32 v130, 16, v59
    v_and_b32 v131, 0xffff0000, v59
    v_pk_add_f32 v[118:119], v[118:119], v[130:131]
    v_pk_fma_f32 v[126:127], v[130:131], v[130:131], v[126:127]
L_s15v3:
    s_waitcnt vmcnt(12)
    v_cmp_eq_u32 vcc, s59, v61
    v_cmp_eq_u32 s[30:31], s59, v63
    s_or_b64 vcc, vcc, s[30:31]
    s_cmp_eq_u64 vcc, 0
    s_cbranch_scc0 L_s15r3
L_s15k3:
    v_lshlrev_b32 v128, 16, v60
    v_and_b32 v129, 0xffff0000, v60
    v_pk_add_f32 v[112:113], v[112:113], v[128:129]
    v_pk_fma_f32 v[120:121], v[128:129], v[128:129], v[120:121]
    v_lshlrev_b32 v130, 16, v61
    v_and_b32 v131, 0xffff0000, v61
    v_pk_add_f32 v[114:115], v[114:115], v[130:131]
    v_pk_fma_f32 v[122:123], v[130:131], v[130:131], v[122:123]
    v_lshlrev_b32 v128, 16, v62
    v_and_b32 v129, 0xffff0000, v62
    v_pk_add_f32 v[116:117], v[116:117], v[128:129]
    v_pk_fma_f32 v[124:125], v[128:129], v[128:129], v[124:125]
    v_lshlrev_b32 v130, 16, v63
    v_and_b32 v131, 0xffff0000, v63
    v_pk_add_f32 v[118:119], v[118:119], v[130:131]
    v_pk_fma_f32 v[126:127], v[130:131], v[130:131], v[126:127]
L_s15v4:
    s_waitcnt vmcnt(11)
    v_cmp_eq_u32 vcc, s59, v65
    v_cmp_eq_u32 s[30:31], s59, v67
    s_or_b64 vcc, vcc, s[30:31]
    s_cmp_eq_u64 vcc, 0
    s_cbranch_scc0 L_s15r4
L_s15k4:
    v_lshlrev_b32 v128, 16, v64
    v_and_b32 v129, 0xffff0000, v64
    v_pk_add_f32 v[112:113], v[112:113], v[128:129]
    v_pk_fma_f32 v[120:121], v[128:129], v[128:129], v[120:121]
    v_lshlrev_b32 v130, 16, v65
    v_and_b32 v131, 0xffff0000, v65
    v_pk_add_f32 v[114:115], v[114:115], v[130:131]
    v_pk_fma_f32 v[122:123], v[130:131], v[130:131], v[122:123]
    v_lshlrev_b32 v128, 16, v66
    v_and_b32 v129, 0xffff0000, v66
    v_pk_add_f32 v[116:117], v[116:117], v[128:129]
    v_pk_fma_f32 v[124:125], v[128:129], v[128:129], v[124:125]
    v_lshlrev_b32 v130, 16, v67
    v_and_b32 v131, 0xffff0000, v67
    v_pk_add_f32 v[118:119], v[118:119], v[130:131]
    v_pk_fma_f32 v[126:127], v[130:131], v[130:131], v[126:127]
L_s15v5:
    s_waitcnt vmcnt(10)
    v_cmp_eq_u32 vcc, s59, v69
    v_cmp_eq_u32 s[30:31], s59, v71
    s_or_b64 vcc, vcc, s[30:31]
    s_cmp_eq_u64 vcc, 0
    s_cbranch_scc0 L_s15r5
L_s15k5:
    v_lshlrev_b32 v128, 16, v68
    v_and_b32 v129, 0xffff0000, v68
    v_pk_add_f32 v[112:113], v[112:113], v[128:129]
    v_pk_fma_f32 v[120:121], v[128:129], v[128:129], v[120:121]
    v_lshlrev_b32 v130, 16, v69
    v_and_b32 v131, 0xffff0000, v69
    v_pk_add_f32 v[114:115], v[114:115], v[130:131]
    v_pk_fma_f32 v[122:123], v[130:131], v[130:131], v[122:123]
    v_lshlrev_b32 v128, 16, v70
    v_and_b32 v129, 0xffff0000, v70
    v_pk_add_f32 v[116:117], v[116:117], v[128:129]
    v_pk_fma_f32 v[124:125], v[128:129], v[128:129], v[124:125]
    v_lshlrev_b32 v130, 16, v71
    v_and_b32 v131, 0xffff0000, v71
    v_pk_add_f32 v[118:119], v[118:119], v[130:131]
    v_pk_fma_f32 v[126:127], v[130:131], v[130:131], v[126:127]
L_s15v6:
    s_waitcnt vmcnt(9)
    v_cmp_eq_u32 vcc, s59, v73
    v_cmp_eq_u32 s[30:31], s59, v75
    s_or_b64 vcc, vcc, s[30:31]
    s_cmp_eq_u64 vcc, 0
    s_cbranch_scc0 L_s15r6
L_s15k6:
    v_lshlrev_b32 v128, 16, v72
    v_and_b32 v129, 0xffff0000, v72
    v_pk_add_f32 v[112:113], v[112:113], v[128:129]
    v_pk_fma_f32 v[120:121], v[128:129], v[128:129], v[120:121]
    v_lshlrev_b32 v130, 16, v73
    v_and_b32 v131, 0xffff0000, v73
    v_pk_add_f32 v[114:115], v[114:115], v[130:131]
    v_pk_fma_f32 v[122:123], v[130:131], v[130:131], v[122:123]
    v_lshlrev_b32 v128, 16, v74
    v_and_b32 v129, 0xffff0000, v74
    v_pk_add_f32 v[116:117], v[116:117], v[128:129]
    v_pk_fma_f32 v[124:125], v[128:129], v[128:129], v[124:125]
    v_lshlrev_b32 v130, 16, v75
    v_and_b32 v131, 0xffff0000, v75
    v_pk_add_f32 v[118:119], v[118:119], v[130:131]
    v_pk_fma_f32 v[126:127], v[130:131], v[130:131], v[126:127]
L_s15v7:
    s_waitcnt vmcnt(8)
    v_cmp_eq_u32 vcc, s59, v77
    v_cmp_eq_u32 s[30:31], s59, v79
    s_or_b64 vcc, vcc, s[30:31]
    s_cmp_eq_u64 vcc, 0
    s_cbranch_scc0 L_s15r7
L_s15k7:
    v_lshlrev_b32 v128, 16, v76
    v_and_b32 v129, 0xffff0000, v76
    v_pk_add_f32 v[112:113], v[112:113], v[128:129]
    v_pk_fma_f32 v[120:121], v[128:129], v[128:129], v[120:121]
    v_lshlrev_b32 v130, 16, v77
    v_and_b32 v131, 0xffff0000, v77
    v_pk_add_f32 v[114:115], v[114:115], v[130:131]
    v_pk_fma_f32 v[122:123], v[130:131], v[130:131], v[122:123]
    v_lshlrev_b32 v128, 16, v78
    v_and_b32 v129, 0xffff0000, v78
    v_pk_add_f32 v[116:117], v[116:117], v[128:129]
    v_pk_fma_f32 v[124:125], v[128:129], v[128:129], v[124:125]
    v_lshlrev_b32 v130, 16, v79
    v_and_b32 v131, 0xffff0000, v79
    v_pk_add_f32 v[118:119], v[118:119], v[130:131]
    v_pk_fma_f32 v[126:127], v[130:131], v[130:131], v[126:127]
L_s15v8:
    s_waitcnt vmcnt(7)
    v_cmp_eq_u32 vcc, s59, v81
    v_cmp_eq_u32 s[30:31], s59, v83
    s_or_b64 vcc, vcc, s[30:31]
    s_cmp_eq_u64 vcc, 0
    s_cbranch_scc0 L_s15r8
L_s15k8:
    v_lshlrev_b32 v128, 16, v80
    v_and_b32 v129, 0xffff0000, v80
    v_pk_add_f32 v[112:113], v[112:113], v[128:129]
    v_pk_fma_f32 v[120:121], v[128:129], v[128:129], v[120:121]
    v_lshlrev_b32 v130, 16, v81
    v_and_b32 v131, 0xffff0000, v81
    v_pk_add_f32 v[114:115], v[114:115], v[130:131]
    v_pk_fma_f32 v[122:123], v[130:131], v[130:131], v[122:123]
    v_lshlrev_b32 v128, 16, v82
    v_and_b32 v129, 0xffff0000, v82
    v_pk_add_f32 v[116:117], v[116:117], v[128:129]
    v_pk_fma_f32 v[124:125], v[128:129], v[128:129], v[124:125]
    v_lshlrev_b32 v130, 16, v83
    v_and_b32 v131, 0xffff0000, v83
    v_pk_add_f32 v[118:119], v[118:119], v[130:131]
    v_pk_fma_f32 v[126:127], v[130:131], v[130:131], v[126:127]
L_s15v9:
    s_waitcnt vmcnt(6)
    v_cmp_eq_u32 vcc, s59, v85
    v_cmp_eq_u32 s[30:31], s59, v87
    s_or_b64 vcc, vcc, s[30:31]
    s_cmp_eq_u64 vcc, 0
    s_cbranch_scc0 L_s15r9
L_s15k9:
    v_lshlrev_b32 v128, 16, v84
    v_and_b32 v129, 0xffff0000, v84
    v_pk_add_f32 v[112:113], v[112:113], v[128:129]
    v_pk_fma_f32 v[120:121], v[128:129], v[128:129], v[120:121]
    v_lshlrev_b32 v130, 16, v85
    v_and_b32 v131, 0xffff0000, v85
    v_pk_add_f32 v[114:115], v[114:115], v[130:131]
    v_pk_fma_f32 v[122:123], v[130:131], v[130:131], v[122:123]
    v_lshlrev_b32 v128, 16, v86
    v_and_b32 v129, 0xffff0000, v86
    v_pk_add_f32 v[116:117], v[116:117], v[128:129]
    v_pk_fma_f32 v[124:125], v[128:129], v[128:129], v[124:125]
    v_lshlrev_b32 v130, 16, v87
    v_and_b32 v131, 0xffff0000, v87
    v_pk_add_f32 v[118:119], v[118:119], v[130:131]
    v_pk_fma_f32 v[126:127], v[130:131], v[130:131], v[126:127]
L_s15v10:
    s_waitcnt vmcnt(5)
    v_cmp_eq_u32 vcc, s59, v89
    v_cmp_eq_u32 s[30:31], s59, v91
    s_or_b64 vcc, vcc, s[30:31]
    s_cmp_eq_u64 vcc, 0
    s_cbranch_scc0 L_s15r10
L_s15k10:
    v_lshlrev_b32 v128, 16, v88
    v_and_b32 v129, 0xffff0000, v88
    v_pk_add_f32 v[112:113], v[112:113], v[128:129]
    v_pk_fma_f32 v[120:121], v[128:129], v[128:129], v[120:121]
    v_lshlrev_b32 v130, 16, v89
    v_and_b32 v131, 0xffff0000, v89
    v_pk_add_f32 v[114:115], v[114:115], v[130:131]
    v_pk_fma_f32 v[122:123], v[130:131], v[130:131], v[122:123]
    v_lshlrev_b32 v128, 16, v90
    v_and_b32 v129, 0xffff0000, v90
    v_pk_add_f32 v[116:117], v[116:117], v[128:129]
    v_pk_fma_f32 v[124:125], v[128:129], v[128:129], v[124:125]
    v_lshlrev_b32 v130, 16, v91
    v_and_b32 v131, 0xffff0000, v91
    v_pk_add_f32 v[118:119], v[118:119], v[130:131]
    v_pk_fma_f32 v[126:127], v[130:131], v[130:131], v[126:127]
L_s15v11:
    s_waitcnt vmcnt(4)
    v_cmp_eq_u32 vcc, s59, v93
    v_cmp_eq_u32 s[30:31], s59, v95
    s_or_b64 vcc, vcc, s[30:31]
    s_cmp_eq_u64 vcc, 0
    s_cbranch_scc0 L_s15r11
L_s15k11:
    v_lshlrev_b32 v128, 16, v92
    v_and_b32 v129, 0xffff0000, v92
    v_pk_add_f32 v[112:113], v[112:113], v[128:129]
    v_pk_fma_f32 v[120:121], v[128:129], v[128:129], v[120:121]
    v_lshlrev_b32 v130, 16, v93
    v_and_b32 v131, 0xffff0000, v93
    v_pk_add_f32 v[114:115], v[114:115], v[130:131]
    v_pk_fma_f32 v[122:123], v[130:131], v[130:131], v[122:123]
    v_lshlrev_b32 v128, 16, v94
    v_and_b32 v129, 0xffff0000, v94
    v_pk_add_f32 v[116:117], v[116:117], v[128:129]
    v_pk_fma_f32 v[124:125], v[128:129], v[128:129], v[124:125]
    v_lshlrev_b32 v130, 16, v95
    v_and_b32 v131, 0xffff0000, v95
    v_pk_add_f32 v[118:119], v[118:119], v[130:131]
    v_pk_fma_f32 v[126:127], v[130:131], v[130:131], v[126:127]
L_s15v12:
    s_waitcnt vmcnt(3)
    v_cmp_eq_u32 vcc, s59, v97
    v_cmp_eq_u32 s[30:31], s59, v99
    s_or_b64 vcc, vcc, s[30:31]
    s_cmp_eq_u64 vcc, 0
    s_cbranch_scc0 L_s15r12
L_s15k12:
    v_lshlrev_b32 v128, 16, v96
    v_and_b32 v129, 0xffff0000, v96
    v_pk_add_f32 v[112:113], v[112:113], v[128:129]
    v_pk_fma_f32 v[120:121], v[128:129], v[128:129], v[120:121]
    v_lshlrev_b32 v130, 16, v97
    v_and_b32 v131, 0xffff0000, v97
    v_pk_add_f32 v[114:115], v[114:115], v[130:131]
    v_pk_fma_f32 v[122:123], v[130:131], v[130:131], v[122:123]
    v_lshlrev_b32 v128, 16, v98
    v_and_b32 v129, 0xffff0000, v98
    v_pk_add_f32 v[116:117], v[116:117], v[128:129]
    v_pk_fma_f32 v[124:125], v[128:129], v[128:129], v[124:125]
    v_lshlrev_b32 v130, 16, v99
    v_and_b32 v131, 0xffff0000, v99
    v_pk_add_f32 v[118:119], v[118:119], v[130:131]
    v_pk_fma_f32 v[126:127], v[130:131], v[130:131], v[126:127]
L_s15v13:
    s_waitcnt vmcnt(2)
    v_cmp_eq_u32 vcc, s59, v101
    v_cmp_eq_u32 s[30:31], s59, v103
    s_or_b64 vcc, vcc, s[30:31]
    s_cmp_eq_u64 vcc, 0
    s_cbranch_scc0 L_s15r13
L_s15k13:
    v_lshlrev_b32 v128, 16, v100
    v_and_b32 v129, 0xffff0000, v100
    v_pk_add_f32 v[112:113], v[112:113], v[128:129]
    v_pk_fma_f32 v[120:121], v[128:129], v[128:129], v[120:121]
    v_lshlrev_b32 v130, 16, v101
    v_and_b32 v131, 0xffff0000, v101
    v_pk_add_f32 v[114:115], v[114:115], v[130:131]
    v_pk_fma_f32 v[122:123], v[130:131], v[130:131], v[122:123]
    v_lshlrev_b32 v128, 16, v102
    v_and_b32 v129, 0xffff0000, v102
    v_pk_add_f32 v[116:117], v[116:117], v[128:129]
    v_pk_fma_f32 v[124:125], v[128:129], v[128:129], v[124:125]
    v_lshlrev_b32 v130, 16, v103
    v_and_b32 v131, 0xffff0000, v103
    v_pk_add_f32 v[118:119], v[118:119], v[130:131]
    v_pk_fma_f32 v[126:127], v[130:131], v[130:131], v[126:127]
L_s15v14:
    s_waitcnt vmcnt(1)
    v_cmp_eq_u32 vcc, s59, v105
    v_cmp_eq_u32 s[30:31], s59, v107
    s_or_b64 vcc, vcc, s[30:31]
    s_cmp_eq_u64 vcc, 0
    s_cbranch_scc0 L_s15r14
L_s15k14:
    v_lshlrev_b32 v128, 16, v104
    v_and_b32 v129, 0xffff0000, v104
    v_pk_add_f32 v[112:113], v[112:113], v[128:129]
    v_pk_fma_f32 v[120:121], v[128:129], v[128:129], v[120:121]
    v_lshlrev_b32 v130, 16, v105
    v_and_b32 v131, 0xffff0000, v105
    v_pk_add_f32 v[114:115], v[114:115], v[130:131]
    v_pk_fma_f32 v[122:123], v[130:131], v[130:131], v[122:123]
    v_lshlrev_b32 v128, 16, v106
    v_and_b32 v129, 0xffff0000, v106
    v_pk_add_f32 v[116:117], v[116:117], v[128:129]
    v_pk_fma_f32 v[124:125], v[128:129], v[128:129], v[124:125]
    v_lshlrev_b32 v130, 16, v107
    v_and_b32 v131, 0xffff0000, v107
    v_pk_add_f32 v[118:119], v[118:119], v[130:131]
    v_pk_fma_f32 v[126:127], v[130:131], v[130:131], v[126:127]
L_s15v15:
    s_waitcnt vmcnt(0)
    v_cmp_eq_u32 vcc, s59, v109
    v_cmp_eq_u32 s[30:31], s59, v111
    s_or_b64 vcc, vcc, s[30:31]
    s_cmp_eq_u64 vcc, 0
    s_cbranch_scc0 L_s15r15
L_s15k15:
    v_lshlrev_b32 v128, 16, v108
    v_and_b32 v129, 0xffff0000, v108
    v_pk_add_f32 v[112:113], v[112:113], v[128:129]
    v_pk_fma_f32 v[120:121], v[128:129], v[128:129], v[120:121]
    v_lshlrev_b32 v130, 16, v109
    v_and_b32 v131, 0xffff0000, v109
    v_pk_add_f32 v[114:115], v[114:115], v[130:131]
    v_pk_fma_f32 v[122:123], v[130:131], v[130:131], v[122:123]
    v_lshlrev_b32 v128, 16, v110
    v_and_b32 v129, 0xffff0000, v110
    v_pk_add_f32 v[116:117], v[116:117], v[128:129]
    v_pk_fma_f32 v[124:125], v[128:129], v[128:129], v[124:125]
    v_lshlrev_b32 v130, 16, v111
    v_and_b32 v131, 0xffff0000, v111
    v_pk_add_f32 v[118:119], v[118:119], v[130:131]
    v_pk_fma_f32 v[126:127], v[130:131], v[130:131], v[126:127]
    v_permlane32_swap_b32 v112, v116
    v_permlane32_swap_b32 v113, v117
    v_permlane32_swap_b32 v114, v118
    v_permlane32_swap_b32 v115, v119
    v_add_f32 v112, v112, v116
    v_add_f32 v113, v113, v117
    v_add_f32 v114, v114, v118
    v_add_f32 v115, v115, v119
    s_nop 0
    v_permlane16_swap_b32 v112, v114
    v_permlane16_swap_b32 v113, v115
    v_add_f32 v112, v112, v114
    v_add_f32 v113, v113, v115
    v_permlane32_swap_b32 v120, v124
    v_permlane32_swap_b32 v121, v125
    v_permlane32_swap_b32 v122, v126
    v_permlane32_swap_b32 v123, v127
    v_add_f32 v120, v120, v124
    v_add_f32 v121, v121, v125
    v_add_f32 v122, v122, v126
    v_add_f32 v123, v123, v127
    s_nop 0
    v_permlane16_swap_b32 v120, v122
    v_permlane16_swap_b32 v121, v123
    v_add_f32 v120, v120, v122
    v_add_f32 v121, v121, v123
    v_mov_b32 v114, v120
    v_mov_b32 v115, v121
    s_sub_u32 s29, s40, 4
    s_lshl_b32 s29, s29, 10
    v_lshl_add_u32 v14, v7, 4, s29
    ds_write_b128 v14, v[112:115]
    s_waitcnt lgkmcnt(0)
    s_barrier
    s_cmp_eq_u32 s40, 4
    s_cbranch_scc0 L_s15_pub
    v_lshlrev_b32 v14, 4, v7
    ds_read_b128 v[48:51], v14 offset:0
    ds_read_b128 v[52:55], v14 offset:1024
    ds_read_b128 v[56:59], v14 offset:2048
    ds_read_b128 v[60:63], v14 offset:3072
    ds_read_b128 v[64:67], v14 offset:4096
    ds_read_b128 v[68:71], v14 offset:5120
    ds_read_b128 v[72:75], v14 offset:6144
    ds_read_b128 v[76:79], v14 offset:7168
    s_waitcnt lgkmcnt(6)
    v_pk_add_f32 v[48:49], v[48:49], v[52:53]
    v_pk_add_f32 v[50:51], v[50:51], v[54:55]
    s_waitcnt lgkmcnt(5)
    v_pk_add_f32 v[48:49], v[48:49], v[56:57]
    v_pk_add_f32 v[50:51], v[50:51], v[58:59]
    s_waitcnt lgkmcnt(4)
    v_pk_add_f32 v[48:49], v[48:49], v[60:61]
    v_pk_add_f32 v[50:51], v[50:51], v[62:63]
    s_waitcnt lgkmcnt(3)
    v_pk_add_f32 v[48:49], v[48:49], v[64:65]
    v_pk_add_f32 v[50:51], v[50:51], v[66:67]
    s_waitcnt lgkmcnt(2)
    v_pk_add_f32 v[48:49], v[48:49], v[68:69]
    v_pk_add_f32 v[50:51], v[50:51], v[70:71]
    s_waitcnt lgkmcnt(1)
    v_pk_add_f32 v[48:49], v[48:49], v[72:73]
    v_pk_add_f32 v[50:51], v[50:51], v[74:75]
    s_waitcnt lgkmcnt(0)
    v_pk_add_f32 v[48:49], v[48:49], v[76:77]
    v_pk_add_f32 v[50:51], v[50:51], v[78:79]
    v_mul_f32 v48, 0x3b000000, v48
    v_mul_f32 v50, 0x3b000000, v50
    v_fma_f32 v50, -v48, v48, v50
    v_max_f32 v50, 0, v50
    v_cvt_pk_bf16_f32 v50, v50, v50
    v_and_b32 v50, 0xffff0000, v50
    v_add_f32 v50, 0x3727c5ac, v50
    v_cvt_pk_bf16_f32 v50, v50, v50
    v_and_b32 v50, 0xffff0000, v50
    v_sqrt_f32 v50, v50
    s_nop 0
    v_cvt_pk_bf16_f32 v128, -v48, v50
    v_mov_b32 v129, s59
    v_mul_f32 v49, 0x3b000000, v49
    v_mul_f32 v51, 0x3b000000, v51
    v_fma_f32 v51, -v49, v49, v51
    v_max_f32 v51, 0, v51
    v_cvt_pk_bf16_f32 v51, v51, v51
    v_and_b32 v51, 0xffff0000, v51
    v_add_f32 v51, 0x3727c5ac, v51
    v_cvt_pk_bf16_f32 v51, v51, v51
    v_and_b32 v51, 0xffff0000, v51
    v_sqrt_f32 v51, v51
    s_nop 0
    v_cvt_pk_bf16_f32 v130, -v49, v51
    v_mov_b32 v131, s59
    v_and_b32 v14, 15, v7
    v_lshlrev_b32 v14, 6, v14
    v_lshrrev_b32 v15, 4, v7
    v_lshl_add_u32 v14, v15, 4, v14
    s_lshl_b32 s29, s26, 10
    buffer_store_dwordx4 v[128:131], v14, s[68:71], s29 offen sc1
L_s15_pub:
    s_cmp_lt_u32 s40, 8
    s_cbranch_scc1 L_s15w_0
    s_branch L_s15w_1
L_s15r0:
    s_add_u32 s58, s58, 1
    s_cmp_lt_u32 s58, 8000
    s_cbranch_scc0 L_s15k0
    s_add_u32 s73, s48, 0
    buffer_load_dwordx4 v[48:51], v46, s[12:15], s73 offen sc1
    s_add_u32 s73, s48, 32768
    buffer_load_dwordx4 v[52:55], v46, s[12:15], s73 offen sc1
    s_add_u32 s73, s48, 65536
    buffer_load_dwordx4 v[56:59], v46, s[12:15], s73 offen sc1
    s_add_u32 s73, s48, 98304
    buffer_load_dwordx4 v[60:63], v46, s[12:15], s73 offen sc1
    s_add_u32 s73, s48, 131072
    buffer_load_dwordx4 v[64:67], v46, s[12:15], s73 offen sc1
    s_add_u32 s73, s48, 163840
    buffer_load_dwordx4 v[68:71], v46, s[12:15], s73 offen sc1
    s_add_u32 s73, s48, 196608
    buffer_load_dwordx4 v[72:75], v46, s[12:15], s73 offen sc1
    s_add_u32 s73, s48, 229376
    buffer_load_dwordx4 v[76:79], v46, s[12:15], s73 offen sc1
    s_add_u32 s73, s48, 262144
    buffer_load_dwordx4 v[80:83], v46, s[12:15], s73 offen sc1
    s_add_u32 s73, s48, 294912
    buffer_load_dwordx4 v[84:87], v46, s[12:15], s73 offen sc1
    s_add_u32 s73, s48, 327680
    buffer_load_dwordx4 v[88:91], v46, s[12:15], s73 offen sc1
    s_add_u32 s73, s48, 360448
    buffer_load_dwordx4 v[92:95], v46, s[12:15], s73 offen sc1
    s_add_u32 s73, s48, 393216
    buffer_load_dwordx4 v[96:99], v46, s[12:15], s73 offen sc1
    s_add_u32 s73, s48, 425984
    buffer_load_dwordx4 v[100:103], v46, s[12:15], s73 offen sc1
    s_add_u32 s73, s48, 458752
    buffer_load_dwordx4 v[104:107], v46, s[12:15], s73 offen sc1
    s_add_u32 s73, s48, 491520
    buffer_load_dwordx4 v[108:111], v46, s[12:15], s73 offen sc1
    s_branch L_s15v0
L_s15r1:
    s_add_u32 s58, s58, 1
    s_cmp_lt_u32 s58, 8000
    s_cbranch_scc0 L_s15k1
    s_add_u32 s73, s48, 32768
    buffer_load_dwordx4 v[52:55], v46, s[12:15], s73 offen sc1
    s_add_u32 s73, s48, 65536
    buffer_load_dwordx4 v[56:59], v46, s[12:15], s73 offen sc1
    s_add_u32 s73, s48, 98304
    buffer_load_dwordx4 v[60:63], v46, s[12:15], s73 offen sc1
    s_add_u32 s73, s48, 131072
    buffer_load_dwordx4 v[64:67], v46, s[12:15], s73 offen sc1
    s_add_u32 s73, s48, 163840
    buffer_load_dwordx4 v[68:71], v46, s[12:15], s73 offen sc1
    s_add_u32 s73, s48, 196608
    buffer_load_dwordx4 v[72:75], v46, s[12:15], s73 offen sc1
    s_add_u32 s73, s48, 229376
    buffer_load_dwordx4 v[76:79], v46, s[12:15], s73 offen sc1
    s_add_u32 s73, s48, 262144
    buffer_load_dwordx4 v[80:83], v46, s[12:15], s73 offen sc1
    s_add_u32 s73, s48, 294912
    buffer_load_dwordx4 v[84:87], v46, s[12:15], s73 offen sc1
    s_add_u32 s73, s48, 327680
    buffer_load_dwordx4 v[88:91], v46, s[12:15], s73 offen sc1
    s_add_u32 s73, s48, 360448
    buffer_load_dwordx4 v[92:95], v46, s[12:15], s73 offen sc1
    s_add_u32 s73, s48, 393216
    buffer_load_dwordx4 v[96:99], v46, s[12:15], s73 offen sc1
    s_add_u32 s73, s48, 425984
    buffer_load_dwordx4 v[100:103], v46, s[12:15], s73 offen sc1
    s_add_u32 s73, s48, 458752
    buffer_load_dwordx4 v[104:107], v46, s[12:15], s73 offen sc1
    s_add_u32 s73, s48, 491520
    buffer_load_dwordx4 v[108:111], v46, s[12:15], s73 offen sc1
    s_branch L_s15v1
L_s15r2:
    s_add_u32 s58, s58, 1
    s_cmp_lt_u32 s58, 8000
    s_cbranch_scc0 L_s15k2
    s_add_u32 s73, s48, 65536
    buffer_load_dwordx4 v[56:59], v46, s[12:15], s73 offen sc1
    s_add_u32 s73, s48, 98304
    buffer_load_dwordx4 v[60:63], v46, s[12:15], s73 offen sc1
    s_add_u32 s73, s48, 131072
    buffer_load_dwordx4 v[64:67], v46, s[12:15], s73 offen sc1
    s_add_u32 s73, s48, 163840
    buffer_load_dwordx4 v[68:71], v46, s[12:15], s73 offen sc1
    s_add_u32 s73, s48, 196608
    buffer_load_dwordx4 v[72:75], v46, s[12:15], s73 offen sc1
    s_add_u32 s73, s48, 229376
    buffer_load_dwordx4 v[76:79], v46, s[12:15], s73 offen sc1
    s_add_u32 s73, s48, 262144
    buffer_load_dwordx4 v[80:83], v46, s[12:15], s73 offen sc1
    s_add_u32 s73, s48, 294912
    buffer_load_dwordx4 v[84:87], v46, s[12:15], s73 offen sc1
    s_add_u32 s73, s48, 327680
    buffer_load_dwordx4 v[88:91], v46, s[12:15], s73 offen sc1
    s_add_u32 s73, s48, 360448
    buffer_load_dwordx4 v[92:95], v46, s[12:15], s73 offen sc1
    s_add_u32 s73, s48, 393216
    buffer_load_dwordx4 v[96:99], v46, s[12:15], s73 offen sc1
    s_add_u32 s73, s48, 425984
    buffer_load_dwordx4 v[100:103], v46, s[12:15], s73 offen sc1
    s_add_u32 s73, s48, 458752
    buffer_load_dwordx4 v[104:107], v46, s[12:15], s73 offen sc1
    s_add_u32 s73, s48, 491520
    buffer_load_dwordx4 v[108:111], v46, s[12:15], s73 offen sc1
    s_branch L_s15v2
L_s15r3:
    s_add_u32 s58, s58, 1
    s_cmp_lt_u32 s58, 8000
    s_cbranch_scc0 L_s15k3
    s_add_u32 s73, s48, 98304
    buffer_load_dwordx4 v[60:63], v46, s[12:15], s73 offen sc1
    s_add_u32 s73, s48, 131072
    buffer_load_dwordx4 v[64:67], v46, s[12:15], s73 offen sc1
    s_add_u32 s73, s48, 163840
    buffer_load_dwordx4 v[68:71], v46, s[12:15], s73 offen sc1
    s_add_u32 s73, s48, 196608
    buffer_load_dwordx4 v[72:75], v46, s[12:15], s73 offen sc1
    s_add_u32 s73, s48, 229376
    buffer_load_dwordx4 v[76:79], v46, s[12:15], s73 offen sc1
    s_add_u32 s73, s48, 262144
    buffer_load_dwordx4 v[80:83], v46, s[12:15], s73 offen sc1
    s_add_u32 s73, s48, 294912
    buffer_load_dwordx4 v[84:87], v46, s[12:15], s73 offen sc1
    s_add_u32 s73, s48, 327680
    buffer_load_dwordx4 v[88:91], v46, s[12:15], s73 offen sc1
    s_add_u32 s73, s48, 360448
    buffer_load_dwordx4 v[92:95], v46, s[12:15], s73 offen sc1
    s_add_u32 s73, s48, 393216
    buffer_load_dwordx4 v[96:99], v46, s[12:15], s73 offen sc1
    s_add_u32 s73, s48, 425984
    buffer_load_dwordx4 v[100:103], v46, s[12:15], s73 offen sc1
    s_add_u32 s73, s48, 458752
    buffer_load_dwordx4 v[104:107], v46, s[12:15], s73 offen sc1
    s_add_u32 s73, s48, 491520
    buffer_load_dwordx4 v[108:111], v46, s[12:15], s73 offen sc1
    s_branch L_s15v3
L_s15r4:
    s_add_u32 s58, s58, 1
    s_cmp_lt_u32 s58, 8000
    s_cbranch_scc0 L_s15k4
    s_add_u32 s73, s48, 131072
    buffer_load_dwordx4 v[64:67], v46, s[12:15], s73 offen sc1
    s_add_u32 s73, s48, 163840
    buffer_load_dwordx4 v[68:71], v46, s[12:15], s73 offen sc1
    s_add_u32 s73, s48, 196608
    buffer_load_dwordx4 v[72:75], v46, s[12:15], s73 offen sc1
    s_add_u32 s73, s48, 229376
    buffer_load_dwordx4 v[76:79], v46, s[12:15], s73 offen sc1
    s_add_u32 s73, s48, 262144
    buffer_load_dwordx4 v[80:83], v46, s[12:15], s73 offen sc1
    s_add_u32 s73, s48, 294912
    buffer_load_dwordx4 v[84:87], v46, s[12:15], s73 offen sc1
    s_add_u32 s73, s48, 327680
    buffer_load_dwordx4 v[88:91], v46, s[12:15], s73 offen sc1
    s_add_u32 s73, s48, 360448
    buffer_load_dwordx4 v[92:95], v46, s[12:15], s73 offen sc1
    s_add_u32 s73, s48, 393216
    buffer_load_dwordx4 v[96:99], v46, s[12:15], s73 offen sc1
    s_add_u32 s73, s48, 425984
    buffer_load_dwordx4 v[100:103], v46, s[12:15], s73 offen sc1
    s_add_u32 s73, s48, 458752
    buffer_load_dwordx4 v[104:107], v46, s[12:15], s73 offen sc1
    s_add_u32 s73, s48, 491520
    buffer_load_dwordx4 v[108:111], v46, s[12:15], s73 offen sc1
    s_branch L_s15v4
L_s15r5:
    s_add_u32 s58, s58, 1
    s_cmp_lt_u32 s58, 8000
    s_cbranch_scc0 L_s15k5
    s_add_u32 s73, s48, 163840
    buffer_load_dwordx4 v[68:71], v46, s[12:15], s73 offen sc1
    s_add_u32 s73, s48, 196608
    buffer_load_dwordx4 v[72:75], v46, s[12:15], s73 offen sc1
    s_add_u32 s73, s48, 229376
    buffer_load_dwordx4 v[76:79], v46, s[12:15], s73 offen sc1
    s_add_u32 s73, s48, 262144
    buffer_load_dwordx4 v[80:83], v46, s[12:15], s73 offen sc1
    s_add_u32 s73, s48, 294912
    buffer_load_dwordx4 v[84:87], v46, s[12:15], s73 offen sc1
    s_add_u32 s73, s48, 327680
    buffer_load_dwordx4 v[88:91], v46, s[12:15], s73 offen sc1
    s_add_u32 s73, s48, 360448
    buffer_load_dwordx4 v[92:95], v46, s[12:15], s73 offen sc1
    s_add_u32 s73, s48, 393216
    buffer_load_dwordx4 v[96:99], v46, s[12:15], s73 offen sc1
    s_add_u32 s73, s48, 425984
    buffer_load_dwordx4 v[100:103], v46, s[12:15], s73 offen sc1
    s_add_u32 s73, s48, 458752
    buffer_load_dwordx4 v[104:107], v46, s[12:15], s73 offen sc1
    s_add_u32 s73, s48, 491520
    buffer_load_dwordx4 v[108:111], v46, s[12:15], s73 offen sc1
    s_branch L_s15v5
L_s15r6:
    s_add_u32 s58, s58, 1
    s_cmp_lt_u32 s58, 8000
    s_cbranch_scc0 L_s15k6
    s_add_u32 s73, s48, 196608
    buffer_load_dwordx4 v[72:75], v46, s[12:15], s73 offen sc1
    s_add_u32 s73, s48, 229376
    buffer_load_dwordx4 v[76:79], v46, s[12:15], s73 offen sc1
    s_add_u32 s73, s48, 262144
    buffer_load_dwordx4 v[80:83], v46, s[12:15], s73 offen sc1
    s_add_u32 s73, s48, 294912
    buffer_load_dwordx4 v[84:87], v46, s[12:15], s73 offen sc1
    s_add_u32 s73, s48, 327680
    buffer_load_dwordx4 v[88:91], v46, s[12:15], s73 offen sc1
    s_add_u32 s73, s48, 360448
    buffer_load_dwordx4 v[92:95], v46, s[12:15], s73 offen sc1
    s_add_u32 s73, s48, 393216
    buffer_load_dwordx4 v[96:99], v46, s[12:15], s73 offen sc1
    s_add_u32 s73, s48, 425984
    buffer_load_dwordx4 v[100:103], v46, s[12:15], s73 offen sc1
    s_add_u32 s73, s48, 458752
    buffer_load_dwordx4 v[104:107], v46, s[12:15], s73 offen sc1
    s_add_u32 s73, s48, 491520
    buffer_load_dwordx4 v[108:111], v46, s[12:15], s73 offen sc1
    s_branch L_s15v6
L_s15r7:
    s_add_u32 s58, s58, 1
    s_cmp_lt_u32 s58, 8000
    s_cbranch_scc0 L_s15k7
    s_add_u32 s73, s48, 229376
    buffer_load_dwordx4 v[76:79], v46, s[12:15], s73 offen sc1
    s_add_u32 s73, s48, 262144
    buffer_load_dwordx4 v[80:83], v46, s[12:15], s73 offen sc1
    s_add_u32 s73, s48, 294912
    buffer_load_dwordx4 v[84:87], v46, s[12:15], s73 offen sc1
    s_add_u32 s73, s48, 327680
    buffer_load_dwordx4 v[88:91], v46, s[12:15], s73 offen sc1
    s_add_u32 s73, s48, 360448
    buffer_load_dwordx4 v[92:95], v46, s[12:15], s73 offen sc1
    s_add_u32 s73, s48, 393216
    buffer_load_dwordx4 v[96:99], v46, s[12:15], s73 offen sc1
    s_add_u32 s73, s48, 425984
    buffer_load_dwordx4 v[100:103], v46, s[12:15], s73 offen sc1
    s_add_u32 s73, s48, 458752
    buffer_load_dwordx4 v[104:107], v46, s[12:15], s73 offen sc1
    s_add_u32 s73, s48, 491520
    buffer_load_dwordx4 v[108:111], v46, s[12:15], s73 offen sc1
    s_branch L_s15v7
L_s15r8:
    s_add_u32 s58, s58, 1
    s_cmp_lt_u32 s58, 8000
    s_cbranch_scc0 L_s15k8
    s_add_u32 s73, s48, 262144
    buffer_load_dwordx4 v[80:83], v46, s[12:15], s73 offen sc1
    s_add_u32 s73, s48, 294912
    buffer_load_dwordx4 v[84:87], v46, s[12:15], s73 offen sc1
    s_add_u32 s73, s48, 327680
    buffer_load_dwordx4 v[88:91], v46, s[12:15], s73 offen sc1
    s_add_u32 s73, s48, 360448
    buffer_load_dwordx4 v[92:95], v46, s[12:15], s73 offen sc1
    s_add_u32 s73, s48, 393216
    buffer_load_dwordx4 v[96:99], v46, s[12:15], s73 offen sc1
    s_add_u32 s73, s48, 425984
    buffer_load_dwordx4 v[100:103], v46, s[12:15], s73 offen sc1
    s_add_u32 s73, s48, 458752
    buffer_load_dwordx4 v[104:107], v46, s[12:15], s73 offen sc1
    s_add_u32 s73, s48, 491520
    buffer_load_dwordx4 v[108:111], v46, s[12:15], s73 offen sc1
    s_branch L_s15v8
L_s15r9:
    s_add_u32 s58, s58, 1
    s_cmp_lt_u32 s58, 8000
    s_cbranch_scc0 L_s15k9
    s_add_u32 s73, s48, 294912
    buffer_load_dwordx4 v[84:87], v46, s[12:15], s73 offen sc1
    s_add_u32 s73, s48, 327680
    buffer_load_dwordx4 v[88:91], v46, s[12:15], s73 offen sc1
    s_add_u32 s73, s48, 360448
    buffer_load_dwordx4 v[92:95], v46, s[12:15], s73 offen sc1
    s_add_u32 s73, s48, 393216
    buffer_load_dwordx4 v[96:99], v46, s[12:15], s73 offen sc1
    s_add_u32 s73, s48, 425984
    buffer_load_dwordx4 v[100:103], v46, s[12:15], s73 offen sc1
    s_add_u32 s73, s48, 458752
    buffer_load_dwordx4 v[104:107], v46, s[12:15], s73 offen sc1
    s_add_u32 s73, s48, 491520
    buffer_load_dwordx4 v[108:111], v46, s[12:15], s73 offen sc1
    s_branch L_s15v9
L_s15r10:
    s_add_u32 s58, s58, 1
    s_cmp_lt_u32 s58, 8000
    s_cbranch_scc0 L_s15k10
    s_add_u32 s73, s48, 327680
    buffer_load_dwordx4 v[88:91], v46, s[12:15], s73 offen sc1
    s_add_u32 s73, s48, 360448
    buffer_load_dwordx4 v[92:95], v46, s[12:15], s73 offen sc1
    s_add_u32 s73, s48, 393216
    buffer_load_dwordx4 v[96:99], v46, s[12:15], s73 offen sc1
    s_add_u32 s73, s48, 425984
    buffer_load_dwordx4 v[100:103], v46, s[12:15], s73 offen sc1
    s_add_u32 s73, s48, 458752
    buffer_load_dwordx4 v[104:107], v46, s[12:15], s73 offen sc1
    s_add_u32 s73, s48, 491520
    buffer_load_dwordx4 v[108:111], v46, s[12:15], s73 offen sc1
    s_branch L_s15v10
L_s15r11:
    s_add_u32 s58, s58, 1
    s_cmp_lt_u32 s58, 8000
    s_cbranch_scc0 L_s15k11
    s_add_u32 s73, s48, 360448
    buffer_load_dwordx4 v[92:95], v46, s[12:15], s73 offen sc1
    s_add_u32 s73, s48, 393216
    buffer_load_dwordx4 v[96:99], v46, s[12:15], s73 offen sc1
    s_add_u32 s73, s48, 425984
    buffer_load_dwordx4 v[100:103], v46, s[12:15], s73 offen sc1
    s_add_u32 s73, s48, 458752
    buffer_load_dwordx4 v[104:107], v46, s[12:15], s73 offen sc1
    s_add_u32 s73, s48, 491520
    buffer_load_dwordx4 v[108:111], v46, s[12:15], s73 offen sc1
    s_branch L_s15v11
L_s15r12:
    s_add_u32 s58, s58, 1
    s_cmp_lt_u32 s58, 8000
    s_cbranch_scc0 L_s15k12
    s_add_u32 s73, s48, 393216
    buffer_load_dwordx4 v[96:99], v46, s[12:15], s73 offen sc1
    s_add_u32 s73, s48, 425984
    buffer_load_dwordx4 v[100:103], v46, s[12:15], s73 offen sc1
    s_add_u32 s73, s48, 458752
    buffer_load_dwordx4 v[104:107], v46, s[12:15], s73 offen sc1
    s_add_u32 s73, s48, 491520
    buffer_load_dwordx4 v[108:111], v46, s[12:15], s73 offen sc1
    s_branch L_s15v12
L_s15r13:
    s_add_u32 s58, s58, 1
    s_cmp_lt_u32 s58, 8000
    s_cbranch_scc0 L_s15k13
    s_add_u32 s73, s48, 425984
    buffer_load_dwordx4 v[100:103], v46, s[12:15], s73 offen sc1
    s_add_u32 s73, s48, 458752
    buffer_load_dwordx4 v[104:107], v46, s[12:15], s73 offen sc1
    s_add_u32 s73, s48, 491520
    buffer_load_dwordx4 v[108:111], v46, s[12:15], s73 offen sc1
    s_branch L_s15v13
L_s15r14:
    s_add_u32 s58, s58, 1
    s_cmp_lt_u32 s58, 8000
    s_cbranch_scc0 L_s15k14
    s_add_u32 s73, s48, 458752
    buffer_load_dwordx4 v[104:107], v46, s[12:15], s73 offen sc1
    s_add_u32 s73, s48, 491520
    buffer_load_dwordx4 v[108:111], v46, s[12:15], s73 offen sc1
    s_branch L_s15v14
L_s15r15:
    s_add_u32 s58, s58, 1
    s_cmp_lt_u32 s58, 8000
    s_cbranch_scc0 L_s15k15
    s_add_u32 s73, s48, 491520
    buffer_load_dwordx4 v[108:111], v46, s[12:15], s73 offen sc1
    s_branch L_s15v15
L_k3_comp:
    s_lshr_b32 s42, s40, 1
    s_and_b32 s41, s40, 1
    s_lshl_b32 s41, s41, 1
    s_add_u32 s45, s41, 1
    s_mul_i32 s30, s27, 6
    s_mul_i32 s31, s42, 3
    s_add_u32 s30, s30, s31
    s_lshl_b32 s31, s30, 10
    v_lshlrev_b32 v1, 4, v7
    s_add_u32 s16, s4, 0x8f0000
    s_addc_u32 s17, s5, 0
    s_and_b32 s17, s17, 0xffff
    s_mov_b32 s18, 0x15800
    s_mov_b32 s19, 0x00020000
    s_add_u32 s20, s4, 0xa80000
    s_addc_u32 s21, s5, 0
    s_and_b32 s21, s21, 0xffff
    s_mov_b32 s22, 0x560000
    s_mov_b32 s23, 0x00020000
    s_add_u32 s64, s4, 0x1040000
    s_addc_u32 s65, s5, 0
    s_and_b32 s65, s65, 0xffff
    s_mov_b32 s66, 0x24800
    s_mov_b32 s67, 0x00020000
    v_bfe_u32 v8, v7, 2, 2
    v_add_u32 v9, s41, v8
    v_and_b32 v9, 3, v9
    v_lshlrev_b32 v9, 6, v9
    v_lshl_add_u32 v9, v8, 8, v9
    v_bfe_u32 v8, v7, 4, 1
    v_lshl_add_u32 v9, v8, 5, v9
    v_and_b32 v8, 3, v7
    v_lshl_add_u32 v9, v8, 3, v9
    v_lshrrev_b32 v8, 5, v7
    v_lshl_add_u32 v9, v8, 10, v9
    v_add_u32 v2, 12352, v9
    v_bfe_u32 v8, v7, 2, 2
    v_add_u32 v9, s45, v8
    v_and_b32 v9, 3, v9
    v_lshlrev_b32 v9, 6, v9
    v_lshl_add_u32 v9, v8, 8, v9
    v_bfe_u32 v8, v7, 4, 1
    v_lshl_add_u32 v9, v8, 5, v9
    v_and_b32 v8, 3, v7
    v_lshl_add_u32 v9, v8, 3, v9
    v_lshrrev_b32 v8, 5, v7
    v_lshl_add_u32 v9, v8, 10, v9
    v_add_u32 v3, 12352, v9
    v_lshrrev_b32 v8, 5, v7
    v_bfe_u32 v9, v7, 2, 2
    v_lshl_add_u32 v8, v8, 2, v9
    v_mul_u32_u24 v8, 192, v8
    v_bfe_u32 v9, v7, 4, 1
    v_mul_u32_u24 v9, 6176, v9
    v_add_u32 v8, v8, v9
    v_and_b32 v9, 3, v7
    v_lshl_add_u32 v164, v9, 3, v8
    v_and_b32 v8, 31, v7
    v_lshlrev_b32 v8, 3, v8
    v_lshrrev_b32 v9, 5, v7
    v_lshl_add_u32 v165, v9, 9, v8
    v_add_u32 v165, 125312, v165
    v_and_b32 v13, 31, v7
    v_lshlrev_b32 v13, 3, v13
    s_lshl_b32 s46, s41, 8
    s_add_u32 s46, s46, 140672
    v_add_u32 v13, s46, v13
    s_add_u32 s68, s4, 0x1020000
    s_addc_u32 s69, s5, 0
    s_and_b32 s69, s69, 0xffff
    s_mov_b32 s70, 0x4000
    s_mov_b32 s71, 0x00020000
    v_and_b32 v12, 31, v7
    v_lshlrev_b32 v12, 3, v12
    s_lshl_b32 s46, s26, 10
    s_lshl_b32 s47, s41, 8
    s_add_u32 s46, s46, s47
    v_mov_b32 v16, 0
    v_mov_b32 v17, 0
    v_mov_b32 v18, 0
    v_mov_b32 v19, 0
    v_mov_b32 v20, 0
    v_mov_b32 v21, 0
    v_mov_b32 v22, 0
    v_mov_b32 v23, 0
    v_mov_b32 v24, 0
    v_mov_b32 v25, 0
    v_mov_b32 v26, 0
    v_mov_b32 v27, 0
    v_mov_b32 v28, 0
    v_mov_b32 v29, 0
    v_mov_b32 v30, 0
    v_mov_b32 v31, 0
    v_mov_b32 v32, 0
    v_mov_b32 v33, 0
    v_mov_b32 v34, 0
    v_mov_b32 v35, 0
    v_mov_b32 v36, 0
    v_mov_b32 v37, 0
    v_mov_b32 v38, 0
    v_mov_b32 v39, 0
    v_mov_b32 v40, 0
    v_mov_b32 v41, 0
    v_mov_b32 v42, 0
    v_mov_b32 v43, 0
    v_mov_b32 v44, 0
    v_mov_b32 v45, 0
    v_mov_b32 v46, 0
    v_mov_b32 v47, 0
    v_mov_b32 v48, 0
    v_mov_b32 v49, 0
    v_mov_b32 v50, 0
    v_mov_b32 v51, 0
    v_mov_b32 v52, 0
    v_mov_b32 v53, 0
    v_mov_b32 v54, 0
    v_mov_b32 v55, 0
    v_mov_b32 v56, 0
    v_mov_b32 v57, 0
    v_mov_b32 v58, 0
    v_mov_b32 v59, 0
    v_mov_b32 v60, 0
    v_mov_b32 v61, 0
    v_mov_b32 v62, 0
    v_mov_b32 v63, 0
    v_mov_b32 v64, 0
    v_mov_b32 v65, 0
    v_mov_b32 v66, 0
    v_mov_b32 v67, 0
    v_mov_b32 v68, 0
    v_mov_b32 v69, 0
    v_mov_b32 v70, 0
    v_mov_b32 v71, 0
    v_mov_b32 v72, 0
    v_mov_b32 v73, 0
    v_mov_b32 v74, 0
    v_mov_b32 v75, 0
    v_mov_b32 v76, 0
    v_mov_b32 v77, 0
    v_mov_b32 v78, 0
    v_mov_b32 v79, 0
    v_mov_b32 v80, 0
    v_mov_b32 v81, 0
    v_mov_b32 v82, 0
    v_mov_b32 v83, 0
    v_mov_b32 v84, 0
    v_mov_b32 v85, 0
    v_mov_b32 v86, 0
    v_mov_b32 v87, 0
    v_mov_b32 v88, 0
    v_mov_b32 v89, 0
    v_mov_b32 v90, 0
    v_mov_b32 v91, 0
    v_mov_b32 v92, 0
    v_mov_b32 v93, 0
    v_mov_b32 v94, 0
    v_mov_b32 v95, 0
    v_mov_b32 v96, 0
    v_mov_b32 v97, 0
    v_mov_b32 v98, 0
    v_mov_b32 v99, 0
    v_mov_b32 v100, 0
    v_mov_b32 v101, 0
    v_mov_b32 v102, 0
    v_mov_b32 v103, 0
    v_mov_b32 v104, 0
    v_mov_b32 v105, 0
    v_mov_b32 v106, 0
    v_mov_b32 v107, 0
    v_mov_b32 v108, 0
    v_mov_b32 v109, 0
    v_mov_b32 v110, 0
    v_mov_b32 v111, 0
    s_mov_b32 s44, 82176
    s_mov_b32 s43, 0
    v_add_u32 v4, s44, v164
    v_add_u32 v5, s44, v2
    v_add_u32 v6, s44, v3
    s_lshl_b32 s35, s26, 1
    s_lshr_b32 s36, s41, 1
    s_add_u32 s35, s35, s36
    s_lshl_b32 s35, s35, 5
    s_lshl_b32 s36, s27, 1
    s_add_u32 s36, s36, s42
    s_add_u32 s35, s35, s36
    s_lshl_b32 s35, s35, 7
    s_waitcnt vmcnt(2)
    v_mov_b32 v10, 163336
    v_mov_b32 v11, 1
    s_mov_b64 exec, 1
    ds_add_u32 v10, v11
    s_mov_b64 exec, -1
    s_waitcnt vmcnt(0)
    v_mov_b32 v10, 163356
    v_mov_b32 v11, 1
    s_mov_b64 exec, 1
    ds_add_u32 v10, v11
    v_mov_b32 v10, 163332
    v_mov_b32 v11, 1
    s_mov_b64 exec, 1
    ds_add_rtn_u32 v11, v10, v11
    s_waitcnt lgkmcnt(0)
    v_readfirstlane_b32 s56, v11
    s_mov_b64 exec, -1
    s_cmp_eq_u32 s56, 8
    s_cbranch_scc0 L_tr_noc
    s_lshl_b32 s56, s74, 7
    s_add_u32 s56, s56, 393216
    v_lshlrev_b32 v10, 11, v7
    v_mov_b32 v11, 1
    s_mov_b64 exec, 0xff
    buffer_atomic_add v11, v10, s[48:51], s56 offen sc1
    s_mov_b64 exec, -1
L_tr_noc:
    s_cmp_eq_u32 s27, 15
    s_cbranch_scc0 L_k3_work
    v_mov_b32 v10, 163344
    v_mov_b32 v11, 1
    s_mov_b64 exec, 1
    ds_add_u32 v10, v11
    s_waitcnt lgkmcnt(0)
    s_mov_b64 exec, -1
    s_branch L_k3_done
L_k3_work:
    s_waitcnt lgkmcnt(0)
    s_barrier
    s_cmp_eq_u32 s42, 0
    s_cbranch_scc0 L_k3_p1
    ds_read_b64_tr_b16 v[112:113], v4 offset:0
    ds_read_b64_tr_b16 v[114:115], v4 offset:1536
    ds_read_b64_tr_b16 v[124:125], v5 offset:0
    ds_read_b64_tr_b16 v[126:127], v5 offset:2048
    ds_read_b64_tr_b16 v[128:129], v6 offset:0
    ds_read_b64_tr_b16 v[130:131], v6 offset:2048
    ds_read_b64_tr_b16 v[116:117], v4 offset:32
    ds_read_b64_tr_b16 v[118:119], v4 offset:1568
    ds_read_b64_tr_b16 v[120:121], v4 offset:64
    ds_read_b64_tr_b16 v[122:123], v4 offset:1600
L_k3_loop0:
    s_waitcnt lgkmcnt(6)
    v_mfma_f32_32x32x16_bf16 v[16:31], v[112:115], v[124:127], v[16:31]
    ds_read_b64_tr_b16 v[132:133], v4 offset:3072
    ds_read_b64_tr_b16 v[134:135], v4 offset:4608
    s_waitcnt lgkmcnt(6)
    v_mfma_f32_32x32x16_bf16 v[32:47], v[112:115], v[128:131], v[32:47]
    ds_read_b64_tr_b16 v[144:145], v5 offset:4096
    ds_read_b64_tr_b16 v[146:147], v5 offset:6144
    s_add_u32 s47, s44, 20544
    s_waitcnt lgkmcnt(6)
    v_mfma_f32_32x32x16_bf16 v[48:63], v[116:119], v[124:127], v[48:63]
    ds_read_b64_tr_b16 v[148:149], v6 offset:4096
    ds_read_b64_tr_b16 v[150:151], v6 offset:6144
    s_cmp_eq_u32 s47, 143808
    s_cselect_b32 s44, 0, s47
    v_mfma_f32_32x32x16_bf16 v[64:79], v[116:119], v[128:131], v[64:79]
    ds_read_b64_tr_b16 v[136:137], v4 offset:3104
    ds_read_b64_tr_b16 v[138:139], v4 offset:4640
    s_cmp_eq_u32 s43, 13
    s_cbranch_scc0 L_noxf0
    s_waitcnt lgkmcnt(4)
    ds_read_b64 v[152:153], v165 offset:0
    ds_read_b64 v[154:155], v165 offset:256
    ds_read_b64 v[156:157], v165 offset:1024
    ds_read_b64 v[158:159], v165 offset:1280
    ds_read_b64 v[160:161], v165 offset:5120
    ds_read_b64 v[162:163], v165 offset:5376
    ds_read_b64 v[8:9], v13 offset:0
    ds_read_b64 v[10:11], v13 offset:256
L_noxf0:
    s_waitcnt lgkmcnt(8)
    v_mfma_f32_32x32x16_bf16 v[80:95], v[120:123], v[124:127], v[80:95]
    ds_read_b64_tr_b16 v[140:141], v4 offset:3136
    ds_read_b64_tr_b16 v[142:143], v4 offset:4672
    s_add_u32 s43, s43, 1
    v_mfma_f32_32x32x16_bf16 v[96:111], v[120:123], v[128:131], v[96:111]
    v_add_u32 v4, s44, v164
    v_add_u32 v5, s44, v2
    v_add_u32 v6, s44, v3
    s_waitcnt lgkmcnt(4)
    v_mfma_f32_32x32x16_bf16 v[16:31], v[132:135], v[144:147], v[16:31]
    s_barrier
    v_mfma_f32_32x32x16_bf16 v[32:47], v[132:135], v[148:151], v[32:47]
    ds_read_b64_tr_b16 v[112:113], v4 offset:0
    ds_read_b64_tr_b16 v[114:115], v4 offset:1536
    ds_read_b64_tr_b16 v[124:125], v5 offset:0
    ds_read_b64_tr_b16 v[126:127], v5 offset:2048
    s_waitcnt lgkmcnt(6)
    v_mfma_f32_32x32x16_bf16 v[48:63], v[136:139], v[144:147], v[48:63]
    ds_read_b64_tr_b16 v[128:129], v6 offset:0
    ds_read_b64_tr_b16 v[130:131], v6 offset:2048
    ds_read_b64_tr_b16 v[116:117], v4 offset:32
    ds_read_b64_tr_b16 v[118:119], v4 offset:1568
    v_mfma_f32_32x32x16_bf16 v[64:79], v[136:139], v[148:151], v[64:79]
    ds_read_b64_tr_b16 v[120:121], v4 offset:64
    ds_read_b64_tr_b16 v[122:123], v4 offset:1600
    s_waitcnt lgkmcnt(10)
    v_mfma_f32_32x32x16_bf16 v[80:95], v[140:143], v[144:147], v[80:95]
    s_cmp_lt_u32 s43, 16
    v_mfma_f32_32x32x16_bf16 v[96:111], v[140:143], v[148:151], v[96:111]
    s_cbranch_scc1 L_k3_loop0
    s_branch L_k3_fin
L_k3_p1:
    ds_read_b64_tr_b16 v[112:113], v4 offset:96
    ds_read_b64_tr_b16 v[114:115], v4 offset:1632
    ds_read_b64_tr_b16 v[124:125], v5 offset:0
    ds_read_b64_tr_b16 v[126:127], v5 offset:2048
    ds_read_b64_tr_b16 v[128:129], v6 offset:0
    ds_read_b64_tr_b16 v[130:131], v6 offset:2048
    ds_read_b64_tr_b16 v[116:117], v4 offset:128
    ds_read_b64_tr_b16 v[118:119], v4 offset:1664
    ds_read_b64_tr_b16 v[120:121], v4 offset:160
    ds_read_b64_tr_b16 v[122:123], v4 offset:1696
L_k3_loop1:
    s_waitcnt lgkmcnt(6)
    v_mfma_f32_32x32x16_bf16 v[16:31], v[112:115], v[124:127], v[16:31]
    ds_read_b64_tr_b16 v[132:133], v4 offset:3168
    ds_read_b64_tr_b16 v[134:135], v4 offset:4704
    s_waitcnt lgkmcnt(6)
    v_mfma_f32_32x32x16_bf16 v[32:47], v[112:115], v[128:131], v[32:47]
    ds_read_b64_tr_b16 v[144:145], v5 offset:4096
    ds_read_b64_tr_b16 v[146:147], v5 offset:6144
    s_add_u32 s47, s44, 20544
    s_waitcnt lgkmcnt(6)
    v_mfma_f32_32x32x16_bf16 v[48:63], v[116:119], v[124:127], v[48:63]
    ds_read_b64_tr_b16 v[148:149], v6 offset:4096
    ds_read_b64_tr_b16 v[150:151], v6 offset:6144
    s_cmp_eq_u32 s47, 143808
    s_cselect_b32 s44, 0, s47
    v_mfma_f32_32x32x16_bf16 v[64:79], v[116:119], v[128:131], v[64:79]
    ds_read_b64_tr_b16 v[136:137], v4 offset:3200
    ds_read_b64_tr_b16 v[138:139], v4 offset:4736
    s_cmp_eq_u32 s43, 13
    s_cbranch_scc0 L_noxf1
    s_waitcnt lgkmcnt(4)
    ds_read_b64 v[152:153], v165 offset:6144
    ds_read_b64 v[154:155], v165 offset:6400
    ds_read_b64 v[156:157], v165 offset:10240
    ds_read_b64 v[158:159], v165 offset:10496
    ds_read_b64 v[160:161], v165 offset:11264
    ds_read_b64 v[162:163], v165 offset:11520
    ds_read_b64 v[8:9], v13 offset:0
    ds_read_b64 v[10:11], v13 offset:256
L_noxf1:
    s_waitcnt lgkmcnt(8)
    v_mfma_f32_32x32x16_bf16 v[80:95], v[120:123], v[124:127], v[80:95]
    ds_read_b64_tr_b16 v[140:141], v4 offset:3232
    ds_read_b64_tr_b16 v[142:143], v4 offset:4768
    s_add_u32 s43, s43, 1
    v_mfma_f32_32x32x16_bf16 v[96:111], v[120:123], v[128:131], v[96:111]
    v_add_u32 v4, s44, v164
    v_add_u32 v5, s44, v2
    v_add_u32 v6, s44, v3
    s_waitcnt lgkmcnt(4)
    v_mfma_f32_32x32x16_bf16 v[16:31], v[132:135], v[144:147], v[16:31]
    s_barrier
    v_mfma_f32_32x32x16_bf16 v[32:47], v[132:135], v[148:151], v[32:47]
    ds_read_b64_tr_b16 v[112:113], v4 offset:96
    ds_read_b64_tr_b16 v[114:115], v4 offset:1632
    ds_read_b64_tr_b16 v[124:125], v5 offset:0
    ds_read_b64_tr_b16 v[126:127], v5 offset:2048
    s_waitcnt lgkmcnt(6)
    v_mfma_f32_32x32x16_bf16 v[48:63], v[136:139], v[144:147], v[48:63]
    ds_read_b64_tr_b16 v[128:129], v6 offset:0
    ds_read_b64_tr_b16 v[130:131], v6 offset:2048
    ds_read_b64_tr_b16 v[116:117], v4 offset:128
    ds_read_b64_tr_b16 v[118:119], v4 offset:1664
    v_mfma_f32_32x32x16_bf16 v[64:79], v[136:139], v[148:151], v[64:79]
    ds_read_b64_tr_b16 v[120:121], v4 offset:160
    ds_read_b64_tr_b16 v[122:123], v4 offset:1696
    s_waitcnt lgkmcnt(10)
    v_mfma_f32_32x32x16_bf16 v[80:95], v[140:143], v[144:147], v[80:95]
    s_cmp_lt_u32 s43, 16
    v_mfma_f32_32x32x16_bf16 v[96:111], v[140:143], v[148:151], v[96:111]
    s_cbranch_scc1 L_k3_loop1
L_k3_fin:
    s_waitcnt vmcnt(0) lgkmcnt(0)
    s_mov_b32 s47, 0
L_k3_rec:
    v_cmp_ne_u32 vcc, s59, v9
    v_cmp_ne_u32 s[36:37], s59, v11
    s_or_b64 vcc, vcc, s[36:37]
    s_cmp_eq_u64 vcc, 0
    s_cbranch_scc1 L_k3_recok
    s_add_u32 s47, s47, 1
    s_cmp_lt_u32 s47, 8000
    s_cbranch_scc0 L_k3_recok
    buffer_load_dwordx2 v[8:9], v12, s[68:71], s46 offen offset:0 sc1
    buffer_load_dwordx2 v[10:11], v12, s[68:71], s46 offen offset:256 sc1
    s_waitcnt vmcnt(0)
    s_branch L_k3_rec
L_k3_recok:
    s_mov_b32 s36, 0x01000100
    s_mov_b32 s37, 0x03020302
    v_perm_b32 v132, v8, v8, s36
    v_perm_b32 v133, v8, v8, s37
    v_perm_b32 v134, v8, v8, s36
    v_perm_b32 v135, v8, v8, s37
    v_perm_b32 v136, v10, v10, s36
    v_perm_b32 v137, v10, v10, s37
    v_perm_b32 v138, v10, v10, s36
    v_perm_b32 v139, v10, v10, s37
    v_mfma_f32_32x32x16_bf16 v[16:31], v[152:155], v[132:135], v[16:31]
    v_and_b32 v9, 0xffff0000, v8
    v_and_b32 v11, 0xffff0000, v10
    v_rcp_f32 v112, v9
    v_mfma_f32_32x32x16_bf16 v[32:47], v[152:155], v[136:139], v[32:47]
    v_rcp_f32 v120, v11
    v_mul_f32 v116, v9, v9
    v_mul_f32 v124, v11, v11
    v_mfma_f32_32x32x16_bf16 v[48:63], v[156:159], v[132:135], v[48:63]
    v_mul_f32 v114, 0xc0135761, v112
    v_mul_f32 v115, v112, v112
    v_mul_f32 v122, 0xc0135761, v120
    v_mfma_f32_32x32x16_bf16 v[64:79], v[156:159], v[136:139], v[64:79]
    v_mul_f32 v123, v120, v120
    v_mul_f32 v115, v115, v112
    v_mul_f32 v123, v123, v120
    v_mfma_f32_32x32x16_bf16 v[80:95], v[160:163], v[132:135], v[80:95]
    v_mul_f32 v115, 0xbdd2d3e8, v115
    v_mul_f32 v123, 0xbdd2d3e8, v123
    v_mfma_f32_32x32x16_bf16 v[96:111], v[160:163], v[136:139], v[96:111]
    s_lshl_b32 s32, s26, 2
    s_add_u32 s32, s32, s41
    s_mul_i32 s32, s32, 88064
    s_add_u32 s32, s32, s31
    s_add_u32 s33, s32, 88064
    v_pk_mul_f32 v[140:141], v[16:17], v[16:17]
    v_pk_mul_f32 v[142:143], v[18:19], v[18:19]
    v_pk_mul_f32 v[144:145], v[20:21], v[20:21]
    v_pk_mul_f32 v[146:147], v[22:23], v[22:23]
    v_pk_fma_f32 v[140:141], v[140:141], v[114:115], v[114:115] op_sel:[0,1,0] op_sel_hi:[1,1,0]
    v_pk_fma_f32 v[142:143], v[142:143], v[114:115], v[114:115] op_sel:[0,1,0] op_sel_hi:[1,1,0]
    v_pk_fma_f32 v[144:145], v[144:145], v[114:115], v[114:115] op_sel:[0,1,0] op_sel_hi:[1,1,0]
    v_pk_fma_f32 v[146:147], v[146:147], v[114:115], v[114:115] op_sel:[0,1,0] op_sel_hi:[1,1,0]
    v_pk_mul_f32 v[140:141], v[140:141], v[16:17]
    v_pk_mul_f32 v[142:143], v[142:143], v[18:19]
    v_pk_mul_f32 v[144:145], v[144:145], v[20:21]
    v_pk_mul_f32 v[146:147], v[146:147], v[22:23]
    v_exp_f32 v140, v140
    v_exp_f32 v141, v141
    v_exp_f32 v142, v142
    v_exp_f32 v143, v143
    v_exp_f32 v144, v144
    v_exp_f32 v145, v145
    v_exp_f32 v146, v146
    v_exp_f32 v147, v147
    v_pk_mul_f32 v[16:17], v[16:17], v[24:25]
    v_pk_mul_f32 v[18:19], v[18:19], v[26:27]
    v_pk_mul_f32 v[20:21], v[20:21], v[28:29]
    v_pk_mul_f32 v[22:23], v[22:23], v[30:31]
    v_pk_fma_f32 v[140:141], v[140:141], v[116:117], v[116:117] op_sel_hi:[1,0,0]
    v_pk_fma_f32 v[142:143], v[142:143], v[116:117], v[116:117] op_sel_hi:[1,0,0]
    v_pk_fma_f32 v[144:145], v[144:145], v[116:117], v[116:117] op_sel_hi:[1,0,0]
    v_pk_fma_f32 v[146:147], v[146:147], v[116:117], v[116:117] op_sel_hi:[1,0,0]
    v_rcp_f32 v140, v140
    v_rcp_f32 v141, v141
    v_rcp_f32 v142, v142
    v_rcp_f32 v143, v143
    v_rcp_f32 v144, v144
    v_rcp_f32 v145, v145
    v_rcp_f32 v146, v146
    v_rcp_f32 v147, v147
    v_pk_mul_f32 v[16:17], v[16:17], v[140:141]
    v_pk_mul_f32 v[18:19], v[18:19], v[142:143]
    v_pk_mul_f32 v[20:21], v[20:21], v[144:145]
    v_pk_mul_f32 v[22:23], v[22:23], v[146:147]
    v_cvt_pk_bf16_f32 v156, v16, v17
    v_cvt_pk_bf16_f32 v157, v18, v19
    v_cvt_pk_bf16_f32 v158, v20, v21
    v_cvt_pk_bf16_f32 v159, v22, v23
    s_add_u32 s34, s30, 0
    s_cmp_lt_u32 s34, 86
    s_cbranch_scc0 L_k3_flag
    buffer_store_dwordx4 v[156:159], v1, s[20:23], s32 offen offset:0 sc1
    v_pk_mul_f32 v[148:149], v[32:33], v[32:33]
    v_pk_mul_f32 v[150:151], v[34:35], v[34:35]
    v_pk_mul_f32 v[152:153], v[36:37], v[36:37]
    v_pk_mul_f32 v[154:155], v[38:39], v[38:39]
    v_pk_fma_f32 v[148:149], v[148:149], v[122:123], v[122:123] op_sel:[0,1,0] op_sel_hi:[1,1,0]
    v_pk_fma_f32 v[150:151], v[150:151], v[122:123], v[122:123] op_sel:[0,1,0] op_sel_hi:[1,1,0]
    v_pk_fma_f32 v[152:153], v[152:153], v[122:123], v[122:123] op_sel:[0,1,0] op_sel_hi:[1,1,0]
    v_pk_fma_f32 v[154:155], v[154:155], v[122:123], v[122:123] op_sel:[0,1,0] op_sel_hi:[1,1,0]
    v_pk_mul_f32 v[148:149], v[148:149], v[32:33]
    v_pk_mul_f32 v[150:151], v[150:151], v[34:35]
    v_pk_mul_f32 v[152:153], v[152:153], v[36:37]
    v_pk_mul_f32 v[154:155], v[154:155], v[38:39]
    v_exp_f32 v148, v148
    v_exp_f32 v149, v149
    v_exp_f32 v150, v150
    v_exp_f32 v151, v151
    v_exp_f32 v152, v152
    v_exp_f32 v153, v153
    v_exp_f32 v154, v154
    v_exp_f32 v155, v155
    v_pk_mul_f32 v[32:33], v[32:33], v[40:41]
    v_pk_mul_f32 v[34:35], v[34:35], v[42:43]
    v_pk_mul_f32 v[36:37], v[36:37], v[44:45]
    v_pk_mul_f32 v[38:39], v[38:39], v[46:47]
    v_pk_fma_f32 v[148:149], v[148:149], v[124:125], v[124:125] op_sel_hi:[1,0,0]
    v_pk_fma_f32 v[150:151], v[150:151], v[124:125], v[124:125] op_sel_hi:[1,0,0]
    v_pk_fma_f32 v[152:153], v[152:153], v[124:125], v[124:125] op_sel_hi:[1,0,0]
    v_pk_fma_f32 v[154:155], v[154:155], v[124:125], v[124:125] op_sel_hi:[1,0,0]
    v_rcp_f32 v148, v148
    v_rcp_f32 v149, v149
    v_rcp_f32 v150, v150
    v_rcp_f32 v151, v151
    v_rcp_f32 v152, v152
    v_rcp_f32 v153, v153
    v_rcp_f32 v154, v154
    v_rcp_f32 v155, v155
    v_pk_mul_f32 v[32:33], v[32:33], v[148:149]
    v_pk_mul_f32 v[34:35], v[34:35], v[150:151]
    v_pk_mul_f32 v[36:37], v[36:37], v[152:153]
    v_pk_mul_f32 v[38:39], v[38:39], v[154:155]
    v_cvt_pk_bf16_f32 v160, v32, v33
    v_cvt_pk_bf16_f32 v161, v34, v35
    v_cvt_pk_bf16_f32 v162, v36, v37
    v_cvt_pk_bf16_f32 v163, v38, v39
    buffer_store_dwordx4 v[160:163], v1, s[20:23], s33 offen offset:0 sc1
    v_pk_mul_f32 v[140:141], v[48:49], v[48:49]
    v_pk_mul_f32 v[142:143], v[50:51], v[50:51]
    v_pk_mul_f32 v[144:145], v[52:53], v[52:53]
    v_pk_mul_f32 v[146:147], v[54:55], v[54:55]
    v_pk_fma_f32 v[140:141], v[140:141], v[114:115], v[114:115] op_sel:[0,1,0] op_sel_hi:[1,1,0]
    v_pk_fma_f32 v[142:143], v[142:143], v[114:115], v[114:115] op_sel:[0,1,0] op_sel_hi:[1,1,0]
    v_pk_fma_f32 v[144:145], v[144:145], v[114:115], v[114:115] op_sel:[0,1,0] op_sel_hi:[1,1,0]
    v_pk_fma_f32 v[146:147], v[146:147], v[114:115], v[114:115] op_sel:[0,1,0] op_sel_hi:[1,1,0]
    v_pk_mul_f32 v[140:141], v[140:141], v[48:49]
    v_pk_mul_f32 v[142:143], v[142:143], v[50:51]
    v_pk_mul_f32 v[144:145], v[144:145], v[52:53]
    v_pk_mul_f32 v[146:147], v[146:147], v[54:55]
    v_exp_f32 v140, v140
    v_exp_f32 v141, v141
    v_exp_f32 v142, v142
    v_exp_f32 v143, v143
    v_exp_f32 v144, v144
    v_exp_f32 v145, v145
    v_exp_f32 v146, v146
    v_exp_f32 v147, v147
    v_pk_mul_f32 v[48:49], v[48:49], v[56:57]
    v_pk_mul_f32 v[50:51], v[50:51], v[58:59]
    v_pk_mul_f32 v[52:53], v[52:53], v[60:61]
    v_pk_mul_f32 v[54:55], v[54:55], v[62:63]
    v_pk_fma_f32 v[140:141], v[140:141], v[116:117], v[116:117] op_sel_hi:[1,0,0]
    v_pk_fma_f32 v[142:143], v[142:143], v[116:117], v[116:117] op_sel_hi:[1,0,0]
    v_pk_fma_f32 v[144:145], v[144:145], v[116:117], v[116:117] op_sel_hi:[1,0,0]
    v_pk_fma_f32 v[146:147], v[146:147], v[116:117], v[116:117] op_sel_hi:[1,0,0]
    v_rcp_f32 v140, v140
    v_rcp_f32 v141, v141
    v_rcp_f32 v142, v142
    v_rcp_f32 v143, v143
    v_rcp_f32 v144, v144
    v_rcp_f32 v145, v145
    v_rcp_f32 v146, v146
    v_rcp_f32 v147, v147
    v_pk_mul_f32 v[48:49], v[48:49], v[140:141]
    v_pk_mul_f32 v[50:51], v[50:51], v[142:143]
    v_pk_mul_f32 v[52:53], v[52:53], v[144:145]
    v_pk_mul_f32 v[54:55], v[54:55], v[146:147]
    v_cvt_pk_bf16_f32 v156, v48, v49
    v_cvt_pk_bf16_f32 v157, v50, v51
    v_cvt_pk_bf16_f32 v158, v52, v53
    v_cvt_pk_bf16_f32 v159, v54, v55
    s_add_u32 s34, s30, 1
    s_cmp_lt_u32 s34, 86
    s_cbranch_scc0 L_k3_flag
    buffer_store_dwordx4 v[156:159], v1, s[20:23], s32 offen offset:1024 sc1
    v_pk_mul_f32 v[148:149], v[64:65], v[64:65]
    v_pk_mul_f32 v[150:151], v[66:67], v[66:67]
    v_pk_mul_f32 v[152:153], v[68:69], v[68:69]
    v_pk_mul_f32 v[154:155], v[70:71], v[70:71]
    v_pk_fma_f32 v[148:149], v[148:149], v[122:123], v[122:123] op_sel:[0,1,0] op_sel_hi:[1,1,0]
    v_pk_fma_f32 v[150:151], v[150:151], v[122:123], v[122:123] op_sel:[0,1,0] op_sel_hi:[1,1,0]
    v_pk_fma_f32 v[152:153], v[152:153], v[122:123], v[122:123] op_sel:[0,1,0] op_sel_hi:[1,1,0]
    v_pk_fma_f32 v[154:155], v[154:155], v[122:123], v[122:123] op_sel:[0,1,0] op_sel_hi:[1,1,0]
    v_pk_mul_f32 v[148:149], v[148:149], v[64:65]
    v_pk_mul_f32 v[150:151], v[150:151], v[66:67]
    v_pk_mul_f32 v[152:153], v[152:153], v[68:69]
    v_pk_mul_f32 v[154:155], v[154:155], v[70:71]
    v_exp_f32 v148, v148
    v_exp_f32 v149, v149
    v_exp_f32 v150, v150
    v_exp_f32 v151, v151
    v_exp_f32 v152, v152
    v_exp_f32 v153, v153
    v_exp_f32 v154, v154
    v_exp_f32 v155, v155
    v_pk_mul_f32 v[64:65], v[64:65], v[72:73]
    v_pk_mul_f32 v[66:67], v[66:67], v[74:75]
    v_pk_mul_f32 v[68:69], v[68:69], v[76:77]
    v_pk_mul_f32 v[70:71], v[70:71], v[78:79]
    v_pk_fma_f32 v[148:149], v[148:149], v[124:125], v[124:125] op_sel_hi:[1,0,0]
    v_pk_fma_f32 v[150:151], v[150:151], v[124:125], v[124:125] op_sel_hi:[1,0,0]
    v_pk_fma_f32 v[152:153], v[152:153], v[124:125], v[124:125] op_sel_hi:[1,0,0]
    v_pk_fma_f32 v[154:155], v[154:155], v[124:125], v[124:125] op_sel_hi:[1,0,0]
    v_rcp_f32 v148, v148
    v_rcp_f32 v149, v149
    v_rcp_f32 v150, v150
    v_rcp_f32 v151, v151
    v_rcp_f32 v152, v152
    v_rcp_f32 v153, v153
    v_rcp_f32 v154, v154
    v_rcp_f32 v155, v155
    v_pk_mul_f32 v[64:65], v[64:65], v[148:149]
    v_pk_mul_f32 v[66:67], v[66:67], v[150:151]
    v_pk_mul_f32 v[68:69], v[68:69], v[152:153]
    v_pk_mul_f32 v[70:71], v[70:71], v[154:155]
    v_cvt_pk_bf16_f32 v160, v64, v65
    v_cvt_pk_bf16_f32 v161, v66, v67
    v_cvt_pk_bf16_f32 v162, v68, v69
    v_cvt_pk_bf16_f32 v163, v70, v71
    buffer_store_dwordx4 v[160:163], v1, s[20:23], s33 offen offset:1024 sc1
    v_pk_mul_f32 v[140:141], v[80:81], v[80:81]
    v_pk_mul_f32 v[142:143], v[82:83], v[82:83]
    v_pk_mul_f32 v[144:145], v[84:85], v[84:85]
    v_pk_mul_f32 v[146:147], v[86:87], v[86:87]
    v_pk_fma_f32 v[140:141], v[140:141], v[114:115], v[114:115] op_sel:[0,1,0] op_sel_hi:[1,1,0]
    v_pk_fma_f32 v[142:143], v[142:143], v[114:115], v[114:115] op_sel:[0,1,0] op_sel_hi:[1,1,0]
    v_pk_fma_f32 v[144:145], v[144:145], v[114:115], v[114:115] op_sel:[0,1,0] op_sel_hi:[1,1,0]
    v_pk_fma_f32 v[146:147], v[146:147], v[114:115], v[114:115] op_sel:[0,1,0] op_sel_hi:[1,1,0]
    v_pk_mul_f32 v[140:141], v[140:141], v[80:81]
    v_pk_mul_f32 v[142:143], v[142:143], v[82:83]
    v_pk_mul_f32 v[144:145], v[144:145], v[84:85]
    v_pk_mul_f32 v[146:147], v[146:147], v[86:87]
    v_exp_f32 v140, v140
    v_exp_f32 v141, v141
    v_exp_f32 v142, v142
    v_exp_f32 v143, v143
    v_exp_f32 v144, v144
    v_exp_f32 v145, v145
    v_exp_f32 v146, v146
    v_exp_f32 v147, v147
    v_pk_mul_f32 v[80:81], v[80:81], v[88:89]
    v_pk_mul_f32 v[82:83], v[82:83], v[90:91]
    v_pk_mul_f32 v[84:85], v[84:85], v[92:93]
    v_pk_mul_f32 v[86:87], v[86:87], v[94:95]
    v_pk_fma_f32 v[140:141], v[140:141], v[116:117], v[116:117] op_sel_hi:[1,0,0]
    v_pk_fma_f32 v[142:143], v[142:143], v[116:117], v[116:117] op_sel_hi:[1,0,0]
    v_pk_fma_f32 v[144:145], v[144:145], v[116:117], v[116:117] op_sel_hi:[1,0,0]
    v_pk_fma_f32 v[146:147], v[146:147], v[116:117], v[116:117] op_sel_hi:[1,0,0]
    v_rcp_f32 v140, v140
    v_rcp_f32 v141, v141
    v_rcp_f32 v142, v142
    v_rcp_f32 v143, v143
    v_rcp_f32 v144, v144
    v_rcp_f32 v145, v145
    v_rcp_f32 v146, v146
    v_rcp_f32 v147, v147
    v_pk_mul_f32 v[80:81], v[80:81], v[140:141]
    v_pk_mul_f32 v[82:83], v[82:83], v[142:143]
    v_pk_mul_f32 v[84:85], v[84:85], v[144:145]
    v_pk_mul_f32 v[86:87], v[86:87], v[146:147]
    v_cvt_pk_bf16_f32 v156, v80, v81
    v_cvt_pk_bf16_f32 v157, v82, v83
    v_cvt_pk_bf16_f32 v158, v84, v85
    v_cvt_pk_bf16_f32 v159, v86, v87
    s_add_u32 s34, s30, 2
    s_cmp_lt_u32 s34, 86
    s_cbranch_scc0 L_k3_flag
    buffer_store_dwordx4 v[156:159], v1, s[20:23], s32 offen offset:2048 sc1
    v_pk_mul_f32 v[148:149], v[96:97], v[96:97]
    v_pk_mul_f32 v[150:151], v[98:99], v[98:99]
    v_pk_mul_f32 v[152:153], v[100:101], v[100:101]
    v_pk_mul_f32 v[154:155], v[102:103], v[102:103]
    v_pk_fma_f32 v[148:149], v[148:149], v[122:123], v[122:123] op_sel:[0,1,0] op_sel_hi:[1,1,0]
    v_pk_fma_f32 v[150:151], v[150:151], v[122:123], v[122:123] op_sel:[0,1,0] op_sel_hi:[1,1,0]
    v_pk_fma_f32 v[152:153], v[152:153], v[122:123], v[122:123] op_sel:[0,1,0] op_sel_hi:[1,1,0]
    v_pk_fma_f32 v[154:155], v[154:155], v[122:123], v[122:123] op_sel:[0,1,0] op_sel_hi:[1,1,0]
    v_pk_mul_f32 v[148:149], v[148:149], v[96:97]
    v_pk_mul_f32 v[150:151], v[150:151], v[98:99]
    v_pk_mul_f32 v[152:153], v[152:153], v[100:101]
    v_pk_mul_f32 v[154:155], v[154:155], v[102:103]
    v_exp_f32 v148, v148
    v_exp_f32 v149, v149
    v_exp_f32 v150, v150
    v_exp_f32 v151, v151
    v_exp_f32 v152, v152
    v_exp_f32 v153, v153
    v_exp_f32 v154, v154
    v_exp_f32 v155, v155
    v_pk_mul_f32 v[96:97], v[96:97], v[104:105]
    v_pk_mul_f32 v[98:99], v[98:99], v[106:107]
    v_pk_mul_f32 v[100:101], v[100:101], v[108:109]
    v_pk_mul_f32 v[102:103], v[102:103], v[110:111]
    v_pk_fma_f32 v[148:149], v[148:149], v[124:125], v[124:125] op_sel_hi:[1,0,0]
    v_pk_fma_f32 v[150:151], v[150:151], v[124:125], v[124:125] op_sel_hi:[1,0,0]
    v_pk_fma_f32 v[152:153], v[152:153], v[124:125], v[124:125] op_sel_hi:[1,0,0]
    v_pk_fma_f32 v[154:155], v[154:155], v[124:125], v[124:125] op_sel_hi:[1,0,0]
    v_rcp_f32 v148, v148
    v_rcp_f32 v149, v149
    v_rcp_f32 v150, v150
    v_rcp_f32 v151, v151
    v_rcp_f32 v152, v152
    v_rcp_f32 v153, v153
    v_rcp_f32 v154, v154
    v_rcp_f32 v155, v155
    v_pk_mul_f32 v[96:97], v[96:97], v[148:149]
    v_pk_mul_f32 v[98:99], v[98:99], v[150:151]
    v_pk_mul_f32 v[100:101], v[100:101], v[152:153]
    v_pk_mul_f32 v[102:103], v[102:103], v[154:155]
    v_cvt_pk_bf16_f32 v160, v96, v97
    v_cvt_pk_bf16_f32 v161, v98, v99
    v_cvt_pk_bf16_f32 v162, v100, v101
    v_cvt_pk_bf16_f32 v163, v102, v103
    buffer_store_dwordx4 v[160:163], v1, s[20:23], s33 offen offset:2048 sc1
L_k3_flag:
    v_mov_b32 v14, 163376
    v_mov_b32 v15, 1
    s_mov_b64 exec, 1
    ds_add_u32 v14, v15
    s_mov_b64 exec, -1
    v_mov_b32 v12, s59
    v_mov_b32 v13, s59
    v_mov_b32 v14, s59
    v_mov_b32 v15, s59
    v_mov_b32 v10, 163344
    v_mov_b32 v11, 1
    s_waitcnt vmcnt(0)
    s_mov_b64 exec, 0xff
    buffer_store_dwordx4 v[12:15], v1, s[64:67], s35 offen sc1
    s_mov_b64 exec, 1
    ds_add_u32 v10, v11
    s_mov_b64 exec, -1
L_k3_done:
L_kf_exit:
    s_endpgm
.section .rodata,"a"
.p2align 6
.amdhsa_kernel adaLN_cond__ssm_conv_s4d__geglu_ffn__prompt_kernel
  .amdhsa_next_free_vgpr 168
  .amdhsa_next_free_sgpr 96
  .amdhsa_accum_offset 168
  .amdhsa_group_segment_fixed_size 0
  .amdhsa_kernarg_size 128
  .amdhsa_user_sgpr_count 2
  .amdhsa_user_sgpr_kernarg_segment_ptr 1
  .amdhsa_system_sgpr_workgroup_id_x 1
  .amdhsa_float_denorm_mode_32 3
.end_amdhsa_kernel
```
